```python
import torch

def _softmax(x, axis=-1):
    return torch.softmax(x, dim=axis)
def _gelu(x):
    return torch.nn.functional.gelu(x, approximate="tanh")
def _silu(x):
    return torch.nn.functional.silu(x)
def _sigmoid(x):
    return torch.sigmoid(x)
def _layernorm(x, axis=-1, eps=1e-5):
    m = x.mean(dim=axis, keepdim=True)
    v = x.var(dim=axis, keepdim=True, unbiased=False)
    return (x - m) / torch.sqrt(v + eps)
def _scatter_add(tgt, idx, src, axis=0):
    return tgt.clone().index_add_(axis, idx, src)
def _segment_sum(src, seg, n):
    out = torch.zeros((n,) + src.shape[1:], dtype=src.dtype)
    return out.index_add_(0, seg, src)
def _pad(x, pw):
    flat = tuple(v for pair in reversed(pw) for v in pair)
    return torch.nn.functional.pad(x, flat)

kernel_name = 'recurrent_scan__linear_attn_block__glu_gated_reglu__prompt'

def setup_inputs():

    _w = (lambda a: (lambda t: t.to(torch.bfloat16) if t.is_floating_point() else t)(torch.as_tensor(a)))
    def _A_setup():
        B, S, D = 1, 2048, 640
        return {
            "x": _w((lambda *s: torch.randn(*s, dtype=torch.bfloat16) * 0.05)(B, S, D)),
            "wqkv": _w((lambda *s: torch.randn(*s, dtype=torch.bfloat16) * 0.8)(D, 3 * D)),
            "wo": _w((lambda *s: torch.randn(*s, dtype=torch.bfloat16) * 0.8)(D, D)),
        }
    _A_in = _A_setup()

    def _B_setup():
        B, S, D, F = 1, 2048, 640, 1728
        return {
            "x": _w((lambda *s: torch.randn(*s, dtype=torch.bfloat16) * 0.05)(B, S, D)),
            "W_gate": _w((lambda *s: torch.randn(*s, dtype=torch.bfloat16) * 0.2)(D, F) * (2.0 / D) ** 0.5),
            "W_up": _w((lambda *s: torch.randn(*s, dtype=torch.bfloat16) * 0.2)(D, F) * (2.0 / D) ** 0.5),
            "W_down": _w((lambda *s: torch.randn(*s, dtype=torch.bfloat16) * 0.2)(F, D) * (1.0 / F) ** 0.5),
        }
    _B_in = _B_setup()

    return {
        "A_x": _A_in["x"],
        "A_wqkv": _A_in["wqkv"],
        "A_wo": _A_in["wo"],
        "B_x": _B_in["x"],
        "B_W_gate": _B_in["W_gate"],
        "B_W_up": _B_in["W_up"],
        "B_W_down": _B_in["W_down"],
    }

def reference(A_x, A_wqkv, A_wo, B_x, B_W_gate, B_W_up, B_W_down):
    def _A_ref(x, wqkv, wo):
        B, S, D = x.shape
        H = 32; Dh = D // H
        qkv = (lambda x, *d: x.permute(*d))((x @ wqkv).reshape(B, S, 3, H, Dh), 2, 0, 3, 1, 4)
        q, k, v = qkv[0], qkv[1], qkv[2]
        phi = lambda t: torch.where(t > 0, t + 1, torch.exp(t)) + 1e-6
        pq, pk = phi(q), phi(k)
        kv = torch.einsum("bhsd,bhse->bhde", pk, v)
        z = torch.einsum("bhsd->bhd", pk)
        num = torch.einsum("bhqd,bhde->bhqe", pq, kv)
        den = torch.einsum("bhqd,bhd->bhq", pq, z)[..., None] + 1e-6
        o = num / den
        return (lambda x, *d: x.permute(*d))(o, 0, 2, 1, 3).reshape(B, S, D) @ wo

    def _B_ref(x, W_gate, W_up, W_down):
        gate = torch.einsum("bsd,df->bsf", x, W_gate)
        up = torch.einsum("bsd,df->bsf", x, W_up)
        gate = gate * (lambda x, dt: x.to(dt))(gate > 0, gate.dtype)
        h = gate * up
        return torch.einsum("bsf,fd->bsd", h, W_down)

    x = A_x
    xn = _layernorm(x, axis=-1)
    s = _A_ref(xn, A_wqkv, A_wo)
    g = _silu(_B_ref(xn, B_W_gate, B_W_up, B_W_down))
    return x + s * g
```

```asm
; @launch grid=(256,1,1) block=(512,1,1) lds=163840
.amdgcn_target "amdgcn-amd-amdhsa--gfx950"
.text
.globl recurrent_scan__linear_attn_block__glu_gated_reglu__prompt_kernel
.p2align 8
.type recurrent_scan__linear_attn_block__glu_gated_reglu__prompt_kernel,@function
recurrent_scan__linear_attn_block__glu_gated_reglu__prompt_kernel:
    s_cmp_ge_u32 s2, 256
    s_cbranch_scc1 L_k1_end
    s_load_dwordx4 s[4:7], s[0:1], 0
    s_load_dwordx2 s[8:9], s[0:1], 16
    s_load_dwordx4 s[12:15], s[0:1], 32
    s_load_dwordx2 s[10:11], s[0:1], 48
    s_load_dwordx2 s[16:17], s[0:1], 72
    v_lshrrev_b32 v1, 6, v0
    v_and_b32 v0, 63, v0
    v_readfirstlane_b32 s3, v1
    s_load_dwordx2 s[18:19], s[0:1], 64
    s_and_b32 s56, s2, 7
    s_lshr_b32 s57, s2, 3
    s_and_b32 s54, s56, 1
    s_lshr_b32 s56, s56, 1
    s_lshr_b32 s55, s57, 3
    s_and_b32 s57, s57, 7
    s_cmp_lt_u32 s3, 4
    s_cbranch_scc1 L_k1_nocpf
    s_cmp_ge_u32 s2, 32
    s_cbranch_scc1 L_k1_nocpf
    s_getpc_b64 s[76:77]
L_k1_pc:
    s_mov_b32 s78, L_code_end-L_k1_pc
    s_mov_b32 s79, 0x20000
    s_and_b32 s71, s3, 3
    s_lshl_b32 s71, s71, 13
    v_lshlrev_b32 v2, 7, v0
    buffer_load_dword v240, v2, s[76:79], s71 offen
    s_add_u32 s71, s71, 32768
    buffer_load_dword v240, v2, s[76:79], s71 offen
L_k1_nocpf:
    s_xor_b32 s70, s55, 1
    s_cmp_ge_u32 s55, 2
    s_cselect_b32 s55, s70, s55
    s_lshl_b32 s67, s55, 6
    s_and_b32 s70, s2, 63
    s_or_b32 s67, s67, s70
    s_cmp_eq_u32 s55, 2
    s_cbranch_scc1 L_k1_deck
    s_lshl_b32 s41, s55, 2
    s_cmp_eq_u32 s55, 3
    s_cselect_b32 s41, 8, s41
    s_add_u32 s41, s41, s56
    s_mul_i32 s70, s55, 3
    s_add_u32 s70, s70, s57
    s_cmp_ge_u32 s70, 10
    s_cselect_b32 s56, 10, 0
    s_sub_u32 s70, s70, s56
    s_mov_b32 s70, 0
    s_lshl_b32 s54, s54, 3
    s_add_u32 s54, s54, s57
    s_lshl_b32 s40, s54, 7
    s_cmp_lt_u32 s41, 9
    s_cbranch_scc1 L_k1_F
    s_sub_u32 s41, s41, 9
    s_cmp_lt_u32 s41, 2
    s_cbranch_scc1 L_k1_Q
    s_mov_b32 s41, s54
    s_branch L_k1_R
L_k1_deck:
    s_lshl_b32 s41, s56, 1
    s_lshr_b32 s56, s57, 2
    s_add_u32 s41, s41, s56
    s_and_b32 s57, s57, 3
    s_lshl_b32 s70, s57, 1
    s_mul_i32 s56, s56, 5
    s_add_u32 s70, s70, s56
    s_add_u32 s70, s70, 6
    s_cmp_ge_u32 s70, 10
    s_cselect_b32 s56, 10, 0
    s_sub_u32 s70, s70, s56
    s_mov_b32 s70, 0
    s_lshl_b32 s54, s54, 2
    s_add_u32 s54, s54, s57
    s_lshl_b32 s40, s54, 8
    s_branch L_k1_K
L_k1_F:
    s_and_b32 s59, s3, 3
    s_mov_b32 s43, s59
    s_lshr_b32 s42, s3, 2
    s_lshl_b32 s56, s59, 3
    s_add_u32 s56, s56, s40
    v_lshrrev_b32 v200, 3, v0
    v_add_u32 v200, s56, v200
    v_mul_u32_u24 v200, 1280, v200
    s_and_b32 s56, s3, 1
    s_lshl_b32 s56, s56, 2
    v_lshrrev_b32 v201, 4, v0
    v_add_u32 v201, s56, v201
    v_xor_b32 v201, v201, v0
    v_and_b32 v201, 7, v201
    v_lshl_add_u32 v190, v201, 4, v200
    v_add_u32 v191, 40960, v190
    s_lshl_b32 s48, s59, 10
    s_add_u32 s49, s48, 98304
    s_mul_i32 s44, s70, 221184
    s_mov_b32 s45, s48
    s_lshl_b32 s46, s70, 7
    s_mov_b32 s47, s49
    s_lshl_b32 s56, s59, 6
    s_add_u32 s56, s56, 0
    v_add_u32 v200, s56, v0
    v_mul_u32_u24 v201, 2731, v200
    v_lshrrev_b32 v201, 16, v201
    v_mul_u32_u24 v202, 24, v201
    v_sub_u32 v202, v200, v202
    v_and_b32 v203, 0x13, v201
    v_bfe_u32 v204, v201, 2, 1
    v_lshl_or_b32 v203, v204, 3, v203
    v_bfe_u32 v204, v201, 3, 1
    v_lshl_or_b32 v203, v204, 2, v203
    v_mul_u32_u24 v203, 3456, v203
    v_and_b32 v204, 6, v201
    v_xor_b32 v204, v204, v202
    v_lshl_add_u32 v203, v204, 4, v203
    s_mul_i32 s56, s41, 384
    v_add_u32 v184, s56, v203
    s_lshl_b32 s56, s59, 6
    s_add_u32 s56, s56, 256
    v_add_u32 v200, s56, v0
    v_mul_u32_u24 v201, 2731, v200
    v_lshrrev_b32 v201, 16, v201
    v_mul_u32_u24 v202, 24, v201
    v_sub_u32 v202, v200, v202
    v_and_b32 v203, 0x13, v201
    v_bfe_u32 v204, v201, 2, 1
    v_lshl_or_b32 v203, v204, 3, v203
    v_bfe_u32 v204, v201, 3, 1
    v_lshl_or_b32 v203, v204, 2, v203
    v_mul_u32_u24 v203, 3456, v203
    v_and_b32 v204, 6, v201
    v_xor_b32 v204, v204, v202
    v_lshl_add_u32 v203, v204, 4, v203
    s_mul_i32 s56, s41, 384
    v_add_u32 v185, s56, v203
    s_lshl_b32 s56, s59, 6
    s_add_u32 s56, s56, 512
    v_add_u32 v200, s56, v0
    v_mul_u32_u24 v201, 2731, v200
    v_lshrrev_b32 v201, 16, v201
    v_mul_u32_u24 v202, 24, v201
    v_sub_u32 v202, v200, v202
    v_and_b32 v203, 0x13, v201
    v_bfe_u32 v204, v201, 2, 1
    v_lshl_or_b32 v203, v204, 3, v203
    v_bfe_u32 v204, v201, 3, 1
    v_lshl_or_b32 v203, v204, 2, v203
    v_mul_u32_u24 v203, 3456, v203
    v_and_b32 v204, 6, v201
    v_xor_b32 v204, v204, v202
    v_lshl_add_u32 v203, v204, 4, v203
    s_mul_i32 s56, s41, 384
    v_add_u32 v186, s56, v203
    s_waitcnt lgkmcnt(0)
    s_mov_b32 s20, s4
    s_mov_b32 s21, s5
    s_mov_b32 s22, 2621440
    s_mov_b32 s23, 0x20000
    s_mov_b32 s24, s12
    s_mov_b32 s25, s13
    s_mov_b32 s26, 2211840
    s_mov_b32 s27, 0x20000
    s_mov_b32 s32, s14
    s_mov_b32 s33, s15
    s_mov_b32 s34, 2211840
    s_mov_b32 s35, 0x20000
    s_cmp_ge_u32 s3, 4
    s_cbranch_scc1 L_k1_F_bpro
    s_add_u32 m0, s47, 0
    s_nop 0
    buffer_load_dwordx4 v190, s[20:23], s46 offen lds
    s_add_u32 m0, s47, 4096
    s_nop 0
    buffer_load_dwordx4 v191, s[20:23], s46 offen lds
    s_add_u32 s47, s47, 8192
    s_add_u32 s46, s46, 81920
    s_add_u32 m0, s48, 0
    s_nop 0
    buffer_load_dwordx4 v184, s[24:27], s44 offen lds
    s_add_u32 m0, s48, 4096
    s_nop 0
    buffer_load_dwordx4 v185, s[24:27], s44 offen lds
    s_add_u32 m0, s48, 8192
    s_nop 0
    buffer_load_dwordx4 v186, s[24:27], s44 offen lds
    s_add_u32 m0, s48, 12288
    s_nop 0
    buffer_load_dwordx4 v184, s[32:35], s44 offen lds
    s_add_u32 m0, s48, 16384
    s_nop 0
    buffer_load_dwordx4 v185, s[32:35], s44 offen lds
    s_add_u32 m0, s48, 20480
    s_nop 0
    buffer_load_dwordx4 v186, s[32:35], s44 offen lds
    s_add_u32 s44, s44, 110592
    s_cmp_eq_u32 s44, 2211840
    s_cselect_b32 s44, 0, s44
    s_add_u32 m0, s47, 0
    s_nop 0
    buffer_load_dwordx4 v190, s[20:23], s46 offen lds
    s_add_u32 m0, s47, 4096
    s_nop 0
    buffer_load_dwordx4 v191, s[20:23], s46 offen lds
    s_add_u32 s47, s47, 8192
    s_sub_u32 s46, s46, 81792
    s_cmp_ge_u32 s47, 147456
    s_cselect_b32 s47, s49, s47
    s_cmp_eq_u32 s46, 1280
    s_cselect_b32 s46, 0, s46
    s_add_u32 m0, s48, 24576
    s_nop 0
    buffer_load_dwordx4 v184, s[24:27], s44 offen lds
    s_add_u32 m0, s48, 28672
    s_nop 0
    buffer_load_dwordx4 v185, s[24:27], s44 offen lds
    s_add_u32 m0, s48, 32768
    s_nop 0
    buffer_load_dwordx4 v186, s[24:27], s44 offen lds
    s_add_u32 m0, s48, 36864
    s_nop 0
    buffer_load_dwordx4 v184, s[32:35], s44 offen lds
    s_add_u32 m0, s48, 40960
    s_nop 0
    buffer_load_dwordx4 v185, s[32:35], s44 offen lds
    s_add_u32 m0, s48, 45056
    s_nop 0
    buffer_load_dwordx4 v186, s[32:35], s44 offen lds
    s_add_u32 m0, s47, 0
    s_nop 0
    buffer_load_dwordx4 v190, s[20:23], s46 offen lds
    s_add_u32 m0, s47, 4096
    s_nop 0
    buffer_load_dwordx4 v191, s[20:23], s46 offen lds
    s_add_u32 s44, s44, 110592
    s_cmp_eq_u32 s44, 2211840
    s_cselect_b32 s44, 0, s44
    s_add_u32 s44, s44, 110592
    s_cmp_eq_u32 s44, 2211840
    s_cselect_b32 s44, 0, s44
    s_add_u32 s44, s44, 110592
    s_cmp_eq_u32 s44, 2211840
    s_cselect_b32 s44, 0, s44
    s_add_u32 s47, s47, 8192
    s_add_u32 s46, s46, 81920
    s_add_u32 s47, s47, 8192
    s_sub_u32 s46, s46, 81792
    s_cmp_ge_u32 s47, 147456
    s_cselect_b32 s47, s49, s47
    s_cmp_eq_u32 s46, 1280
    s_cselect_b32 s46, 0, s46
    s_add_u32 s47, s47, 8192
    s_add_u32 s46, s46, 81920
L_k1_F_bpro:
L_k1_F_common:
    s_mov_b32 s36, s16
    s_mov_b32 s37, s17
    s_mov_b32 s38, 33554432
    s_mov_b32 s39, 0x20000
    s_mov_b32 s28, s18
    s_mov_b32 s29, s19
    s_mov_b32 s30, 256
    s_mov_b32 s31, 0x20000
    s_and_b32 s71, s3, 3
    s_lshl_b32 s72, s67, 2
    s_add_u32 s71, s71, s72
    s_lshr_b32 s72, s71, 3
    s_and_b32 s73, s71, 7
    s_mov_b32 s66, s73
    s_mul_i32 s64, s73, 21504
    s_lshl_b32 s65, s72, 8
    s_add_u32 s64, s64, s65
    s_add_u32 s64, s64, 16334848
    s_cmp_lt_u32 s72, 57
    s_cselect_b32 s76, s12, s14
    s_cselect_b32 s77, s13, s15
    s_cselect_b32 s62, 30, 57
    s_mov_b32 s78, 2211840
    s_movk_i32 s63, 3456
    s_cmp_lt_u32 s72, 30
    s_cselect_b32 s76, s6, s76
    s_cselect_b32 s77, s7, s77
    s_cselect_b32 s62, 0, s62
    s_cselect_b32 s78, 2457600, s78
    s_cselect_b32 s63, 3840, s63
    s_mov_b32 s79, 0x20000
    s_sub_u32 s72, s72, s62
    s_lshl_b32 s72, s72, 7
    s_mul_i32 s73, s73, 80
    s_mul_i32 s73, s73, s63
    s_add_u32 s72, s72, s73
    s_lshl_b32 s73, s63, 3
    s_cmp_ge_u32 s71, 672
    s_cselect_b32 s72, 2146435072, s72
    v_lshrrev_b32 v2, 3, v0
    v_and_b32 v3, 7, v0
    v_mul_u32_u24 v1, s63, v2
    v_lshl_add_u32 v1, v3, 4, v1
    v_and_b32 v2, 15, v0
    v_and_b32 v3, 1, v0
    v_lshlrev_b32 v3, 4, v3
    v_mov_b32 v4, 0x3f80
    v_lshlrev_b32 v3, v3, v4
    v_lshrrev_b32 v2, 1, v2
    v_cmp_eq_u32 vcc, 0, v2
    s_nop 1
    v_cndmask_b32 v4, 0, v3, vcc
    v_cmp_eq_u32 vcc, 1, v2
    s_nop 1
    v_cndmask_b32 v5, 0, v3, vcc
    v_cmp_eq_u32 vcc, 2, v2
    s_nop 1
    v_cndmask_b32 v6, 0, v3, vcc
    v_cmp_eq_u32 vcc, 3, v2
    s_nop 1
    v_cndmask_b32 v7, 0, v3, vcc
    s_cmp_ge_u32 s71, 672
    s_cselect_b32 s71, 2146435072, s64
    v_bfe_u32 v2, v0, 4, 1
    v_lshlrev_b32 v2, 7, v2
    v_and_b32 v3, 7, v0
    v_lshl_add_u32 v2, v3, 2, v2
    s_lshl_b32 s95, s41, 2
    s_add_u32 s95, s95, s40
    s_add_u32 s95, s95, 16252928
    s_mov_b32 s75, 0
    v_and_b32 v200, 15, v0
    v_lshrrev_b32 v201, 4, v0
    v_lshrrev_b32 v202, 1, v200
    v_xor_b32 v202, v202, v201
    s_lshl_b32 s56, s42, 13
    v_lshlrev_b32 v203, 7, v200
    v_add_u32 v203, s56, v203
    v_lshl_add_u32 v192, v202, 4, v203
    v_xor_b32 v193, 64, v192
    v_lshrrev_b32 v202, 5, v0
    v_lshlrev_b32 v202, 4, v202
    v_bfe_u32 v203, v0, 4, 1
    v_lshl_or_b32 v202, v203, 2, v202
    v_bfe_u32 v203, v0, 2, 2
    v_or_b32 v202, v202, v203
    v_mul_u32_u24 v203, 384, v202
    v_and_b32 v204, 3, v0
    v_lshl_add_u32 v203, v204, 3, v203
    v_bfe_u32 v202, v202, 1, 2
    s_mul_i32 s56, s43, 3
    s_add_u32 s57, s56, 0
    v_xor_b32 v204, s57, v202
    v_lshl_add_u32 v194, v204, 5, v203
    s_add_u32 s57, s56, 1
    v_xor_b32 v204, s57, v202
    v_lshl_add_u32 v195, v204, 5, v203
    s_add_u32 s57, s56, 2
    v_xor_b32 v204, s57, v202
    v_lshl_add_u32 v196, v204, 5, v203
    v_mov_b32 v8, 0
    v_mov_b32 v9, 0
    v_mov_b32 v10, 0
    v_mov_b32 v11, 0
    v_mov_b32 v12, 0
    v_mov_b32 v13, 0
    v_mov_b32 v14, 0
    v_mov_b32 v15, 0
    v_mov_b32 v16, 0
    v_mov_b32 v17, 0
    v_mov_b32 v18, 0
    v_mov_b32 v19, 0
    v_mov_b32 v20, 0
    v_mov_b32 v21, 0
    v_mov_b32 v22, 0
    v_mov_b32 v23, 0
    v_mov_b32 v24, 0
    v_mov_b32 v25, 0
    v_mov_b32 v26, 0
    v_mov_b32 v27, 0
    v_mov_b32 v28, 0
    v_mov_b32 v29, 0
    v_mov_b32 v30, 0
    v_mov_b32 v31, 0
    v_mov_b32 v32, 0
    v_mov_b32 v33, 0
    v_mov_b32 v34, 0
    v_mov_b32 v35, 0
    v_mov_b32 v36, 0
    v_mov_b32 v37, 0
    v_mov_b32 v38, 0
    v_mov_b32 v39, 0
    v_mov_b32 v40, 0
    v_mov_b32 v41, 0
    v_mov_b32 v42, 0
    v_mov_b32 v43, 0
    v_mov_b32 v44, 0
    v_mov_b32 v45, 0
    v_mov_b32 v46, 0
    v_mov_b32 v47, 0
    v_mov_b32 v48, 0
    v_mov_b32 v49, 0
    v_mov_b32 v50, 0
    v_mov_b32 v51, 0
    v_mov_b32 v52, 0
    v_mov_b32 v53, 0
    v_mov_b32 v54, 0
    v_mov_b32 v55, 0
    v_mov_b32 v56, 0
    v_mov_b32 v57, 0
    v_mov_b32 v58, 0
    v_mov_b32 v59, 0
    v_mov_b32 v60, 0
    v_mov_b32 v61, 0
    v_mov_b32 v62, 0
    v_mov_b32 v63, 0
    v_mov_b32 v64, 0
    v_mov_b32 v65, 0
    v_mov_b32 v66, 0
    v_mov_b32 v67, 0
    v_mov_b32 v68, 0
    v_mov_b32 v69, 0
    v_mov_b32 v70, 0
    v_mov_b32 v71, 0
    v_mov_b32 v72, 0
    v_mov_b32 v73, 0
    v_mov_b32 v74, 0
    v_mov_b32 v75, 0
    v_mov_b32 v76, 0
    v_mov_b32 v77, 0
    v_mov_b32 v78, 0
    v_mov_b32 v79, 0
    v_mov_b32 v80, 0
    v_mov_b32 v81, 0
    v_mov_b32 v82, 0
    v_mov_b32 v83, 0
    v_mov_b32 v84, 0
    v_mov_b32 v85, 0
    v_mov_b32 v86, 0
    v_mov_b32 v87, 0
    v_mov_b32 v88, 0
    v_mov_b32 v89, 0
    v_mov_b32 v90, 0
    v_mov_b32 v91, 0
    v_mov_b32 v92, 0
    v_mov_b32 v93, 0
    v_mov_b32 v94, 0
    v_mov_b32 v95, 0
    v_mov_b32 v96, 0
    v_mov_b32 v97, 0
    v_mov_b32 v98, 0
    v_mov_b32 v99, 0
    v_mov_b32 v100, 0
    v_mov_b32 v101, 0
    v_mov_b32 v102, 0
    v_mov_b32 v103, 0
    v_lshlrev_b32 v200, 4, v0
    s_lshl_b32 s56, s59, 10
    s_add_u32 s56, s56, 147456
    v_add_u32 v201, s56, v200
    v_and_b32 v202, 15, v0
    v_lshlrev_b32 v202, 2, v202
    v_and_b32 v205, 7, v0
    v_lshlrev_b32 v205, 5, v205
    s_movk_i32 s69, 21504
    s_cmp_lt_u32 s59, 2
    s_cselect_b32 s69, 268304384, s69
    s_lshl_b32 s68, s40, 2
    s_add_u32 s68, s68, 16318464
    s_add_u32 s56, s68, 8192
    s_cmp_eq_u32 s59, 1
    s_cselect_b32 s68, s56, s68
    s_mul_i32 s56, s41, 768
    s_add_u32 s57, s56, 16342528
    s_cmp_eq_u32 s59, 2
    s_cselect_b32 s68, s57, s68
    s_add_u32 s57, s56, 16349440
    s_cmp_eq_u32 s59, 3
    s_cselect_b32 s68, s57, s68
    s_mov_b32 s52, 0
    s_mov_b32 s53, 98304
    s_mov_b32 s54, 0
    s_mov_b32 s74, 49152
    s_cmp_ge_u32 s3, 4
    s_cbranch_scc1 L_k1_F_pre1
L_k1_F_pre0:
    s_waitcnt vmcnt(0)
    s_barrier
    v_add_u32 v197, s53, v192
    ds_read_b128 v[104:107], v197 offset:0
    ds_read_b128 v[108:111], v197 offset:2048
    ds_read_b128 v[112:115], v197 offset:4096
    ds_read_b128 v[116:119], v197 offset:6144
    ds_read_b64_tr_b16 v[136:137], v194 offset:0
    ds_read_b64_tr_b16 v[138:139], v194 offset:3072
    ds_read_b64_tr_b16 v[140:141], v194 offset:12288
    ds_read_b64_tr_b16 v[142:143], v194 offset:15360
    ds_read_b64_tr_b16 v[144:145], v195 offset:0
    ds_read_b64_tr_b16 v[146:147], v195 offset:3072
    ds_read_b64_tr_b16 v[148:149], v195 offset:12288
    ds_read_b64_tr_b16 v[150:151], v195 offset:15360
    ds_read_b64_tr_b16 v[152:153], v196 offset:0
    ds_read_b64_tr_b16 v[154:155], v196 offset:3072
    ds_read_b64_tr_b16 v[156:157], v196 offset:12288
    ds_read_b64_tr_b16 v[158:159], v196 offset:15360
.p2align 3
L_k1_F_loop0:
    s_waitcnt lgkmcnt(10)
    v_mfma_f32_16x16x32_bf16 v[8:11], v[136:139], v[104:107], v[8:11]
    v_mfma_f32_16x16x32_bf16 v[12:15], v[136:139], v[108:111], v[12:15]
    s_cmp_eq_u32 s54, 8
    s_cselect_b32 s44, 2146435072, s44
    v_mfma_f32_16x16x32_bf16 v[16:19], v[136:139], v[112:115], v[16:19]
    v_mfma_f32_16x16x32_bf16 v[20:23], v[136:139], v[116:119], v[20:23]
    s_waitcnt lgkmcnt(8)
    v_mfma_f32_16x16x32_bf16 v[24:27], v[140:143], v[104:107], v[24:27]
    v_mfma_f32_16x16x32_bf16 v[28:31], v[140:143], v[108:111], v[28:31]
    v_mfma_f32_16x16x32_bf16 v[32:35], v[140:143], v[112:115], v[32:35]
    v_mfma_f32_16x16x32_bf16 v[36:39], v[140:143], v[116:119], v[36:39]
    s_waitcnt lgkmcnt(0) vmcnt(16)
    s_barrier
    v_add_u32 v197, s53, v193
    v_mfma_f32_16x16x32_bf16 v[40:43], v[144:147], v[104:107], v[40:43]
    ds_read_b128 v[120:123], v197 offset:0
    ds_read_b128 v[124:127], v197 offset:2048
    v_mfma_f32_16x16x32_bf16 v[44:47], v[144:147], v[108:111], v[44:47]
    ds_read_b128 v[128:131], v197 offset:4096
    ds_read_b128 v[132:135], v197 offset:6144
    v_mfma_f32_16x16x32_bf16 v[48:51], v[144:147], v[112:115], v[48:51]
    ds_read_b64_tr_b16 v[160:161], v194 offset:24576
    ds_read_b64_tr_b16 v[162:163], v194 offset:27648
    v_mfma_f32_16x16x32_bf16 v[52:55], v[144:147], v[116:119], v[52:55]
    ds_read_b64_tr_b16 v[164:165], v194 offset:36864
    ds_read_b64_tr_b16 v[166:167], v194 offset:39936
    v_mfma_f32_16x16x32_bf16 v[56:59], v[148:151], v[104:107], v[56:59]
    ds_read_b64_tr_b16 v[168:169], v195 offset:24576
    v_mfma_f32_16x16x32_bf16 v[60:63], v[148:151], v[108:111], v[60:63]
    ds_read_b64_tr_b16 v[170:171], v195 offset:27648
    v_mfma_f32_16x16x32_bf16 v[64:67], v[148:151], v[112:115], v[64:67]
    ds_read_b64_tr_b16 v[172:173], v195 offset:36864
    s_add_u32 m0, s45, 0
    v_mfma_f32_16x16x32_bf16 v[68:71], v[148:151], v[116:119], v[68:71]
    buffer_load_dwordx4 v184, s[24:27], s44 offen lds
    ds_read_b64_tr_b16 v[174:175], v195 offset:39936
    s_add_u32 m0, s45, 4096
    v_mfma_f32_16x16x32_bf16 v[72:75], v[152:155], v[104:107], v[72:75]
    buffer_load_dwordx4 v185, s[24:27], s44 offen lds
    ds_read_b64_tr_b16 v[176:177], v196 offset:24576
    s_add_u32 m0, s45, 8192
    v_mfma_f32_16x16x32_bf16 v[76:79], v[152:155], v[108:111], v[76:79]
    buffer_load_dwordx4 v186, s[24:27], s44 offen lds
    ds_read_b64_tr_b16 v[178:179], v196 offset:27648
    s_add_u32 m0, s45, 12288
    v_mfma_f32_16x16x32_bf16 v[80:83], v[152:155], v[112:115], v[80:83]
    buffer_load_dwordx4 v184, s[32:35], s44 offen lds
    ds_read_b64_tr_b16 v[180:181], v196 offset:36864
    s_add_u32 m0, s45, 16384
    v_mfma_f32_16x16x32_bf16 v[84:87], v[152:155], v[116:119], v[84:87]
    buffer_load_dwordx4 v185, s[32:35], s44 offen lds
    ds_read_b64_tr_b16 v[182:183], v196 offset:39936
    s_add_u32 m0, s45, 20480
    v_mfma_f32_16x16x32_bf16 v[88:91], v[156:159], v[104:107], v[88:91]
    buffer_load_dwordx4 v186, s[32:35], s44 offen lds
    s_add_u32 m0, s47, 0
    v_mfma_f32_16x16x32_bf16 v[92:95], v[156:159], v[108:111], v[92:95]
    buffer_load_dwordx4 v190, s[20:23], s46 offen lds
    s_add_u32 m0, s47, 4096
    v_mfma_f32_16x16x32_bf16 v[96:99], v[156:159], v[112:115], v[96:99]
    buffer_load_dwordx4 v191, s[20:23], s46 offen lds
    s_add_u32 s53, s53, 16384
    s_cmp_eq_u32 s53, 147456
    s_cselect_b32 s53, 98304, s53
    v_mfma_f32_16x16x32_bf16 v[100:103], v[156:159], v[116:119], v[100:103]
    s_add_u32 s44, s44, 110592
    s_cmp_eq_u32 s44, 2211840
    s_cselect_b32 s44, 0, s44
    s_add_u32 s47, s47, 8192
    s_sub_u32 s46, s46, 81792
    s_cmp_ge_u32 s47, 147456
    s_cselect_b32 s47, s49, s47
    s_cmp_eq_u32 s46, 1280
    s_cselect_b32 s46, 0, s46
    s_cmp_eq_u32 s54, 7
    s_cselect_b32 s46, 2146435072, s46
    s_waitcnt lgkmcnt(10)
    v_mfma_f32_16x16x32_bf16 v[8:11], v[160:163], v[120:123], v[8:11]
    v_mfma_f32_16x16x32_bf16 v[12:15], v[160:163], v[124:127], v[12:15]
    v_mfma_f32_16x16x32_bf16 v[16:19], v[160:163], v[128:131], v[16:19]
    v_mfma_f32_16x16x32_bf16 v[20:23], v[160:163], v[132:135], v[20:23]
    s_waitcnt lgkmcnt(8)
    v_mfma_f32_16x16x32_bf16 v[24:27], v[164:167], v[120:123], v[24:27]
    v_mfma_f32_16x16x32_bf16 v[28:31], v[164:167], v[124:127], v[28:31]
    v_mfma_f32_16x16x32_bf16 v[32:35], v[164:167], v[128:131], v[32:35]
    v_mfma_f32_16x16x32_bf16 v[36:39], v[164:167], v[132:135], v[36:39]
    s_waitcnt lgkmcnt(0) vmcnt(16)
    s_barrier
    v_add_u32 v197, s53, v192
    v_add_u32 v194, s74, v194
    v_add_u32 v195, s74, v195
    v_add_u32 v196, s74, v196
    v_mfma_f32_16x16x32_bf16 v[40:43], v[168:171], v[120:123], v[40:43]
    ds_read_b128 v[104:107], v197 offset:0
    ds_read_b128 v[108:111], v197 offset:2048
    v_mfma_f32_16x16x32_bf16 v[44:47], v[168:171], v[124:127], v[44:47]
    ds_read_b128 v[112:115], v197 offset:4096
    ds_read_b128 v[116:119], v197 offset:6144
    v_mfma_f32_16x16x32_bf16 v[48:51], v[168:171], v[128:131], v[48:51]
    ds_read_b64_tr_b16 v[136:137], v194 offset:0
    ds_read_b64_tr_b16 v[138:139], v194 offset:3072
    v_mfma_f32_16x16x32_bf16 v[52:55], v[168:171], v[132:135], v[52:55]
    ds_read_b64_tr_b16 v[140:141], v194 offset:12288
    ds_read_b64_tr_b16 v[142:143], v194 offset:15360
    v_mfma_f32_16x16x32_bf16 v[56:59], v[172:175], v[120:123], v[56:59]
    ds_read_b64_tr_b16 v[144:145], v195 offset:0
    v_mfma_f32_16x16x32_bf16 v[60:63], v[172:175], v[124:127], v[60:63]
    ds_read_b64_tr_b16 v[146:147], v195 offset:3072
    v_mfma_f32_16x16x32_bf16 v[64:67], v[172:175], v[128:131], v[64:67]
    ds_read_b64_tr_b16 v[148:149], v195 offset:12288
    s_add_u32 m0, s45, 24576
    v_mfma_f32_16x16x32_bf16 v[68:71], v[172:175], v[132:135], v[68:71]
    buffer_load_dwordx4 v184, s[24:27], s44 offen lds
    ds_read_b64_tr_b16 v[150:151], v195 offset:15360
    s_add_u32 m0, s45, 28672
    v_mfma_f32_16x16x32_bf16 v[72:75], v[176:179], v[120:123], v[72:75]
    buffer_load_dwordx4 v185, s[24:27], s44 offen lds
    ds_read_b64_tr_b16 v[152:153], v196 offset:0
    s_add_u32 m0, s45, 32768
    v_mfma_f32_16x16x32_bf16 v[76:79], v[176:179], v[124:127], v[76:79]
    buffer_load_dwordx4 v186, s[24:27], s44 offen lds
    ds_read_b64_tr_b16 v[154:155], v196 offset:3072
    s_add_u32 m0, s45, 36864
    v_mfma_f32_16x16x32_bf16 v[80:83], v[176:179], v[128:131], v[80:83]
    buffer_load_dwordx4 v184, s[32:35], s44 offen lds
    ds_read_b64_tr_b16 v[156:157], v196 offset:12288
    s_add_u32 m0, s45, 40960
    v_mfma_f32_16x16x32_bf16 v[84:87], v[176:179], v[132:135], v[84:87]
    buffer_load_dwordx4 v185, s[32:35], s44 offen lds
    ds_read_b64_tr_b16 v[158:159], v196 offset:15360
    s_add_u32 m0, s45, 45056
    v_mfma_f32_16x16x32_bf16 v[88:91], v[180:183], v[120:123], v[88:91]
    buffer_load_dwordx4 v186, s[32:35], s44 offen lds
    s_add_u32 m0, s47, 0
    v_mfma_f32_16x16x32_bf16 v[92:95], v[180:183], v[124:127], v[92:95]
    buffer_load_dwordx4 v190, s[20:23], s46 offen lds
    s_add_u32 m0, s47, 4096
    v_mfma_f32_16x16x32_bf16 v[96:99], v[180:183], v[128:131], v[96:99]
    buffer_load_dwordx4 v191, s[20:23], s46 offen lds
    s_add_u32 s44, s44, 110592
    s_cmp_eq_u32 s44, 2211840
    s_cselect_b32 s44, 0, s44
    v_mfma_f32_16x16x32_bf16 v[100:103], v[180:183], v[132:135], v[100:103]
    s_add_u32 s47, s47, 8192
    s_add_u32 s46, s46, 81920
    s_add_u32 s45, s45, s74
    s_sub_u32 s74, 0, s74
    s_add_u32 s54, s54, 1
    s_cmp_lt_u32 s54, 10
    s_cbranch_scc1 L_k1_F_loop0
    s_branch L_k1_F_epi
L_k1_F_pre1:
    s_add_u32 s44, s44, 110592
    s_cmp_eq_u32 s44, 2211840
    s_cselect_b32 s44, 0, s44
    s_add_u32 s44, s44, 110592
    s_cmp_eq_u32 s44, 2211840
    s_cselect_b32 s44, 0, s44
    s_add_u32 s47, s47, 8192
    s_add_u32 s46, s46, 81920
    s_add_u32 s47, s47, 8192
    s_sub_u32 s46, s46, 81792
    s_cmp_ge_u32 s47, 147456
    s_cselect_b32 s47, s49, s47
    s_cmp_eq_u32 s46, 1280
    s_cselect_b32 s46, 0, s46
    s_add_u32 s47, s47, 8192
    s_add_u32 s46, s46, 81920
    s_add_u32 m0, s48, 49152
    s_nop 0
    buffer_load_dwordx4 v184, s[24:27], s44 offen lds
    s_add_u32 m0, s48, 53248
    s_nop 0
    buffer_load_dwordx4 v185, s[24:27], s44 offen lds
    s_add_u32 m0, s48, 57344
    s_nop 0
    buffer_load_dwordx4 v186, s[24:27], s44 offen lds
    s_add_u32 m0, s48, 61440
    s_nop 0
    buffer_load_dwordx4 v184, s[32:35], s44 offen lds
    s_add_u32 m0, s48, 65536
    s_nop 0
    buffer_load_dwordx4 v185, s[32:35], s44 offen lds
    s_add_u32 m0, s48, 69632
    s_nop 0
    buffer_load_dwordx4 v186, s[32:35], s44 offen lds
    s_add_u32 s44, s44, 110592
    s_cmp_eq_u32 s44, 2211840
    s_cselect_b32 s44, 0, s44
    s_add_u32 m0, s47, 0
    s_nop 0
    buffer_load_dwordx4 v190, s[20:23], s46 offen lds
    s_add_u32 m0, s47, 4096
    s_nop 0
    buffer_load_dwordx4 v191, s[20:23], s46 offen lds
    s_add_u32 s47, s47, 8192
    s_sub_u32 s46, s46, 81792
    s_cmp_ge_u32 s47, 147456
    s_cselect_b32 s47, s49, s47
    s_cmp_eq_u32 s46, 1280
    s_cselect_b32 s46, 0, s46
    s_barrier
    v_add_u32 v197, s53, v192
    ds_read_b128 v[104:107], v197 offset:0
    ds_read_b128 v[108:111], v197 offset:2048
    ds_read_b128 v[112:115], v197 offset:4096
    ds_read_b128 v[116:119], v197 offset:6144
    ds_read_b64_tr_b16 v[136:137], v194 offset:0
    ds_read_b64_tr_b16 v[138:139], v194 offset:3072
    ds_read_b64_tr_b16 v[140:141], v194 offset:12288
    ds_read_b64_tr_b16 v[142:143], v194 offset:15360
    ds_read_b64_tr_b16 v[144:145], v195 offset:0
    ds_read_b64_tr_b16 v[146:147], v195 offset:3072
    ds_read_b64_tr_b16 v[148:149], v195 offset:12288
    ds_read_b64_tr_b16 v[150:151], v195 offset:15360
    ds_read_b64_tr_b16 v[152:153], v196 offset:0
    ds_read_b64_tr_b16 v[154:155], v196 offset:3072
    ds_read_b64_tr_b16 v[156:157], v196 offset:12288
    ds_read_b64_tr_b16 v[158:159], v196 offset:15360
    s_add_u32 m0, s48, 73728
    s_nop 0
    buffer_load_dwordx4 v184, s[24:27], s44 offen lds
    s_add_u32 m0, s48, 77824
    s_nop 0
    buffer_load_dwordx4 v185, s[24:27], s44 offen lds
    s_add_u32 m0, s48, 81920
    s_nop 0
    buffer_load_dwordx4 v186, s[24:27], s44 offen lds
    s_add_u32 m0, s48, 86016
    s_nop 0
    buffer_load_dwordx4 v184, s[32:35], s44 offen lds
    s_add_u32 m0, s48, 90112
    s_nop 0
    buffer_load_dwordx4 v185, s[32:35], s44 offen lds
    s_add_u32 m0, s48, 94208
    s_nop 0
    buffer_load_dwordx4 v186, s[32:35], s44 offen lds
    s_add_u32 m0, s47, 0
    s_nop 0
    buffer_load_dwordx4 v190, s[20:23], s46 offen lds
    s_add_u32 m0, s47, 4096
    s_nop 0
    buffer_load_dwordx4 v191, s[20:23], s46 offen lds
    s_cmp_lt_u32 s66, 5
    s_cbranch_scc0 L_ax_1
    buffer_load_dwordx4 v[212:215], v1, s[76:79], s72 offen
    s_add_u32 s72, s72, s73
    buffer_load_dwordx4 v[216:219], v1, s[76:79], s72 offen
    s_add_u32 s72, s72, s73
    buffer_load_dwordx4 v[220:223], v1, s[76:79], s72 offen
    s_add_u32 s72, s72, s73
    buffer_load_dwordx4 v[224:227], v1, s[76:79], s72 offen
    s_add_u32 s72, s72, s73
    buffer_load_dwordx4 v[228:231], v1, s[76:79], s72 offen
    s_add_u32 s72, s72, s73
    buffer_load_dwordx4 v[232:235], v1, s[76:79], s72 offen
    s_add_u32 s72, s72, s73
    buffer_load_dwordx4 v[236:239], v1, s[76:79], s72 offen
    s_add_u32 s72, s72, s73
    buffer_load_dwordx4 v[240:243], v1, s[76:79], s72 offen
    s_add_u32 s72, s72, s73
    buffer_load_dwordx4 v[184:187], v1, s[76:79], s72 offen
    s_add_u32 s72, s72, s73
    buffer_load_dwordx4 v[188:191], v1, s[76:79], s72 offen
L_ax_1:
.p2align 3
L_k1_F_loop1:
    s_waitcnt lgkmcnt(10)
    v_mfma_f32_16x16x32_bf16 v[8:11], v[136:139], v[104:107], v[8:11]
    v_mfma_f32_16x16x32_bf16 v[12:15], v[136:139], v[108:111], v[12:15]
    v_mfma_f32_16x16x32_bf16 v[16:19], v[136:139], v[112:115], v[16:19]
    v_mfma_f32_16x16x32_bf16 v[20:23], v[136:139], v[116:119], v[20:23]
    s_waitcnt lgkmcnt(8)
    v_mfma_f32_16x16x32_bf16 v[24:27], v[140:143], v[104:107], v[24:27]
    v_mfma_f32_16x16x32_bf16 v[28:31], v[140:143], v[108:111], v[28:31]
    v_mfma_f32_16x16x32_bf16 v[32:35], v[140:143], v[112:115], v[32:35]
    v_mfma_f32_16x16x32_bf16 v[36:39], v[140:143], v[116:119], v[36:39]
    s_waitcnt lgkmcnt(0)
    s_barrier
    v_add_u32 v197, s53, v193
    v_mfma_f32_16x16x32_bf16 v[40:43], v[144:147], v[104:107], v[40:43]
    ds_read_b128 v[120:123], v197 offset:0
    ds_read_b128 v[124:127], v197 offset:2048
    v_mfma_f32_16x16x32_bf16 v[44:47], v[144:147], v[108:111], v[44:47]
    ds_read_b128 v[128:131], v197 offset:4096
    ds_read_b128 v[132:135], v197 offset:6144
    v_mfma_f32_16x16x32_bf16 v[48:51], v[144:147], v[112:115], v[48:51]
    ds_read_b64_tr_b16 v[160:161], v194 offset:24576
    ds_read_b64_tr_b16 v[162:163], v194 offset:27648
    v_mfma_f32_16x16x32_bf16 v[52:55], v[144:147], v[116:119], v[52:55]
    ds_read_b64_tr_b16 v[164:165], v194 offset:36864
    ds_read_b64_tr_b16 v[166:167], v194 offset:39936
    v_mfma_f32_16x16x32_bf16 v[56:59], v[148:151], v[104:107], v[56:59]
    ds_read_b64_tr_b16 v[168:169], v195 offset:24576
    v_mfma_f32_16x16x32_bf16 v[60:63], v[148:151], v[108:111], v[60:63]
    ds_read_b64_tr_b16 v[170:171], v195 offset:27648
    v_mfma_f32_16x16x32_bf16 v[64:67], v[148:151], v[112:115], v[64:67]
    ds_read_b64_tr_b16 v[172:173], v195 offset:36864
    v_mfma_f32_16x16x32_bf16 v[68:71], v[148:151], v[116:119], v[68:71]
    ds_read_b64_tr_b16 v[174:175], v195 offset:39936
    v_mfma_f32_16x16x32_bf16 v[72:75], v[152:155], v[104:107], v[72:75]
    ds_read_b64_tr_b16 v[176:177], v196 offset:24576
    v_mfma_f32_16x16x32_bf16 v[76:79], v[152:155], v[108:111], v[76:79]
    ds_read_b64_tr_b16 v[178:179], v196 offset:27648
    v_mfma_f32_16x16x32_bf16 v[80:83], v[152:155], v[112:115], v[80:83]
    ds_read_b64_tr_b16 v[180:181], v196 offset:36864
    v_mfma_f32_16x16x32_bf16 v[84:87], v[152:155], v[116:119], v[84:87]
    ds_read_b64_tr_b16 v[182:183], v196 offset:39936
    v_mfma_f32_16x16x32_bf16 v[88:91], v[156:159], v[104:107], v[88:91]
    s_bitcmp1_b32 791, s54
    s_cbranch_scc1 L_k1_F_ev0
L_k1_F_evr0:
    v_mfma_f32_16x16x32_bf16 v[92:95], v[156:159], v[108:111], v[92:95]
    s_add_u32 s53, s53, 16384
    s_cmp_eq_u32 s53, 147456
    s_cselect_b32 s53, 98304, s53
    v_mfma_f32_16x16x32_bf16 v[96:99], v[156:159], v[112:115], v[96:99]
    v_mfma_f32_16x16x32_bf16 v[100:103], v[156:159], v[116:119], v[100:103]
    s_waitcnt lgkmcnt(10)
    v_mfma_f32_16x16x32_bf16 v[8:11], v[160:163], v[120:123], v[8:11]
    v_mfma_f32_16x16x32_bf16 v[12:15], v[160:163], v[124:127], v[12:15]
    v_mfma_f32_16x16x32_bf16 v[16:19], v[160:163], v[128:131], v[16:19]
    v_mfma_f32_16x16x32_bf16 v[20:23], v[160:163], v[132:135], v[20:23]
    s_waitcnt lgkmcnt(8)
    v_mfma_f32_16x16x32_bf16 v[24:27], v[164:167], v[120:123], v[24:27]
    v_mfma_f32_16x16x32_bf16 v[28:31], v[164:167], v[124:127], v[28:31]
    v_mfma_f32_16x16x32_bf16 v[32:35], v[164:167], v[128:131], v[32:35]
    v_mfma_f32_16x16x32_bf16 v[36:39], v[164:167], v[132:135], v[36:39]
    s_waitcnt lgkmcnt(0)
    s_barrier
    v_add_u32 v197, s53, v192
    v_add_u32 v194, s74, v194
    v_add_u32 v195, s74, v195
    v_add_u32 v196, s74, v196
    v_mfma_f32_16x16x32_bf16 v[40:43], v[168:171], v[120:123], v[40:43]
    ds_read_b128 v[104:107], v197 offset:0
    ds_read_b128 v[108:111], v197 offset:2048
    v_mfma_f32_16x16x32_bf16 v[44:47], v[168:171], v[124:127], v[44:47]
    ds_read_b128 v[112:115], v197 offset:4096
    ds_read_b128 v[116:119], v197 offset:6144
    v_mfma_f32_16x16x32_bf16 v[48:51], v[168:171], v[128:131], v[48:51]
    ds_read_b64_tr_b16 v[136:137], v194 offset:0
    ds_read_b64_tr_b16 v[138:139], v194 offset:3072
    v_mfma_f32_16x16x32_bf16 v[52:55], v[168:171], v[132:135], v[52:55]
    ds_read_b64_tr_b16 v[140:141], v194 offset:12288
    ds_read_b64_tr_b16 v[142:143], v194 offset:15360
    v_mfma_f32_16x16x32_bf16 v[56:59], v[172:175], v[120:123], v[56:59]
    ds_read_b64_tr_b16 v[144:145], v195 offset:0
    v_mfma_f32_16x16x32_bf16 v[60:63], v[172:175], v[124:127], v[60:63]
    ds_read_b64_tr_b16 v[146:147], v195 offset:3072
    v_mfma_f32_16x16x32_bf16 v[64:67], v[172:175], v[128:131], v[64:67]
    ds_read_b64_tr_b16 v[148:149], v195 offset:12288
    v_mfma_f32_16x16x32_bf16 v[68:71], v[172:175], v[132:135], v[68:71]
    ds_read_b64_tr_b16 v[150:151], v195 offset:15360
    v_mfma_f32_16x16x32_bf16 v[72:75], v[176:179], v[120:123], v[72:75]
    ds_read_b64_tr_b16 v[152:153], v196 offset:0
    v_mfma_f32_16x16x32_bf16 v[76:79], v[176:179], v[124:127], v[76:79]
    ds_read_b64_tr_b16 v[154:155], v196 offset:3072
    v_mfma_f32_16x16x32_bf16 v[80:83], v[176:179], v[128:131], v[80:83]
    ds_read_b64_tr_b16 v[156:157], v196 offset:12288
    v_mfma_f32_16x16x32_bf16 v[84:87], v[176:179], v[132:135], v[84:87]
    ds_read_b64_tr_b16 v[158:159], v196 offset:15360
    v_mfma_f32_16x16x32_bf16 v[88:91], v[180:183], v[120:123], v[88:91]
    s_bitcmp1_b32 77, s54
    s_cbranch_scc1 L_k1_F_ev1
L_k1_F_evr1:
    v_mfma_f32_16x16x32_bf16 v[92:95], v[180:183], v[124:127], v[92:95]
    s_sub_u32 s74, 0, s74
    s_add_u32 s54, s54, 1
    v_mfma_f32_16x16x32_bf16 v[96:99], v[180:183], v[128:131], v[96:99]
    v_mfma_f32_16x16x32_bf16 v[100:103], v[180:183], v[132:135], v[100:103]
    s_cmp_lt_u32 s54, 10
    s_cbranch_scc1 L_k1_F_loop1
    s_branch L_k1_F_epi
L_k1_F_ev0:
    s_cmp_eq_u32 s54, 0
    s_cbranch_scc1 L_ev_2
    s_cmp_eq_u32 s54, 1
    s_cbranch_scc1 L_ev_3
    s_cmp_eq_u32 s54, 2
    s_cbranch_scc1 L_ev_4
    s_cmp_eq_u32 s54, 4
    s_cbranch_scc1 L_ev_5
    s_cmp_eq_u32 s54, 8
    s_cbranch_scc1 L_ev_6
    s_waitcnt vmcnt(0)
    v_add_f32 v212, v212, v216
    v_add_f32 v212, v212, v220
    v_add_f32 v212, v212, v224
    v_add_f32 v212, v212, v228
    v_add_f32 v212, v212, v232
    v_add_f32 v212, v212, v236
    v_add_f32 v212, v212, v240
    v_add_f32 v213, v213, v217
    v_add_f32 v213, v213, v221
    v_add_f32 v213, v213, v225
    v_add_f32 v213, v213, v229
    v_add_f32 v213, v213, v233
    v_add_f32 v213, v213, v237
    v_add_f32 v213, v213, v241
    v_add_f32 v214, v214, v218
    v_add_f32 v214, v214, v222
    v_add_f32 v214, v214, v226
    v_add_f32 v214, v214, v230
    v_add_f32 v214, v214, v234
    v_add_f32 v214, v214, v238
    v_add_f32 v214, v214, v242
    v_add_f32 v215, v215, v219
    v_add_f32 v215, v215, v223
    v_add_f32 v215, v215, v227
    v_add_f32 v215, v215, v231
    v_add_f32 v215, v215, v235
    v_add_f32 v215, v215, v239
    v_add_f32 v215, v215, v243
    ds_write_b128 v201, v[212:215]
    s_branch L_k1_F_evr0
L_ev_2:
    s_waitcnt vmcnt(8)
    s_branch L_k1_F_evr0
L_ev_3:
    s_cmp_lt_u32 s66, 5
    s_cbranch_scc1 L_ax_8
    buffer_load_dwordx4 v[212:215], v1, s[76:79], s72 offen
    s_add_u32 s72, s72, s73
    buffer_load_dwordx4 v[216:219], v1, s[76:79], s72 offen
    s_add_u32 s72, s72, s73
    buffer_load_dwordx4 v[220:223], v1, s[76:79], s72 offen
    s_add_u32 s72, s72, s73
    buffer_load_dwordx4 v[224:227], v1, s[76:79], s72 offen
    s_add_u32 s72, s72, s73
    buffer_load_dwordx4 v[228:231], v1, s[76:79], s72 offen
    s_add_u32 s72, s72, s73
    buffer_load_dwordx4 v[232:235], v1, s[76:79], s72 offen
    s_add_u32 s72, s72, s73
    buffer_load_dwordx4 v[236:239], v1, s[76:79], s72 offen
    s_add_u32 s72, s72, s73
    buffer_load_dwordx4 v[240:243], v1, s[76:79], s72 offen
    s_add_u32 s72, s72, s73
    buffer_load_dwordx4 v[184:187], v1, s[76:79], s72 offen
    s_add_u32 s72, s72, s73
    buffer_load_dwordx4 v[188:191], v1, s[76:79], s72 offen
L_ax_8:
    s_branch L_k1_F_evr0
L_ev_4:
    s_waitcnt vmcnt(0)
    v_mfma_f32_16x16x32_bf16 v[208:211], v[212:215], v[4:7], 0
    v_mfma_f32_16x16x32_bf16 v[208:211], v[216:219], v[4:7], v[208:211]
    v_mfma_f32_16x16x32_bf16 v[208:211], v[220:223], v[4:7], v[208:211]
    v_mfma_f32_16x16x32_bf16 v[208:211], v[224:227], v[4:7], v[208:211]
    v_mfma_f32_16x16x32_bf16 v[208:211], v[228:231], v[4:7], v[208:211]
    v_mfma_f32_16x16x32_bf16 v[208:211], v[232:235], v[4:7], v[208:211]
    v_mfma_f32_16x16x32_bf16 v[208:211], v[236:239], v[4:7], v[208:211]
    v_mfma_f32_16x16x32_bf16 v[208:211], v[240:243], v[4:7], v[208:211]
    v_mfma_f32_16x16x32_bf16 v[208:211], v[184:187], v[4:7], v[208:211]
    v_mfma_f32_16x16x32_bf16 v[208:211], v[188:191], v[4:7], v[208:211]
    s_branch L_k1_F_evr0
L_ev_5:
    s_cmp_eq_u32 s3, 4
    s_cbranch_scc0 L_ar_9
    s_and_b32 s56, s2, 7
    s_lshl_b32 s56, s56, 5
    v_mov_b32 v184, 1
    v_mov_b32 v185, 0
    s_mov_b64 exec, 1
    buffer_atomic_add v184, v185, s[28:31], s56 offen sc1
    s_mov_b64 exec, -1
L_ar_9:
    s_branch L_k1_F_evr0
L_ev_6:
    s_mov_b32 s56, 0
L_sp_10:
    s_waitcnt vmcnt(0)
    v_cmp_ne_u32 vcc, 32, v184
    s_add_u32 s56, s56, 1
    s_nop 2
    s_cmp_eq_u64 vcc, 0
    s_cbranch_scc1 L_sp_10b
    s_cmp_gt_u32 s56, 0x8000
    s_cbranch_scc1 L_sp_10b
    s_sleep 1
    buffer_load_dword v184, v205, s[28:31], 0 offen sc1
    s_branch L_sp_10
L_sp_10b:
    buffer_load_dwordx4 v[212:215], v200, s[36:39], s68 offen sc1
    s_add_u32 s68, s68, s69
    buffer_load_dwordx4 v[216:219], v200, s[36:39], s68 offen sc1
    s_add_u32 s68, s68, s69
    buffer_load_dwordx4 v[220:223], v200, s[36:39], s68 offen sc1
    s_add_u32 s68, s68, s69
    buffer_load_dwordx4 v[224:227], v200, s[36:39], s68 offen sc1
    s_add_u32 s68, s68, s69
    buffer_load_dwordx4 v[228:231], v200, s[36:39], s68 offen sc1
    s_add_u32 s68, s68, s69
    buffer_load_dwordx4 v[232:235], v200, s[36:39], s68 offen sc1
    s_add_u32 s68, s68, s69
    buffer_load_dwordx4 v[236:239], v200, s[36:39], s68 offen sc1
    s_add_u32 s68, s68, s69
    buffer_load_dwordx4 v[240:243], v200, s[36:39], s68 offen sc1
    s_branch L_k1_F_evr0
L_k1_F_ev1:
    s_cmp_eq_u32 s54, 0
    s_cbranch_scc1 L_ev_11
    s_cmp_eq_u32 s54, 2
    s_cbranch_scc1 L_ev_12
    s_cmp_eq_u32 s54, 3
    s_cbranch_scc1 L_ev_13
    buffer_load_dword v184, v205, s[28:31], 0 offen sc1
    s_branch L_k1_F_evr1
L_ev_11:
    s_cmp_lt_u32 s66, 5
    s_cbranch_scc1 L_g1_15
    s_waitcnt vmcnt(0)
    s_branch L_g1_16
L_g1_15:
    s_waitcnt vmcnt(10)
L_g1_16:
    s_branch L_k1_F_evr1
L_ev_12:
    v_mov_b32 v212, v208
    v_mov_b32 v213, v209
    v_mov_b32 v214, v210
    v_mov_b32 v215, v211
    s_nop 1
    v_permlane32_swap_b32 v208, v212
    v_permlane32_swap_b32 v209, v213
    v_permlane32_swap_b32 v210, v214
    v_permlane32_swap_b32 v211, v215
    v_add_f32 v208, v208, v212
    v_add_f32 v209, v209, v213
    v_add_f32 v210, v210, v214
    v_add_f32 v211, v211, v215
    s_mov_b64 exec, 0x00ff00ff
    buffer_store_dword v208, v2, s[36:39], s71 offen offset:0 sc1
    buffer_store_dword v209, v2, s[36:39], s71 offen offset:32 sc1
    buffer_store_dword v210, v2, s[36:39], s71 offen offset:64 sc1
    buffer_store_dword v211, v2, s[36:39], s71 offen offset:96 sc1
    s_mov_b64 exec, -1
    s_cmp_eq_u32 s3, 5
    s_cbranch_scc0 L_fl_17
    v_mov_b32 v220, 0
    v_mov_b32 v221, 0
    s_mov_b64 exec, 1
    s_and_b32 s56, s2, 7
    s_lshl_b32 s56, s56, 9
    s_bfe_u32 s57, s2, 0x20003
    s_lshl_b32 s57, s57, 7
    s_add_u32 s56, s56, s57
    s_lshr_b32 s57, s2, 5
    s_lshl_b32 s57, s57, 2
    s_add_u32 s56, s56, s57
    s_add_u32 s56, s56, 16257024
    buffer_store_dword v220, v221, s[36:39], s56 offen sc1
    s_mov_b64 exec, -1
L_fl_17:
    s_cmp_eq_u32 s3, 4
    s_cbranch_scc0 L_fl_18
    v_mov_b32 v220, 0
    v_mov_b32 v221, 0
    s_mov_b64 exec, 1
    buffer_store_dword v220, v221, s[36:39], s95 offen sc1
    s_mov_b64 exec, -1
L_fl_18:
    s_branch L_k1_F_evr1
L_ev_13:
    s_waitcnt vmcnt(0)
    s_branch L_k1_F_evr1
.p2align 3
L_k1_F_epi:
    s_waitcnt lgkmcnt(0)
    v_lshrrev_b32 v203, 4, v0
    v_lshlrev_b32 v204, 4, v203
    s_lshl_b32 s56, s42, 8
    s_add_u32 s56, s56, 147456
    v_add_u32 v201, s56, v202
    ds_read_b32 v104, v201 offset:0
    ds_read_b32 v120, v201 offset:1024
    ds_read_b32 v108, v201 offset:64
    ds_read_b32 v124, v201 offset:1088
    ds_read_b32 v112, v201 offset:128
    ds_read_b32 v128, v201 offset:1152
    ds_read_b32 v116, v201 offset:192
    ds_read_b32 v132, v201 offset:1216
    s_mul_i32 s56, s43, 192
    s_add_u32 s56, s56, 149504
    v_add_u32 v201, s56, v204
    ds_read_b128 v[136:139], v201 offset:0
    ds_read_b128 v[140:143], v201 offset:1024
    ds_read_b128 v[144:147], v201 offset:64
    ds_read_b128 v[148:151], v201 offset:1088
    ds_read_b128 v[152:155], v201 offset:128
    ds_read_b128 v[156:159], v201 offset:1152
    s_lshr_b32 s56, s40, 4
    s_lshl_b32 s57, s42, 2
    s_add_u32 s56, s56, s57
    s_mul_i32 s56, s56, 54
    s_lshl_b32 s57, s41, 2
    s_add_u32 s57, s57, s56
    s_add_u32 s57, s57, s43
    s_lshl_b32 s57, s57, 10
    v_add_u32 v201, s57, v200
    s_and_b32 s57, s43, 1
    s_mul_i32 s57, s57, 54
    s_add_u32 s56, s56, s57
    s_lshl_b32 s57, s41, 1
    s_add_u32 s56, s56, s57
    s_lshr_b32 s57, s43, 1
    s_add_u32 s56, s56, s57
    s_add_u32 s56, s56, 36
    s_lshl_b32 s56, s56, 10
    v_add_u32 v202, s56, v200
    s_waitcnt lgkmcnt(0)
    v_mul_f32 v120, v120, v120
    v_pk_fma_f32 v[8:9], v[136:137], v[104:105], v[8:9] op_sel_hi:[1,0,1]
    v_pk_fma_f32 v[24:25], v[140:141], v[104:105], v[24:25] op_sel_hi:[1,0,1]
    v_pk_fma_f32 v[10:11], v[138:139], v[104:105], v[10:11] op_sel_hi:[1,0,1]
    v_pk_fma_f32 v[26:27], v[142:143], v[104:105], v[26:27] op_sel_hi:[1,0,1]
    v_max_f32 v8, 0, v8
    v_max_f32 v9, 0, v9
    v_max_f32 v10, 0, v10
    v_max_f32 v11, 0, v11
    v_pk_mul_f32 v[24:25], v[24:25], v[120:121] op_sel_hi:[1,0]
    v_pk_mul_f32 v[26:27], v[26:27], v[120:121] op_sel_hi:[1,0]
    v_pk_mul_f32 v[8:9], v[8:9], v[24:25]
    v_pk_mul_f32 v[10:11], v[10:11], v[26:27]
    v_cvt_pk_bf16_f32 v160, v8, v9
    v_cvt_pk_bf16_f32 v161, v10, v11
    v_pk_fma_f32 v[40:41], v[144:145], v[104:105], v[40:41] op_sel_hi:[1,0,1]
    v_pk_fma_f32 v[56:57], v[148:149], v[104:105], v[56:57] op_sel_hi:[1,0,1]
    v_pk_fma_f32 v[42:43], v[146:147], v[104:105], v[42:43] op_sel_hi:[1,0,1]
    v_pk_fma_f32 v[58:59], v[150:151], v[104:105], v[58:59] op_sel_hi:[1,0,1]
    v_max_f32 v40, 0, v40
    v_max_f32 v41, 0, v41
    v_max_f32 v42, 0, v42
    v_max_f32 v43, 0, v43
    v_pk_mul_f32 v[56:57], v[56:57], v[120:121] op_sel_hi:[1,0]
    v_pk_mul_f32 v[58:59], v[58:59], v[120:121] op_sel_hi:[1,0]
    v_pk_mul_f32 v[40:41], v[40:41], v[56:57]
    v_pk_mul_f32 v[42:43], v[42:43], v[58:59]
    v_cvt_pk_bf16_f32 v162, v40, v41
    v_cvt_pk_bf16_f32 v163, v42, v43
    v_pk_fma_f32 v[72:73], v[152:153], v[104:105], v[72:73] op_sel_hi:[1,0,1]
    v_pk_fma_f32 v[88:89], v[156:157], v[104:105], v[88:89] op_sel_hi:[1,0,1]
    v_pk_fma_f32 v[74:75], v[154:155], v[104:105], v[74:75] op_sel_hi:[1,0,1]
    v_pk_fma_f32 v[90:91], v[158:159], v[104:105], v[90:91] op_sel_hi:[1,0,1]
    v_max_f32 v72, 0, v72
    v_max_f32 v73, 0, v73
    v_max_f32 v74, 0, v74
    v_max_f32 v75, 0, v75
    v_pk_mul_f32 v[88:89], v[88:89], v[120:121] op_sel_hi:[1,0]
    v_pk_mul_f32 v[90:91], v[90:91], v[120:121] op_sel_hi:[1,0]
    v_pk_mul_f32 v[72:73], v[72:73], v[88:89]
    v_pk_mul_f32 v[74:75], v[74:75], v[90:91]
    v_cvt_pk_bf16_f32 v168, v72, v73
    v_cvt_pk_bf16_f32 v169, v74, v75
    s_mov_b32 s56, 0
    buffer_store_dwordx4 v[160:163], v201, s[36:39], s56 offen sc1
    v_mul_f32 v124, v124, v124
    v_pk_fma_f32 v[12:13], v[136:137], v[108:109], v[12:13] op_sel_hi:[1,0,1]
    v_pk_fma_f32 v[28:29], v[140:141], v[108:109], v[28:29] op_sel_hi:[1,0,1]
    v_pk_fma_f32 v[14:15], v[138:139], v[108:109], v[14:15] op_sel_hi:[1,0,1]
    v_pk_fma_f32 v[30:31], v[142:143], v[108:109], v[30:31] op_sel_hi:[1,0,1]
    v_max_f32 v12, 0, v12
    v_max_f32 v13, 0, v13
    v_max_f32 v14, 0, v14
    v_max_f32 v15, 0, v15
    v_pk_mul_f32 v[28:29], v[28:29], v[124:125] op_sel_hi:[1,0]
    v_pk_mul_f32 v[30:31], v[30:31], v[124:125] op_sel_hi:[1,0]
    v_pk_mul_f32 v[12:13], v[12:13], v[28:29]
    v_pk_mul_f32 v[14:15], v[14:15], v[30:31]
    v_cvt_pk_bf16_f32 v164, v12, v13
    v_cvt_pk_bf16_f32 v165, v14, v15
    v_pk_fma_f32 v[44:45], v[144:145], v[108:109], v[44:45] op_sel_hi:[1,0,1]
    v_pk_fma_f32 v[60:61], v[148:149], v[108:109], v[60:61] op_sel_hi:[1,0,1]
    v_pk_fma_f32 v[46:47], v[146:147], v[108:109], v[46:47] op_sel_hi:[1,0,1]
    v_pk_fma_f32 v[62:63], v[150:151], v[108:109], v[62:63] op_sel_hi:[1,0,1]
    v_max_f32 v44, 0, v44
    v_max_f32 v45, 0, v45
    v_max_f32 v46, 0, v46
    v_max_f32 v47, 0, v47
    v_pk_mul_f32 v[60:61], v[60:61], v[124:125] op_sel_hi:[1,0]
    v_pk_mul_f32 v[62:63], v[62:63], v[124:125] op_sel_hi:[1,0]
    v_pk_mul_f32 v[44:45], v[44:45], v[60:61]
    v_pk_mul_f32 v[46:47], v[46:47], v[62:63]
    v_cvt_pk_bf16_f32 v166, v44, v45
    v_cvt_pk_bf16_f32 v167, v46, v47
    v_pk_fma_f32 v[76:77], v[152:153], v[108:109], v[76:77] op_sel_hi:[1,0,1]
    v_pk_fma_f32 v[92:93], v[156:157], v[108:109], v[92:93] op_sel_hi:[1,0,1]
    v_pk_fma_f32 v[78:79], v[154:155], v[108:109], v[78:79] op_sel_hi:[1,0,1]
    v_pk_fma_f32 v[94:95], v[158:159], v[108:109], v[94:95] op_sel_hi:[1,0,1]
    v_max_f32 v76, 0, v76
    v_max_f32 v77, 0, v77
    v_max_f32 v78, 0, v78
    v_max_f32 v79, 0, v79
    v_pk_mul_f32 v[92:93], v[92:93], v[124:125] op_sel_hi:[1,0]
    v_pk_mul_f32 v[94:95], v[94:95], v[124:125] op_sel_hi:[1,0]
    v_pk_mul_f32 v[76:77], v[76:77], v[92:93]
    v_pk_mul_f32 v[78:79], v[78:79], v[94:95]
    v_cvt_pk_bf16_f32 v170, v76, v77
    v_cvt_pk_bf16_f32 v171, v78, v79
    s_mov_b32 s56, 55296
    buffer_store_dwordx4 v[164:167], v201, s[36:39], s56 offen sc1
    s_mov_b32 s57, 0
    buffer_store_dwordx4 v[168:171], v202, s[36:39], s57 offen sc1
    v_mul_f32 v128, v128, v128
    v_pk_fma_f32 v[16:17], v[136:137], v[112:113], v[16:17] op_sel_hi:[1,0,1]
    v_pk_fma_f32 v[32:33], v[140:141], v[112:113], v[32:33] op_sel_hi:[1,0,1]
    v_pk_fma_f32 v[18:19], v[138:139], v[112:113], v[18:19] op_sel_hi:[1,0,1]
    v_pk_fma_f32 v[34:35], v[142:143], v[112:113], v[34:35] op_sel_hi:[1,0,1]
    v_max_f32 v16, 0, v16
    v_max_f32 v17, 0, v17
    v_max_f32 v18, 0, v18
    v_max_f32 v19, 0, v19
    v_pk_mul_f32 v[32:33], v[32:33], v[128:129] op_sel_hi:[1,0]
    v_pk_mul_f32 v[34:35], v[34:35], v[128:129] op_sel_hi:[1,0]
    v_pk_mul_f32 v[16:17], v[16:17], v[32:33]
    v_pk_mul_f32 v[18:19], v[18:19], v[34:35]
    v_cvt_pk_bf16_f32 v160, v16, v17
    v_cvt_pk_bf16_f32 v161, v18, v19
    v_pk_fma_f32 v[48:49], v[144:145], v[112:113], v[48:49] op_sel_hi:[1,0,1]
    v_pk_fma_f32 v[64:65], v[148:149], v[112:113], v[64:65] op_sel_hi:[1,0,1]
    v_pk_fma_f32 v[50:51], v[146:147], v[112:113], v[50:51] op_sel_hi:[1,0,1]
    v_pk_fma_f32 v[66:67], v[150:151], v[112:113], v[66:67] op_sel_hi:[1,0,1]
    v_max_f32 v48, 0, v48
    v_max_f32 v49, 0, v49
    v_max_f32 v50, 0, v50
    v_max_f32 v51, 0, v51
    v_pk_mul_f32 v[64:65], v[64:65], v[128:129] op_sel_hi:[1,0]
    v_pk_mul_f32 v[66:67], v[66:67], v[128:129] op_sel_hi:[1,0]
    v_pk_mul_f32 v[48:49], v[48:49], v[64:65]
    v_pk_mul_f32 v[50:51], v[50:51], v[66:67]
    v_cvt_pk_bf16_f32 v162, v48, v49
    v_cvt_pk_bf16_f32 v163, v50, v51
    v_pk_fma_f32 v[80:81], v[152:153], v[112:113], v[80:81] op_sel_hi:[1,0,1]
    v_pk_fma_f32 v[96:97], v[156:157], v[112:113], v[96:97] op_sel_hi:[1,0,1]
    v_pk_fma_f32 v[82:83], v[154:155], v[112:113], v[82:83] op_sel_hi:[1,0,1]
    v_pk_fma_f32 v[98:99], v[158:159], v[112:113], v[98:99] op_sel_hi:[1,0,1]
    v_max_f32 v80, 0, v80
    v_max_f32 v81, 0, v81
    v_max_f32 v82, 0, v82
    v_max_f32 v83, 0, v83
    v_pk_mul_f32 v[96:97], v[96:97], v[128:129] op_sel_hi:[1,0]
    v_pk_mul_f32 v[98:99], v[98:99], v[128:129] op_sel_hi:[1,0]
    v_pk_mul_f32 v[80:81], v[80:81], v[96:97]
    v_pk_mul_f32 v[82:83], v[82:83], v[98:99]
    v_cvt_pk_bf16_f32 v172, v80, v81
    v_cvt_pk_bf16_f32 v173, v82, v83
    s_mov_b32 s56, 110592
    buffer_store_dwordx4 v[160:163], v201, s[36:39], s56 offen sc1
    v_mul_f32 v132, v132, v132
    v_pk_fma_f32 v[20:21], v[136:137], v[116:117], v[20:21] op_sel_hi:[1,0,1]
    v_pk_fma_f32 v[36:37], v[140:141], v[116:117], v[36:37] op_sel_hi:[1,0,1]
    v_pk_fma_f32 v[22:23], v[138:139], v[116:117], v[22:23] op_sel_hi:[1,0,1]
    v_pk_fma_f32 v[38:39], v[142:143], v[116:117], v[38:39] op_sel_hi:[1,0,1]
    v_max_f32 v20, 0, v20
    v_max_f32 v21, 0, v21
    v_max_f32 v22, 0, v22
    v_max_f32 v23, 0, v23
    v_pk_mul_f32 v[36:37], v[36:37], v[132:133] op_sel_hi:[1,0]
    v_pk_mul_f32 v[38:39], v[38:39], v[132:133] op_sel_hi:[1,0]
    v_pk_mul_f32 v[20:21], v[20:21], v[36:37]
    v_pk_mul_f32 v[22:23], v[22:23], v[38:39]
    v_cvt_pk_bf16_f32 v164, v20, v21
    v_cvt_pk_bf16_f32 v165, v22, v23
    v_pk_fma_f32 v[52:53], v[144:145], v[116:117], v[52:53] op_sel_hi:[1,0,1]
    v_pk_fma_f32 v[68:69], v[148:149], v[116:117], v[68:69] op_sel_hi:[1,0,1]
    v_pk_fma_f32 v[54:55], v[146:147], v[116:117], v[54:55] op_sel_hi:[1,0,1]
    v_pk_fma_f32 v[70:71], v[150:151], v[116:117], v[70:71] op_sel_hi:[1,0,1]
    v_max_f32 v52, 0, v52
    v_max_f32 v53, 0, v53
    v_max_f32 v54, 0, v54
    v_max_f32 v55, 0, v55
    v_pk_mul_f32 v[68:69], v[68:69], v[132:133] op_sel_hi:[1,0]
    v_pk_mul_f32 v[70:71], v[70:71], v[132:133] op_sel_hi:[1,0]
    v_pk_mul_f32 v[52:53], v[52:53], v[68:69]
    v_pk_mul_f32 v[54:55], v[54:55], v[70:71]
    v_cvt_pk_bf16_f32 v166, v52, v53
    v_cvt_pk_bf16_f32 v167, v54, v55
    v_pk_fma_f32 v[84:85], v[152:153], v[116:117], v[84:85] op_sel_hi:[1,0,1]
    v_pk_fma_f32 v[100:101], v[156:157], v[116:117], v[100:101] op_sel_hi:[1,0,1]
    v_pk_fma_f32 v[86:87], v[154:155], v[116:117], v[86:87] op_sel_hi:[1,0,1]
    v_pk_fma_f32 v[102:103], v[158:159], v[116:117], v[102:103] op_sel_hi:[1,0,1]
    v_max_f32 v84, 0, v84
    v_max_f32 v85, 0, v85
    v_max_f32 v86, 0, v86
    v_max_f32 v87, 0, v87
    v_pk_mul_f32 v[100:101], v[100:101], v[132:133] op_sel_hi:[1,0]
    v_pk_mul_f32 v[102:103], v[102:103], v[132:133] op_sel_hi:[1,0]
    v_pk_mul_f32 v[84:85], v[84:85], v[100:101]
    v_pk_mul_f32 v[86:87], v[86:87], v[102:103]
    v_cvt_pk_bf16_f32 v174, v84, v85
    v_cvt_pk_bf16_f32 v175, v86, v87
    s_mov_b32 s56, 165888
    buffer_store_dwordx4 v[164:167], v201, s[36:39], s56 offen sc1
    s_mov_b32 s57, 110592
    buffer_store_dwordx4 v[172:175], v202, s[36:39], s57 offen sc1
    s_branch L_k1_done
L_k1_Q:
    s_and_b32 s59, s3, 3
    s_mov_b32 s43, s59
    s_lshr_b32 s42, s3, 2
    s_lshl_b32 s56, s59, 3
    s_add_u32 s56, s56, s40
    v_lshrrev_b32 v200, 3, v0
    v_add_u32 v200, s56, v200
    v_mul_u32_u24 v200, 1280, v200
    s_and_b32 s56, s3, 1
    s_lshl_b32 s56, s56, 2
    v_lshrrev_b32 v201, 4, v0
    v_add_u32 v201, s56, v201
    v_xor_b32 v201, v201, v0
    v_and_b32 v201, 7, v201
    v_lshl_add_u32 v190, v201, 4, v200
    v_add_u32 v191, 40960, v190
    s_lshl_b32 s48, s59, 10
    s_add_u32 s49, s48, 98304
    s_mul_i32 s44, s70, 245760
    s_mov_b32 s45, s48
    s_lshl_b32 s46, s70, 7
    s_mov_b32 s47, s49
    s_lshl_b32 s56, s59, 6
    s_add_u32 s56, s56, 0
    v_add_u32 v200, s56, v0
    v_mul_u32_u24 v201, 1561, v200
    v_lshrrev_b32 v201, 16, v201
    v_mul_u32_u24 v202, 42, v201
    v_sub_u32 v202, v200, v202
    v_and_b32 v203, 0x13, v201
    v_bfe_u32 v204, v201, 2, 1
    v_lshl_or_b32 v203, v204, 3, v203
    v_bfe_u32 v204, v201, 3, 1
    v_lshl_or_b32 v203, v204, 2, v203
    v_mul_u32_u24 v203, 3840, v203
    v_lshl_add_u32 v203, v202, 4, v203
    s_mul_i32 s56, s41, 640
    v_add_u32 v203, s56, v203
    v_cmp_gt_u32 vcc, 40, v202
    v_cmp_gt_u32 s[60:61], 32, v201
    v_mov_b32 v204, 2146435072
    s_and_b64 vcc, vcc, s[60:61]
    v_cndmask_b32 v184, v204, v203, vcc
    s_lshl_b32 s56, s59, 6
    s_add_u32 s56, s56, 256
    v_add_u32 v200, s56, v0
    v_mul_u32_u24 v201, 1561, v200
    v_lshrrev_b32 v201, 16, v201
    v_mul_u32_u24 v202, 42, v201
    v_sub_u32 v202, v200, v202
    v_and_b32 v203, 0x13, v201
    v_bfe_u32 v204, v201, 2, 1
    v_lshl_or_b32 v203, v204, 3, v203
    v_bfe_u32 v204, v201, 3, 1
    v_lshl_or_b32 v203, v204, 2, v203
    v_mul_u32_u24 v203, 3840, v203
    v_lshl_add_u32 v203, v202, 4, v203
    s_mul_i32 s56, s41, 640
    v_add_u32 v203, s56, v203
    v_cmp_gt_u32 vcc, 40, v202
    v_cmp_gt_u32 s[60:61], 32, v201
    v_mov_b32 v204, 2146435072
    s_and_b64 vcc, vcc, s[60:61]
    v_cndmask_b32 v185, v204, v203, vcc
    s_lshl_b32 s56, s59, 6
    s_add_u32 s56, s56, 512
    v_add_u32 v200, s56, v0
    v_mul_u32_u24 v201, 1561, v200
    v_lshrrev_b32 v201, 16, v201
    v_mul_u32_u24 v202, 42, v201
    v_sub_u32 v202, v200, v202
    v_and_b32 v203, 0x13, v201
    v_bfe_u32 v204, v201, 2, 1
    v_lshl_or_b32 v203, v204, 3, v203
    v_bfe_u32 v204, v201, 3, 1
    v_lshl_or_b32 v203, v204, 2, v203
    v_mul_u32_u24 v203, 3840, v203
    v_lshl_add_u32 v203, v202, 4, v203
    s_mul_i32 s56, s41, 640
    v_add_u32 v203, s56, v203
    v_cmp_gt_u32 vcc, 40, v202
    v_cmp_gt_u32 s[60:61], 32, v201
    v_mov_b32 v204, 2146435072
    s_and_b64 vcc, vcc, s[60:61]
    v_cndmask_b32 v186, v204, v203, vcc
    s_lshl_b32 s56, s59, 6
    s_add_u32 s56, s56, 768
    v_add_u32 v200, s56, v0
    v_mul_u32_u24 v201, 1561, v200
    v_lshrrev_b32 v201, 16, v201
    v_mul_u32_u24 v202, 42, v201
    v_sub_u32 v202, v200, v202
    v_and_b32 v203, 0x13, v201
    v_bfe_u32 v204, v201, 2, 1
    v_lshl_or_b32 v203, v204, 3, v203
    v_bfe_u32 v204, v201, 3, 1
    v_lshl_or_b32 v203, v204, 2, v203
    v_mul_u32_u24 v203, 3840, v203
    v_lshl_add_u32 v203, v202, 4, v203
    s_mul_i32 s56, s41, 640
    v_add_u32 v203, s56, v203
    v_cmp_gt_u32 vcc, 40, v202
    v_cmp_gt_u32 s[60:61], 32, v201
    v_mov_b32 v204, 2146435072
    s_and_b64 vcc, vcc, s[60:61]
    v_cndmask_b32 v187, v204, v203, vcc
    s_lshl_b32 s56, s59, 6
    s_add_u32 s56, s56, 1024
    v_add_u32 v200, s56, v0
    v_mul_u32_u24 v201, 1561, v200
    v_lshrrev_b32 v201, 16, v201
    v_mul_u32_u24 v202, 42, v201
    v_sub_u32 v202, v200, v202
    v_and_b32 v203, 0x13, v201
    v_bfe_u32 v204, v201, 2, 1
    v_lshl_or_b32 v203, v204, 3, v203
    v_bfe_u32 v204, v201, 3, 1
    v_lshl_or_b32 v203, v204, 2, v203
    v_mul_u32_u24 v203, 3840, v203
    v_lshl_add_u32 v203, v202, 4, v203
    s_mul_i32 s56, s41, 640
    v_add_u32 v203, s56, v203
    v_cmp_gt_u32 vcc, 40, v202
    v_cmp_gt_u32 s[60:61], 32, v201
    v_mov_b32 v204, 2146435072
    s_and_b64 vcc, vcc, s[60:61]
    v_cndmask_b32 v188, v204, v203, vcc
    s_lshl_b32 s56, s59, 6
    s_add_u32 s56, s56, 1280
    v_add_u32 v200, s56, v0
    v_mul_u32_u24 v201, 1561, v200
    v_lshrrev_b32 v201, 16, v201
    v_mul_u32_u24 v202, 42, v201
    v_sub_u32 v202, v200, v202
    v_and_b32 v203, 0x13, v201
    v_bfe_u32 v204, v201, 2, 1
    v_lshl_or_b32 v203, v204, 3, v203
    v_bfe_u32 v204, v201, 3, 1
    v_lshl_or_b32 v203, v204, 2, v203
    v_mul_u32_u24 v203, 3840, v203
    v_lshl_add_u32 v203, v202, 4, v203
    s_mul_i32 s56, s41, 640
    v_add_u32 v203, s56, v203
    v_cmp_gt_u32 vcc, 40, v202
    v_cmp_gt_u32 s[60:61], 32, v201
    v_mov_b32 v204, 2146435072
    s_and_b64 vcc, vcc, s[60:61]
    v_cndmask_b32 v189, v204, v203, vcc
    s_waitcnt lgkmcnt(0)
    s_mov_b32 s20, s4
    s_mov_b32 s21, s5
    s_mov_b32 s22, 2621440
    s_mov_b32 s23, 0x20000
    s_mov_b32 s24, s6
    s_mov_b32 s25, s7
    s_mov_b32 s26, 2457600
    s_mov_b32 s27, 0x20000
    s_cmp_ge_u32 s3, 4
    s_cbranch_scc1 L_k1_Q_bpro
    s_add_u32 m0, s47, 0
    s_nop 0
    buffer_load_dwordx4 v190, s[20:23], s46 offen lds
    s_add_u32 m0, s47, 4096
    s_nop 0
    buffer_load_dwordx4 v191, s[20:23], s46 offen lds
    s_add_u32 s47, s47, 8192
    s_add_u32 s46, s46, 81920
    s_add_u32 m0, s48, 0
    s_nop 0
    buffer_load_dwordx4 v184, s[24:27], s44 offen lds
    s_add_u32 m0, s48, 4096
    s_nop 0
    buffer_load_dwordx4 v185, s[24:27], s44 offen lds
    s_add_u32 m0, s48, 8192
    s_nop 0
    buffer_load_dwordx4 v186, s[24:27], s44 offen lds
    s_add_u32 m0, s48, 12288
    s_nop 0
    buffer_load_dwordx4 v187, s[24:27], s44 offen lds
    s_add_u32 m0, s48, 16384
    s_nop 0
    buffer_load_dwordx4 v188, s[24:27], s44 offen lds
    s_add_u32 m0, s48, 20480
    s_nop 0
    buffer_load_dwordx4 v189, s[24:27], s44 offen lds
    s_add_u32 s44, s44, 122880
    s_cmp_eq_u32 s44, 2457600
    s_cselect_b32 s44, 0, s44
    s_add_u32 m0, s47, 0
    s_nop 0
    buffer_load_dwordx4 v190, s[20:23], s46 offen lds
    s_add_u32 m0, s47, 4096
    s_nop 0
    buffer_load_dwordx4 v191, s[20:23], s46 offen lds
    s_add_u32 s47, s47, 8192
    s_sub_u32 s46, s46, 81792
    s_cmp_ge_u32 s47, 147456
    s_cselect_b32 s47, s49, s47
    s_cmp_eq_u32 s46, 1280
    s_cselect_b32 s46, 0, s46
    s_add_u32 m0, s48, 24576
    s_nop 0
    buffer_load_dwordx4 v184, s[24:27], s44 offen lds
    s_add_u32 m0, s48, 28672
    s_nop 0
    buffer_load_dwordx4 v185, s[24:27], s44 offen lds
    s_add_u32 m0, s48, 32768
    s_nop 0
    buffer_load_dwordx4 v186, s[24:27], s44 offen lds
    s_add_u32 m0, s48, 36864
    s_nop 0
    buffer_load_dwordx4 v187, s[24:27], s44 offen lds
    s_add_u32 m0, s48, 40960
    s_nop 0
    buffer_load_dwordx4 v188, s[24:27], s44 offen lds
    s_add_u32 m0, s48, 45056
    s_nop 0
    buffer_load_dwordx4 v189, s[24:27], s44 offen lds
    s_add_u32 m0, s47, 0
    s_nop 0
    buffer_load_dwordx4 v190, s[20:23], s46 offen lds
    s_add_u32 m0, s47, 4096
    s_nop 0
    buffer_load_dwordx4 v191, s[20:23], s46 offen lds
    s_add_u32 s44, s44, 122880
    s_cmp_eq_u32 s44, 2457600
    s_cselect_b32 s44, 0, s44
    s_add_u32 s44, s44, 122880
    s_cmp_eq_u32 s44, 2457600
    s_cselect_b32 s44, 0, s44
    s_add_u32 s44, s44, 122880
    s_cmp_eq_u32 s44, 2457600
    s_cselect_b32 s44, 0, s44
    s_add_u32 s47, s47, 8192
    s_add_u32 s46, s46, 81920
    s_add_u32 s47, s47, 8192
    s_sub_u32 s46, s46, 81792
    s_cmp_ge_u32 s47, 147456
    s_cselect_b32 s47, s49, s47
    s_cmp_eq_u32 s46, 1280
    s_cselect_b32 s46, 0, s46
    s_add_u32 s47, s47, 8192
    s_add_u32 s46, s46, 81920
L_k1_Q_bpro:
L_k1_Q_common:
    s_mov_b32 s36, s16
    s_mov_b32 s37, s17
    s_mov_b32 s38, 33554432
    s_mov_b32 s39, 0x20000
    s_mov_b32 s28, s18
    s_mov_b32 s29, s19
    s_mov_b32 s30, 256
    s_mov_b32 s31, 0x20000
    s_and_b32 s71, s3, 3
    s_lshl_b32 s72, s67, 2
    s_add_u32 s71, s71, s72
    s_lshr_b32 s72, s71, 3
    s_and_b32 s73, s71, 7
    s_mov_b32 s66, s73
    s_mul_i32 s64, s73, 21504
    s_lshl_b32 s65, s72, 8
    s_add_u32 s64, s64, s65
    s_add_u32 s64, s64, 16334848
    s_cmp_lt_u32 s72, 57
    s_cselect_b32 s76, s12, s14
    s_cselect_b32 s77, s13, s15
    s_cselect_b32 s62, 30, 57
    s_mov_b32 s78, 2211840
    s_movk_i32 s63, 3456
    s_cmp_lt_u32 s72, 30
    s_cselect_b32 s76, s6, s76
    s_cselect_b32 s77, s7, s77
    s_cselect_b32 s62, 0, s62
    s_cselect_b32 s78, 2457600, s78
    s_cselect_b32 s63, 3840, s63
    s_mov_b32 s79, 0x20000
    s_sub_u32 s72, s72, s62
    s_lshl_b32 s72, s72, 7
    s_mul_i32 s73, s73, 80
    s_mul_i32 s73, s73, s63
    s_add_u32 s72, s72, s73
    s_lshl_b32 s73, s63, 3
    s_cmp_ge_u32 s71, 672
    s_cselect_b32 s72, 2146435072, s72
    v_lshrrev_b32 v2, 3, v0
    v_and_b32 v3, 7, v0
    v_mul_u32_u24 v1, s63, v2
    v_lshl_add_u32 v1, v3, 4, v1
    v_and_b32 v2, 15, v0
    v_and_b32 v3, 1, v0
    v_lshlrev_b32 v3, 4, v3
    v_mov_b32 v4, 0x3f80
    v_lshlrev_b32 v3, v3, v4
    v_lshrrev_b32 v2, 1, v2
    v_cmp_eq_u32 vcc, 0, v2
    s_nop 1
    v_cndmask_b32 v4, 0, v3, vcc
    v_cmp_eq_u32 vcc, 1, v2
    s_nop 1
    v_cndmask_b32 v5, 0, v3, vcc
    v_cmp_eq_u32 vcc, 2, v2
    s_nop 1
    v_cndmask_b32 v6, 0, v3, vcc
    v_cmp_eq_u32 vcc, 3, v2
    s_nop 1
    v_cndmask_b32 v7, 0, v3, vcc
    s_cmp_ge_u32 s71, 672
    s_cselect_b32 s71, 2146435072, s64
    v_bfe_u32 v2, v0, 4, 1
    v_lshlrev_b32 v2, 7, v2
    v_and_b32 v3, 7, v0
    v_lshl_add_u32 v2, v3, 2, v2
    s_lshl_b32 s95, s41, 2
    s_add_u32 s95, s95, s40
    s_add_u32 s95, s95, 16252964
    s_mov_b32 s75, 0
    v_and_b32 v200, 15, v0
    v_lshrrev_b32 v201, 4, v0
    v_lshrrev_b32 v202, 1, v200
    v_xor_b32 v202, v202, v201
    s_lshl_b32 s56, s42, 13
    v_lshlrev_b32 v203, 7, v200
    v_add_u32 v203, s56, v203
    v_lshl_add_u32 v192, v202, 4, v203
    v_xor_b32 v193, 64, v192
    v_lshrrev_b32 v202, 5, v0
    v_lshlrev_b32 v202, 4, v202
    v_bfe_u32 v203, v0, 4, 1
    v_lshl_or_b32 v202, v203, 2, v202
    v_bfe_u32 v203, v0, 2, 2
    v_or_b32 v202, v202, v203
    v_mul_u32_u24 v203, 672, v202
    v_and_b32 v204, 3, v0
    s_mul_i32 s56, s43, 160
    v_add_u32 v203, s56, v203
    v_lshl_add_u32 v194, v204, 3, v203
    v_mul_u32_u24 v204, 40, v204
    v_add_u32 v195, v204, v203
    v_mov_b32 v8, 0
    v_mov_b32 v9, 0
    v_mov_b32 v10, 0
    v_mov_b32 v11, 0
    v_mov_b32 v12, 0
    v_mov_b32 v13, 0
    v_mov_b32 v14, 0
    v_mov_b32 v15, 0
    v_mov_b32 v16, 0
    v_mov_b32 v17, 0
    v_mov_b32 v18, 0
    v_mov_b32 v19, 0
    v_mov_b32 v20, 0
    v_mov_b32 v21, 0
    v_mov_b32 v22, 0
    v_mov_b32 v23, 0
    v_mov_b32 v24, 0
    v_mov_b32 v25, 0
    v_mov_b32 v26, 0
    v_mov_b32 v27, 0
    v_mov_b32 v28, 0
    v_mov_b32 v29, 0
    v_mov_b32 v30, 0
    v_mov_b32 v31, 0
    v_mov_b32 v32, 0
    v_mov_b32 v33, 0
    v_mov_b32 v34, 0
    v_mov_b32 v35, 0
    v_mov_b32 v36, 0
    v_mov_b32 v37, 0
    v_mov_b32 v38, 0
    v_mov_b32 v39, 0
    v_mov_b32 v40, 0
    v_mov_b32 v41, 0
    v_mov_b32 v42, 0
    v_mov_b32 v43, 0
    v_mov_b32 v44, 0
    v_mov_b32 v45, 0
    v_mov_b32 v46, 0
    v_mov_b32 v47, 0
    v_mov_b32 v48, 0
    v_mov_b32 v49, 0
    v_mov_b32 v50, 0
    v_mov_b32 v51, 0
    v_mov_b32 v52, 0
    v_mov_b32 v53, 0
    v_mov_b32 v54, 0
    v_mov_b32 v55, 0
    v_mov_b32 v56, 0
    v_mov_b32 v57, 0
    v_mov_b32 v58, 0
    v_mov_b32 v59, 0
    v_mov_b32 v60, 0
    v_mov_b32 v61, 0
    v_mov_b32 v62, 0
    v_mov_b32 v63, 0
    v_mov_b32 v64, 0
    v_mov_b32 v65, 0
    v_mov_b32 v66, 0
    v_mov_b32 v67, 0
    v_mov_b32 v68, 0
    v_mov_b32 v69, 0
    v_mov_b32 v70, 0
    v_mov_b32 v71, 0
    v_mov_b32 v72, 0
    v_mov_b32 v73, 0
    v_mov_b32 v74, 0
    v_mov_b32 v75, 0
    v_mov_b32 v76, 0
    v_mov_b32 v77, 0
    v_mov_b32 v78, 0
    v_mov_b32 v79, 0
    v_mov_b32 v80, 0
    v_mov_b32 v81, 0
    v_mov_b32 v82, 0
    v_mov_b32 v83, 0
    v_mov_b32 v84, 0
    v_mov_b32 v85, 0
    v_mov_b32 v86, 0
    v_mov_b32 v87, 0
    v_lshlrev_b32 v200, 4, v0
    s_lshl_b32 s56, s59, 10
    s_add_u32 s56, s56, 147456
    v_add_u32 v201, s56, v200
    v_and_b32 v202, 15, v0
    v_lshlrev_b32 v202, 2, v202
    v_and_b32 v205, 7, v0
    v_lshlrev_b32 v205, 5, v205
    s_movk_i32 s69, 21504
    s_cmp_lt_u32 s59, 2
    s_cselect_b32 s69, 268304384, s69
    s_lshl_b32 s68, s40, 2
    s_add_u32 s68, s68, 16318464
    s_add_u32 s56, s68, 8192
    s_cmp_eq_u32 s59, 1
    s_cselect_b32 s68, s56, s68
    s_mul_i32 s56, s41, 1280
    s_add_u32 s57, s56, 16334848
    s_cmp_eq_u32 s59, 2
    s_cselect_b32 s68, s57, s68
    s_add_u32 s57, s56, 16335872
    s_cmp_eq_u32 s59, 3
    s_cselect_b32 s68, s57, s68
    s_mov_b32 s52, 0
    s_mov_b32 s53, 98304
    s_mov_b32 s54, 0
    s_mov_b32 s74, 49152
    s_cmp_ge_u32 s3, 4
    s_cbranch_scc1 L_k1_Q_pre1
L_k1_Q_pre0:
    s_waitcnt vmcnt(0)
    s_barrier
    v_add_u32 v197, s53, v192
    ds_read_b128 v[104:107], v197 offset:0
    ds_read_b128 v[108:111], v197 offset:2048
    ds_read_b128 v[112:115], v197 offset:4096
    ds_read_b128 v[116:119], v197 offset:6144
    ds_read_b64_tr_b16 v[136:137], v194 offset:0
    ds_read_b64_tr_b16 v[138:139], v194 offset:5376
    ds_read_b64_tr_b16 v[140:141], v194 offset:40
    ds_read_b64_tr_b16 v[142:143], v194 offset:5416
    ds_read_b64_tr_b16 v[144:145], v194 offset:80
    ds_read_b64_tr_b16 v[146:147], v194 offset:5456
    ds_read_b64_tr_b16 v[148:149], v194 offset:120
    ds_read_b64_tr_b16 v[150:151], v194 offset:5496
    ds_read_b64_tr_b16 v[152:153], v195 offset:32
    ds_read_b64_tr_b16 v[154:155], v195 offset:5408
.p2align 3
L_k1_Q_loop0:
    s_waitcnt lgkmcnt(8)
    v_mfma_f32_16x16x32_bf16 v[8:11], v[136:139], v[104:107], v[8:11]
    v_mfma_f32_16x16x32_bf16 v[12:15], v[136:139], v[108:111], v[12:15]
    s_cmp_eq_u32 s54, 8
    s_cselect_b32 s44, 2146435072, s44
    v_mfma_f32_16x16x32_bf16 v[16:19], v[136:139], v[112:115], v[16:19]
    v_mfma_f32_16x16x32_bf16 v[20:23], v[136:139], v[116:119], v[20:23]
    s_waitcnt lgkmcnt(6)
    v_mfma_f32_16x16x32_bf16 v[24:27], v[140:143], v[104:107], v[24:27]
    v_mfma_f32_16x16x32_bf16 v[28:31], v[140:143], v[108:111], v[28:31]
    v_mfma_f32_16x16x32_bf16 v[32:35], v[140:143], v[112:115], v[32:35]
    v_mfma_f32_16x16x32_bf16 v[36:39], v[140:143], v[116:119], v[36:39]
    s_waitcnt lgkmcnt(0) vmcnt(16)
    s_barrier
    v_add_u32 v197, s53, v193
    v_mfma_f32_16x16x32_bf16 v[40:43], v[144:147], v[104:107], v[40:43]
    ds_read_b128 v[120:123], v197 offset:0
    ds_read_b128 v[124:127], v197 offset:2048
    v_mfma_f32_16x16x32_bf16 v[44:47], v[144:147], v[108:111], v[44:47]
    ds_read_b128 v[128:131], v197 offset:4096
    ds_read_b128 v[132:135], v197 offset:6144
    v_mfma_f32_16x16x32_bf16 v[48:51], v[144:147], v[112:115], v[48:51]
    ds_read_b64_tr_b16 v[160:161], v194 offset:24576
    ds_read_b64_tr_b16 v[162:163], v194 offset:29952
    s_add_u32 m0, s45, 0
    v_mfma_f32_16x16x32_bf16 v[52:55], v[144:147], v[116:119], v[52:55]
    buffer_load_dwordx4 v184, s[24:27], s44 offen lds
    ds_read_b64_tr_b16 v[164:165], v194 offset:24616
    ds_read_b64_tr_b16 v[166:167], v194 offset:29992
    s_add_u32 m0, s45, 4096
    v_mfma_f32_16x16x32_bf16 v[56:59], v[148:151], v[104:107], v[56:59]
    buffer_load_dwordx4 v185, s[24:27], s44 offen lds
    ds_read_b64_tr_b16 v[168:169], v194 offset:24656
    ds_read_b64_tr_b16 v[170:171], v194 offset:30032
    s_add_u32 m0, s45, 8192
    v_mfma_f32_16x16x32_bf16 v[60:63], v[148:151], v[108:111], v[60:63]
    buffer_load_dwordx4 v186, s[24:27], s44 offen lds
    ds_read_b64_tr_b16 v[172:173], v194 offset:24696
    ds_read_b64_tr_b16 v[174:175], v194 offset:30072
    s_add_u32 m0, s45, 12288
    v_mfma_f32_16x16x32_bf16 v[64:67], v[148:151], v[112:115], v[64:67]
    buffer_load_dwordx4 v187, s[24:27], s44 offen lds
    ds_read_b64_tr_b16 v[176:177], v195 offset:24608
    s_add_u32 m0, s45, 16384
    v_mfma_f32_16x16x32_bf16 v[68:71], v[148:151], v[116:119], v[68:71]
    buffer_load_dwordx4 v188, s[24:27], s44 offen lds
    ds_read_b64_tr_b16 v[178:179], v195 offset:29984
    s_add_u32 m0, s45, 20480
    v_mfma_f32_16x16x32_bf16 v[72:75], v[152:155], v[104:107], v[72:75]
    buffer_load_dwordx4 v189, s[24:27], s44 offen lds
    s_add_u32 m0, s47, 0
    v_mfma_f32_16x16x32_bf16 v[76:79], v[152:155], v[108:111], v[76:79]
    buffer_load_dwordx4 v190, s[20:23], s46 offen lds
    s_add_u32 m0, s47, 4096
    v_mfma_f32_16x16x32_bf16 v[80:83], v[152:155], v[112:115], v[80:83]
    buffer_load_dwordx4 v191, s[20:23], s46 offen lds
    s_add_u32 s53, s53, 16384
    s_cmp_eq_u32 s53, 147456
    s_cselect_b32 s53, 98304, s53
    v_mfma_f32_16x16x32_bf16 v[84:87], v[152:155], v[116:119], v[84:87]
    s_add_u32 s44, s44, 122880
    s_cmp_eq_u32 s44, 2457600
    s_cselect_b32 s44, 0, s44
    s_add_u32 s47, s47, 8192
    s_sub_u32 s46, s46, 81792
    s_cmp_ge_u32 s47, 147456
    s_cselect_b32 s47, s49, s47
    s_cmp_eq_u32 s46, 1280
    s_cselect_b32 s46, 0, s46
    s_cmp_eq_u32 s54, 7
    s_cselect_b32 s46, 2146435072, s46
    s_waitcnt lgkmcnt(8)
    v_mfma_f32_16x16x32_bf16 v[8:11], v[160:163], v[120:123], v[8:11]
    v_mfma_f32_16x16x32_bf16 v[12:15], v[160:163], v[124:127], v[12:15]
    v_mfma_f32_16x16x32_bf16 v[16:19], v[160:163], v[128:131], v[16:19]
    v_mfma_f32_16x16x32_bf16 v[20:23], v[160:163], v[132:135], v[20:23]
    s_waitcnt lgkmcnt(6)
    v_mfma_f32_16x16x32_bf16 v[24:27], v[164:167], v[120:123], v[24:27]
    v_mfma_f32_16x16x32_bf16 v[28:31], v[164:167], v[124:127], v[28:31]
    v_mfma_f32_16x16x32_bf16 v[32:35], v[164:167], v[128:131], v[32:35]
    v_mfma_f32_16x16x32_bf16 v[36:39], v[164:167], v[132:135], v[36:39]
    s_waitcnt lgkmcnt(0) vmcnt(16)
    s_barrier
    v_add_u32 v197, s53, v192
    v_add_u32 v194, s74, v194
    v_add_u32 v195, s74, v195
    v_mfma_f32_16x16x32_bf16 v[40:43], v[168:171], v[120:123], v[40:43]
    ds_read_b128 v[104:107], v197 offset:0
    ds_read_b128 v[108:111], v197 offset:2048
    v_mfma_f32_16x16x32_bf16 v[44:47], v[168:171], v[124:127], v[44:47]
    ds_read_b128 v[112:115], v197 offset:4096
    ds_read_b128 v[116:119], v197 offset:6144
    v_mfma_f32_16x16x32_bf16 v[48:51], v[168:171], v[128:131], v[48:51]
    ds_read_b64_tr_b16 v[136:137], v194 offset:0
    ds_read_b64_tr_b16 v[138:139], v194 offset:5376
    s_add_u32 m0, s45, 24576
    v_mfma_f32_16x16x32_bf16 v[52:55], v[168:171], v[132:135], v[52:55]
    buffer_load_dwordx4 v184, s[24:27], s44 offen lds
    ds_read_b64_tr_b16 v[140:141], v194 offset:40
    ds_read_b64_tr_b16 v[142:143], v194 offset:5416
    s_add_u32 m0, s45, 28672
    v_mfma_f32_16x16x32_bf16 v[56:59], v[172:175], v[120:123], v[56:59]
    buffer_load_dwordx4 v185, s[24:27], s44 offen lds
    ds_read_b64_tr_b16 v[144:145], v194 offset:80
    ds_read_b64_tr_b16 v[146:147], v194 offset:5456
    s_add_u32 m0, s45, 32768
    v_mfma_f32_16x16x32_bf16 v[60:63], v[172:175], v[124:127], v[60:63]
    buffer_load_dwordx4 v186, s[24:27], s44 offen lds
    ds_read_b64_tr_b16 v[148:149], v194 offset:120
    ds_read_b64_tr_b16 v[150:151], v194 offset:5496
    s_add_u32 m0, s45, 36864
    v_mfma_f32_16x16x32_bf16 v[64:67], v[172:175], v[128:131], v[64:67]
    buffer_load_dwordx4 v187, s[24:27], s44 offen lds
    ds_read_b64_tr_b16 v[152:153], v195 offset:32
    s_add_u32 m0, s45, 40960
    v_mfma_f32_16x16x32_bf16 v[68:71], v[172:175], v[132:135], v[68:71]
    buffer_load_dwordx4 v188, s[24:27], s44 offen lds
    ds_read_b64_tr_b16 v[154:155], v195 offset:5408
    s_add_u32 m0, s45, 45056
    v_mfma_f32_16x16x32_bf16 v[72:75], v[176:179], v[120:123], v[72:75]
    buffer_load_dwordx4 v189, s[24:27], s44 offen lds
    s_add_u32 m0, s47, 0
    v_mfma_f32_16x16x32_bf16 v[76:79], v[176:179], v[124:127], v[76:79]
    buffer_load_dwordx4 v190, s[20:23], s46 offen lds
    s_add_u32 m0, s47, 4096
    v_mfma_f32_16x16x32_bf16 v[80:83], v[176:179], v[128:131], v[80:83]
    buffer_load_dwordx4 v191, s[20:23], s46 offen lds
    s_add_u32 s44, s44, 122880
    s_cmp_eq_u32 s44, 2457600
    s_cselect_b32 s44, 0, s44
    v_mfma_f32_16x16x32_bf16 v[84:87], v[176:179], v[132:135], v[84:87]
    s_add_u32 s47, s47, 8192
    s_add_u32 s46, s46, 81920
    s_add_u32 s45, s45, s74
    s_sub_u32 s74, 0, s74
    s_add_u32 s54, s54, 1
    s_cmp_lt_u32 s54, 10
    s_cbranch_scc1 L_k1_Q_loop0
    s_branch L_k1_Q_epi
L_k1_Q_pre1:
    s_add_u32 s44, s44, 122880
    s_cmp_eq_u32 s44, 2457600
    s_cselect_b32 s44, 0, s44
    s_add_u32 s44, s44, 122880
    s_cmp_eq_u32 s44, 2457600
    s_cselect_b32 s44, 0, s44
    s_add_u32 s47, s47, 8192
    s_add_u32 s46, s46, 81920
    s_add_u32 s47, s47, 8192
    s_sub_u32 s46, s46, 81792
    s_cmp_ge_u32 s47, 147456
    s_cselect_b32 s47, s49, s47
    s_cmp_eq_u32 s46, 1280
    s_cselect_b32 s46, 0, s46
    s_add_u32 s47, s47, 8192
    s_add_u32 s46, s46, 81920
    s_add_u32 m0, s48, 49152
    s_nop 0
    buffer_load_dwordx4 v184, s[24:27], s44 offen lds
    s_add_u32 m0, s48, 53248
    s_nop 0
    buffer_load_dwordx4 v185, s[24:27], s44 offen lds
    s_add_u32 m0, s48, 57344
    s_nop 0
    buffer_load_dwordx4 v186, s[24:27], s44 offen lds
    s_add_u32 m0, s48, 61440
    s_nop 0
    buffer_load_dwordx4 v187, s[24:27], s44 offen lds
    s_add_u32 m0, s48, 65536
    s_nop 0
    buffer_load_dwordx4 v188, s[24:27], s44 offen lds
    s_add_u32 m0, s48, 69632
    s_nop 0
    buffer_load_dwordx4 v189, s[24:27], s44 offen lds
    s_add_u32 s44, s44, 122880
    s_cmp_eq_u32 s44, 2457600
    s_cselect_b32 s44, 0, s44
    s_add_u32 m0, s47, 0
    s_nop 0
    buffer_load_dwordx4 v190, s[20:23], s46 offen lds
    s_add_u32 m0, s47, 4096
    s_nop 0
    buffer_load_dwordx4 v191, s[20:23], s46 offen lds
    s_add_u32 s47, s47, 8192
    s_sub_u32 s46, s46, 81792
    s_cmp_ge_u32 s47, 147456
    s_cselect_b32 s47, s49, s47
    s_cmp_eq_u32 s46, 1280
    s_cselect_b32 s46, 0, s46
    s_barrier
    v_add_u32 v197, s53, v192
    ds_read_b128 v[104:107], v197 offset:0
    ds_read_b128 v[108:111], v197 offset:2048
    ds_read_b128 v[112:115], v197 offset:4096
    ds_read_b128 v[116:119], v197 offset:6144
    ds_read_b64_tr_b16 v[136:137], v194 offset:0
    ds_read_b64_tr_b16 v[138:139], v194 offset:5376
    ds_read_b64_tr_b16 v[140:141], v194 offset:40
    ds_read_b64_tr_b16 v[142:143], v194 offset:5416
    ds_read_b64_tr_b16 v[144:145], v194 offset:80
    ds_read_b64_tr_b16 v[146:147], v194 offset:5456
    ds_read_b64_tr_b16 v[148:149], v194 offset:120
    ds_read_b64_tr_b16 v[150:151], v194 offset:5496
    ds_read_b64_tr_b16 v[152:153], v195 offset:32
    ds_read_b64_tr_b16 v[154:155], v195 offset:5408
    s_add_u32 m0, s48, 73728
    s_nop 0
    buffer_load_dwordx4 v184, s[24:27], s44 offen lds
    s_add_u32 m0, s48, 77824
    s_nop 0
    buffer_load_dwordx4 v185, s[24:27], s44 offen lds
    s_add_u32 m0, s48, 81920
    s_nop 0
    buffer_load_dwordx4 v186, s[24:27], s44 offen lds
    s_add_u32 m0, s48, 86016
    s_nop 0
    buffer_load_dwordx4 v187, s[24:27], s44 offen lds
    s_add_u32 m0, s48, 90112
    s_nop 0
    buffer_load_dwordx4 v188, s[24:27], s44 offen lds
    s_add_u32 m0, s48, 94208
    s_nop 0
    buffer_load_dwordx4 v189, s[24:27], s44 offen lds
    s_add_u32 m0, s47, 0
    s_nop 0
    buffer_load_dwordx4 v190, s[20:23], s46 offen lds
    s_add_u32 m0, s47, 4096
    s_nop 0
    buffer_load_dwordx4 v191, s[20:23], s46 offen lds
    s_cmp_lt_u32 s66, 5
    s_cbranch_scc0 L_ax_19
    buffer_load_dwordx4 v[212:215], v1, s[76:79], s72 offen
    s_add_u32 s72, s72, s73
    buffer_load_dwordx4 v[216:219], v1, s[76:79], s72 offen
    s_add_u32 s72, s72, s73
    buffer_load_dwordx4 v[220:223], v1, s[76:79], s72 offen
    s_add_u32 s72, s72, s73
    buffer_load_dwordx4 v[224:227], v1, s[76:79], s72 offen
    s_add_u32 s72, s72, s73
    buffer_load_dwordx4 v[228:231], v1, s[76:79], s72 offen
    s_add_u32 s72, s72, s73
    buffer_load_dwordx4 v[232:235], v1, s[76:79], s72 offen
    s_add_u32 s72, s72, s73
    buffer_load_dwordx4 v[236:239], v1, s[76:79], s72 offen
    s_add_u32 s72, s72, s73
    buffer_load_dwordx4 v[240:243], v1, s[76:79], s72 offen
    s_add_u32 s72, s72, s73
    buffer_load_dwordx4 v[184:187], v1, s[76:79], s72 offen
    s_add_u32 s72, s72, s73
    buffer_load_dwordx4 v[188:191], v1, s[76:79], s72 offen
L_ax_19:
.p2align 3
L_k1_Q_loop1:
    s_waitcnt lgkmcnt(8)
    v_mfma_f32_16x16x32_bf16 v[8:11], v[136:139], v[104:107], v[8:11]
    v_mfma_f32_16x16x32_bf16 v[12:15], v[136:139], v[108:111], v[12:15]
    v_mfma_f32_16x16x32_bf16 v[16:19], v[136:139], v[112:115], v[16:19]
    v_mfma_f32_16x16x32_bf16 v[20:23], v[136:139], v[116:119], v[20:23]
    s_waitcnt lgkmcnt(6)
    v_mfma_f32_16x16x32_bf16 v[24:27], v[140:143], v[104:107], v[24:27]
    v_mfma_f32_16x16x32_bf16 v[28:31], v[140:143], v[108:111], v[28:31]
    v_mfma_f32_16x16x32_bf16 v[32:35], v[140:143], v[112:115], v[32:35]
    v_mfma_f32_16x16x32_bf16 v[36:39], v[140:143], v[116:119], v[36:39]
    s_waitcnt lgkmcnt(0)
    s_barrier
    v_add_u32 v197, s53, v193
    v_mfma_f32_16x16x32_bf16 v[40:43], v[144:147], v[104:107], v[40:43]
    ds_read_b128 v[120:123], v197 offset:0
    ds_read_b128 v[124:127], v197 offset:2048
    v_mfma_f32_16x16x32_bf16 v[44:47], v[144:147], v[108:111], v[44:47]
    ds_read_b128 v[128:131], v197 offset:4096
    ds_read_b128 v[132:135], v197 offset:6144
    v_mfma_f32_16x16x32_bf16 v[48:51], v[144:147], v[112:115], v[48:51]
    ds_read_b64_tr_b16 v[160:161], v194 offset:24576
    ds_read_b64_tr_b16 v[162:163], v194 offset:29952
    v_mfma_f32_16x16x32_bf16 v[52:55], v[144:147], v[116:119], v[52:55]
    ds_read_b64_tr_b16 v[164:165], v194 offset:24616
    ds_read_b64_tr_b16 v[166:167], v194 offset:29992
    v_mfma_f32_16x16x32_bf16 v[56:59], v[148:151], v[104:107], v[56:59]
    ds_read_b64_tr_b16 v[168:169], v194 offset:24656
    ds_read_b64_tr_b16 v[170:171], v194 offset:30032
    v_mfma_f32_16x16x32_bf16 v[60:63], v[148:151], v[108:111], v[60:63]
    ds_read_b64_tr_b16 v[172:173], v194 offset:24696
    ds_read_b64_tr_b16 v[174:175], v194 offset:30072
    v_mfma_f32_16x16x32_bf16 v[64:67], v[148:151], v[112:115], v[64:67]
    ds_read_b64_tr_b16 v[176:177], v195 offset:24608
    v_mfma_f32_16x16x32_bf16 v[68:71], v[148:151], v[116:119], v[68:71]
    ds_read_b64_tr_b16 v[178:179], v195 offset:29984
    v_mfma_f32_16x16x32_bf16 v[72:75], v[152:155], v[104:107], v[72:75]
    s_bitcmp1_b32 791, s54
    s_cbranch_scc1 L_k1_Q_ev0
L_k1_Q_evr0:
    v_mfma_f32_16x16x32_bf16 v[76:79], v[152:155], v[108:111], v[76:79]
    s_add_u32 s53, s53, 16384
    s_cmp_eq_u32 s53, 147456
    s_cselect_b32 s53, 98304, s53
    v_mfma_f32_16x16x32_bf16 v[80:83], v[152:155], v[112:115], v[80:83]
    v_mfma_f32_16x16x32_bf16 v[84:87], v[152:155], v[116:119], v[84:87]
    s_waitcnt lgkmcnt(8)
    v_mfma_f32_16x16x32_bf16 v[8:11], v[160:163], v[120:123], v[8:11]
    v_mfma_f32_16x16x32_bf16 v[12:15], v[160:163], v[124:127], v[12:15]
    v_mfma_f32_16x16x32_bf16 v[16:19], v[160:163], v[128:131], v[16:19]
    v_mfma_f32_16x16x32_bf16 v[20:23], v[160:163], v[132:135], v[20:23]
    s_waitcnt lgkmcnt(6)
    v_mfma_f32_16x16x32_bf16 v[24:27], v[164:167], v[120:123], v[24:27]
    v_mfma_f32_16x16x32_bf16 v[28:31], v[164:167], v[124:127], v[28:31]
    v_mfma_f32_16x16x32_bf16 v[32:35], v[164:167], v[128:131], v[32:35]
    v_mfma_f32_16x16x32_bf16 v[36:39], v[164:167], v[132:135], v[36:39]
    s_waitcnt lgkmcnt(0)
    s_barrier
    v_add_u32 v197, s53, v192
    v_add_u32 v194, s74, v194
    v_add_u32 v195, s74, v195
    v_mfma_f32_16x16x32_bf16 v[40:43], v[168:171], v[120:123], v[40:43]
    ds_read_b128 v[104:107], v197 offset:0
    ds_read_b128 v[108:111], v197 offset:2048
    v_mfma_f32_16x16x32_bf16 v[44:47], v[168:171], v[124:127], v[44:47]
    ds_read_b128 v[112:115], v197 offset:4096
    ds_read_b128 v[116:119], v197 offset:6144
    v_mfma_f32_16x16x32_bf16 v[48:51], v[168:171], v[128:131], v[48:51]
    ds_read_b64_tr_b16 v[136:137], v194 offset:0
    ds_read_b64_tr_b16 v[138:139], v194 offset:5376
    v_mfma_f32_16x16x32_bf16 v[52:55], v[168:171], v[132:135], v[52:55]
    ds_read_b64_tr_b16 v[140:141], v194 offset:40
    ds_read_b64_tr_b16 v[142:143], v194 offset:5416
    v_mfma_f32_16x16x32_bf16 v[56:59], v[172:175], v[120:123], v[56:59]
    ds_read_b64_tr_b16 v[144:145], v194 offset:80
    ds_read_b64_tr_b16 v[146:147], v194 offset:5456
    v_mfma_f32_16x16x32_bf16 v[60:63], v[172:175], v[124:127], v[60:63]
    ds_read_b64_tr_b16 v[148:149], v194 offset:120
    ds_read_b64_tr_b16 v[150:151], v194 offset:5496
    v_mfma_f32_16x16x32_bf16 v[64:67], v[172:175], v[128:131], v[64:67]
    ds_read_b64_tr_b16 v[152:153], v195 offset:32
    v_mfma_f32_16x16x32_bf16 v[68:71], v[172:175], v[132:135], v[68:71]
    ds_read_b64_tr_b16 v[154:155], v195 offset:5408
    v_mfma_f32_16x16x32_bf16 v[72:75], v[176:179], v[120:123], v[72:75]
    s_bitcmp1_b32 77, s54
    s_cbranch_scc1 L_k1_Q_ev1
L_k1_Q_evr1:
    v_mfma_f32_16x16x32_bf16 v[76:79], v[176:179], v[124:127], v[76:79]
    s_sub_u32 s74, 0, s74
    s_add_u32 s54, s54, 1
    v_mfma_f32_16x16x32_bf16 v[80:83], v[176:179], v[128:131], v[80:83]
    v_mfma_f32_16x16x32_bf16 v[84:87], v[176:179], v[132:135], v[84:87]
    s_cmp_lt_u32 s54, 10
    s_cbranch_scc1 L_k1_Q_loop1
    s_branch L_k1_Q_epi
L_k1_Q_ev0:
    s_cmp_eq_u32 s54, 0
    s_cbranch_scc1 L_ev_20
    s_cmp_eq_u32 s54, 1
    s_cbranch_scc1 L_ev_21
    s_cmp_eq_u32 s54, 2
    s_cbranch_scc1 L_ev_22
    s_cmp_eq_u32 s54, 4
    s_cbranch_scc1 L_ev_23
    s_cmp_eq_u32 s54, 8
    s_cbranch_scc1 L_ev_24
    s_waitcnt vmcnt(0)
    v_add_f32 v212, v212, v216
    v_add_f32 v212, v212, v220
    v_add_f32 v212, v212, v224
    v_add_f32 v212, v212, v228
    v_add_f32 v212, v212, v232
    v_add_f32 v212, v212, v236
    v_add_f32 v212, v212, v240
    v_add_f32 v213, v213, v217
    v_add_f32 v213, v213, v221
    v_add_f32 v213, v213, v225
    v_add_f32 v213, v213, v229
    v_add_f32 v213, v213, v233
    v_add_f32 v213, v213, v237
    v_add_f32 v213, v213, v241
    v_add_f32 v214, v214, v218
    v_add_f32 v214, v214, v222
    v_add_f32 v214, v214, v226
    v_add_f32 v214, v214, v230
    v_add_f32 v214, v214, v234
    v_add_f32 v214, v214, v238
    v_add_f32 v214, v214, v242
    v_add_f32 v215, v215, v219
    v_add_f32 v215, v215, v223
    v_add_f32 v215, v215, v227
    v_add_f32 v215, v215, v231
    v_add_f32 v215, v215, v235
    v_add_f32 v215, v215, v239
    v_add_f32 v215, v215, v243
    ds_write_b128 v201, v[212:215]
    s_branch L_k1_Q_evr0
L_ev_20:
    s_waitcnt vmcnt(8)
    s_branch L_k1_Q_evr0
L_ev_21:
    s_cmp_lt_u32 s66, 5
    s_cbranch_scc1 L_ax_26
    buffer_load_dwordx4 v[212:215], v1, s[76:79], s72 offen
    s_add_u32 s72, s72, s73
    buffer_load_dwordx4 v[216:219], v1, s[76:79], s72 offen
    s_add_u32 s72, s72, s73
    buffer_load_dwordx4 v[220:223], v1, s[76:79], s72 offen
    s_add_u32 s72, s72, s73
    buffer_load_dwordx4 v[224:227], v1, s[76:79], s72 offen
    s_add_u32 s72, s72, s73
    buffer_load_dwordx4 v[228:231], v1, s[76:79], s72 offen
    s_add_u32 s72, s72, s73
    buffer_load_dwordx4 v[232:235], v1, s[76:79], s72 offen
    s_add_u32 s72, s72, s73
    buffer_load_dwordx4 v[236:239], v1, s[76:79], s72 offen
    s_add_u32 s72, s72, s73
    buffer_load_dwordx4 v[240:243], v1, s[76:79], s72 offen
    s_add_u32 s72, s72, s73
    buffer_load_dwordx4 v[184:187], v1, s[76:79], s72 offen
    s_add_u32 s72, s72, s73
    buffer_load_dwordx4 v[188:191], v1, s[76:79], s72 offen
L_ax_26:
    s_branch L_k1_Q_evr0
L_ev_22:
    s_waitcnt vmcnt(0)
    v_mfma_f32_16x16x32_bf16 v[208:211], v[212:215], v[4:7], 0
    v_mfma_f32_16x16x32_bf16 v[208:211], v[216:219], v[4:7], v[208:211]
    v_mfma_f32_16x16x32_bf16 v[208:211], v[220:223], v[4:7], v[208:211]
    v_mfma_f32_16x16x32_bf16 v[208:211], v[224:227], v[4:7], v[208:211]
    v_mfma_f32_16x16x32_bf16 v[208:211], v[228:231], v[4:7], v[208:211]
    v_mfma_f32_16x16x32_bf16 v[208:211], v[232:235], v[4:7], v[208:211]
    v_mfma_f32_16x16x32_bf16 v[208:211], v[236:239], v[4:7], v[208:211]
    v_mfma_f32_16x16x32_bf16 v[208:211], v[240:243], v[4:7], v[208:211]
    v_mfma_f32_16x16x32_bf16 v[208:211], v[184:187], v[4:7], v[208:211]
    v_mfma_f32_16x16x32_bf16 v[208:211], v[188:191], v[4:7], v[208:211]
    s_branch L_k1_Q_evr0
L_ev_23:
    s_cmp_eq_u32 s3, 4
    s_cbranch_scc0 L_ar_27
    s_and_b32 s56, s2, 7
    s_lshl_b32 s56, s56, 5
    v_mov_b32 v184, 1
    v_mov_b32 v185, 0
    s_mov_b64 exec, 1
    buffer_atomic_add v184, v185, s[28:31], s56 offen sc1
    s_mov_b64 exec, -1
L_ar_27:
    s_branch L_k1_Q_evr0
L_ev_24:
    s_mov_b32 s56, 0
L_sp_28:
    s_waitcnt vmcnt(0)
    v_cmp_ne_u32 vcc, 32, v184
    s_add_u32 s56, s56, 1
    s_nop 2
    s_cmp_eq_u64 vcc, 0
    s_cbranch_scc1 L_sp_28b
    s_cmp_gt_u32 s56, 0x8000
    s_cbranch_scc1 L_sp_28b
    s_sleep 1
    buffer_load_dword v184, v205, s[28:31], 0 offen sc1
    s_branch L_sp_28
L_sp_28b:
    buffer_load_dwordx4 v[212:215], v200, s[36:39], s68 offen sc1
    s_add_u32 s68, s68, s69
    buffer_load_dwordx4 v[216:219], v200, s[36:39], s68 offen sc1
    s_add_u32 s68, s68, s69
    buffer_load_dwordx4 v[220:223], v200, s[36:39], s68 offen sc1
    s_add_u32 s68, s68, s69
    buffer_load_dwordx4 v[224:227], v200, s[36:39], s68 offen sc1
    s_add_u32 s68, s68, s69
    buffer_load_dwordx4 v[228:231], v200, s[36:39], s68 offen sc1
    s_add_u32 s68, s68, s69
    buffer_load_dwordx4 v[232:235], v200, s[36:39], s68 offen sc1
    s_add_u32 s68, s68, s69
    buffer_load_dwordx4 v[236:239], v200, s[36:39], s68 offen sc1
    s_add_u32 s68, s68, s69
    buffer_load_dwordx4 v[240:243], v200, s[36:39], s68 offen sc1
    s_branch L_k1_Q_evr0
L_k1_Q_ev1:
    s_cmp_eq_u32 s54, 0
    s_cbranch_scc1 L_ev_29
    s_cmp_eq_u32 s54, 2
    s_cbranch_scc1 L_ev_30
    s_cmp_eq_u32 s54, 3
    s_cbranch_scc1 L_ev_31
    buffer_load_dword v184, v205, s[28:31], 0 offen sc1
    s_branch L_k1_Q_evr1
L_ev_29:
    s_cmp_lt_u32 s66, 5
    s_cbranch_scc1 L_g1_33
    s_waitcnt vmcnt(0)
    s_branch L_g1_34
L_g1_33:
    s_waitcnt vmcnt(10)
L_g1_34:
    s_branch L_k1_Q_evr1
L_ev_30:
    v_mov_b32 v212, v208
    v_mov_b32 v213, v209
    v_mov_b32 v214, v210
    v_mov_b32 v215, v211
    s_nop 1
    v_permlane32_swap_b32 v208, v212
    v_permlane32_swap_b32 v209, v213
    v_permlane32_swap_b32 v210, v214
    v_permlane32_swap_b32 v211, v215
    v_add_f32 v208, v208, v212
    v_add_f32 v209, v209, v213
    v_add_f32 v210, v210, v214
    v_add_f32 v211, v211, v215
    s_mov_b64 exec, 0x00ff00ff
    buffer_store_dword v208, v2, s[36:39], s71 offen offset:0 sc1
    buffer_store_dword v209, v2, s[36:39], s71 offen offset:32 sc1
    buffer_store_dword v210, v2, s[36:39], s71 offen offset:64 sc1
    buffer_store_dword v211, v2, s[36:39], s71 offen offset:96 sc1
    s_mov_b64 exec, -1
    s_cmp_eq_u32 s3, 5
    s_cbranch_scc0 L_fl_35
    v_mov_b32 v220, 0
    v_mov_b32 v221, 0
    s_mov_b64 exec, 1
    s_and_b32 s56, s2, 7
    s_lshl_b32 s56, s56, 9
    s_bfe_u32 s57, s2, 0x20003
    s_lshl_b32 s57, s57, 7
    s_add_u32 s56, s56, s57
    s_lshr_b32 s57, s2, 5
    s_lshl_b32 s57, s57, 2
    s_add_u32 s56, s56, s57
    s_add_u32 s56, s56, 16257024
    buffer_store_dword v220, v221, s[36:39], s56 offen sc1
    s_mov_b64 exec, -1
L_fl_35:
    s_cmp_eq_u32 s3, 4
    s_cbranch_scc0 L_fl_36
    v_mov_b32 v220, 0
    v_mov_b32 v221, 0
    s_mov_b64 exec, 1
    buffer_store_dword v220, v221, s[36:39], s95 offen sc1
    s_mov_b64 exec, -1
L_fl_36:
    s_branch L_k1_Q_evr1
L_ev_31:
    s_waitcnt vmcnt(0)
    s_branch L_k1_Q_evr1
.p2align 3
L_k1_Q_epi:
    s_waitcnt lgkmcnt(0)
    v_lshrrev_b32 v203, 4, v0
    v_lshlrev_b32 v204, 4, v203
    s_lshl_b32 s56, s42, 8
    s_add_u32 s56, s56, 147456
    v_add_u32 v201, s56, v202
    ds_read_b32 v104, v201 offset:0
    ds_read_b32 v120, v201 offset:1024
    ds_read_b32 v108, v201 offset:64
    ds_read_b32 v124, v201 offset:1088
    ds_read_b32 v112, v201 offset:128
    ds_read_b32 v128, v201 offset:1152
    ds_read_b32 v116, v201 offset:192
    ds_read_b32 v132, v201 offset:1216
    s_mul_i32 s56, s43, 320
    s_add_u32 s56, s56, 149504
    v_add_u32 v201, s56, v204
    ds_read_b128 v[136:139], v201 offset:0
    ds_read_b128 v[140:143], v201 offset:80
    ds_read_b128 v[144:147], v201 offset:160
    ds_read_b128 v[148:151], v201 offset:240
    v_mul_u32_u24 v201, 80, v203
    v_add_u32 v201, s56, v201
    ds_read_b128 v[152:155], v201 offset:64
    s_mov_b32 s58, 0x3fb8aa3b
    s_mov_b32 s59, 0x358637bd
    v_mov_b32 v206, s59
    s_lshr_b32 s56, s40, 4
    s_lshl_b32 s57, s42, 2
    s_add_u32 s56, s56, s57
    s_lshl_b32 s56, s56, 3
    s_lshl_b32 s57, s41, 2
    s_add_u32 s56, s56, s57
    s_add_u32 s56, s56, s43
    s_mul_i32 s56, s56, 2560
    v_add_u32 v201, s56, v200
    v_lshlrev_b32 v202, 3, v0
    v_add_u32 v202, s56, v202
    s_waitcnt lgkmcnt(0)
    v_mul_f32 v212, s58, v120
    v_mul_f32 v214, s58, v124
    v_mul_f32 v216, s58, v128
    v_mul_f32 v218, s58, v132
    v_pk_fma_f32 v[8:9], v[136:137], v[104:105], v[8:9] op_sel_hi:[1,0,1]
    v_pk_fma_f32 v[10:11], v[138:139], v[104:105], v[10:11] op_sel_hi:[1,0,1]
    v_pk_mul_f32 v[184:185], v[8:9], v[212:213] op_sel_hi:[1,0]
    v_pk_mul_f32 v[186:187], v[10:11], v[212:213] op_sel_hi:[1,0]
    v_pk_fma_f32 v[8:9], v[8:9], v[120:121], v[206:207] op_sel_hi:[1,0,0]
    v_pk_fma_f32 v[10:11], v[10:11], v[120:121], v[206:207] op_sel_hi:[1,0,0]
    v_exp_f32_e64 v184, v184 clamp
    v_exp_f32_e64 v185, v185 clamp
    v_exp_f32_e64 v186, v186 clamp
    v_exp_f32_e64 v187, v187 clamp
    v_max_f32 v8, s59, v8
    v_max_f32 v9, s59, v9
    v_max_f32 v10, s59, v10
    v_max_f32 v11, s59, v11
    v_pk_add_f32 v[8:9], v[8:9], v[184:185]
    v_pk_add_f32 v[10:11], v[10:11], v[186:187]
    v_cvt_pk_bf16_f32 v160, v8, v9
    v_cvt_pk_bf16_f32 v161, v10, v11
    v_pk_fma_f32 v[24:25], v[140:141], v[104:105], v[24:25] op_sel_hi:[1,0,1]
    v_pk_fma_f32 v[26:27], v[142:143], v[104:105], v[26:27] op_sel_hi:[1,0,1]
    v_pk_mul_f32 v[188:189], v[24:25], v[212:213] op_sel_hi:[1,0]
    v_pk_mul_f32 v[190:191], v[26:27], v[212:213] op_sel_hi:[1,0]
    v_pk_fma_f32 v[24:25], v[24:25], v[120:121], v[206:207] op_sel_hi:[1,0,0]
    v_pk_fma_f32 v[26:27], v[26:27], v[120:121], v[206:207] op_sel_hi:[1,0,0]
    v_exp_f32_e64 v188, v188 clamp
    v_exp_f32_e64 v189, v189 clamp
    v_exp_f32_e64 v190, v190 clamp
    v_exp_f32_e64 v191, v191 clamp
    v_max_f32 v24, s59, v24
    v_max_f32 v25, s59, v25
    v_max_f32 v26, s59, v26
    v_max_f32 v27, s59, v27
    v_pk_add_f32 v[24:25], v[24:25], v[188:189]
    v_pk_add_f32 v[26:27], v[26:27], v[190:191]
    v_cvt_pk_bf16_f32 v162, v24, v25
    v_cvt_pk_bf16_f32 v163, v26, v27
    v_pk_fma_f32 v[40:41], v[144:145], v[104:105], v[40:41] op_sel_hi:[1,0,1]
    v_pk_fma_f32 v[42:43], v[146:147], v[104:105], v[42:43] op_sel_hi:[1,0,1]
    v_pk_mul_f32 v[184:185], v[40:41], v[212:213] op_sel_hi:[1,0]
    v_pk_mul_f32 v[186:187], v[42:43], v[212:213] op_sel_hi:[1,0]
    v_pk_fma_f32 v[40:41], v[40:41], v[120:121], v[206:207] op_sel_hi:[1,0,0]
    v_pk_fma_f32 v[42:43], v[42:43], v[120:121], v[206:207] op_sel_hi:[1,0,0]
    v_exp_f32_e64 v184, v184 clamp
    v_exp_f32_e64 v185, v185 clamp
    v_exp_f32_e64 v186, v186 clamp
    v_exp_f32_e64 v187, v187 clamp
    v_max_f32 v40, s59, v40
    v_max_f32 v41, s59, v41
    v_max_f32 v42, s59, v42
    v_max_f32 v43, s59, v43
    v_pk_add_f32 v[40:41], v[40:41], v[184:185]
    v_pk_add_f32 v[42:43], v[42:43], v[186:187]
    v_cvt_pk_bf16_f32 v164, v40, v41
    v_cvt_pk_bf16_f32 v165, v42, v43
    v_pk_fma_f32 v[56:57], v[148:149], v[104:105], v[56:57] op_sel_hi:[1,0,1]
    v_pk_fma_f32 v[58:59], v[150:151], v[104:105], v[58:59] op_sel_hi:[1,0,1]
    v_pk_mul_f32 v[188:189], v[56:57], v[212:213] op_sel_hi:[1,0]
    v_pk_mul_f32 v[190:191], v[58:59], v[212:213] op_sel_hi:[1,0]
    v_pk_fma_f32 v[56:57], v[56:57], v[120:121], v[206:207] op_sel_hi:[1,0,0]
    v_pk_fma_f32 v[58:59], v[58:59], v[120:121], v[206:207] op_sel_hi:[1,0,0]
    v_exp_f32_e64 v188, v188 clamp
    v_exp_f32_e64 v189, v189 clamp
    v_exp_f32_e64 v190, v190 clamp
    v_exp_f32_e64 v191, v191 clamp
    v_max_f32 v56, s59, v56
    v_max_f32 v57, s59, v57
    v_max_f32 v58, s59, v58
    v_max_f32 v59, s59, v59
    v_pk_add_f32 v[56:57], v[56:57], v[188:189]
    v_pk_add_f32 v[58:59], v[58:59], v[190:191]
    v_cvt_pk_bf16_f32 v166, v56, v57
    v_cvt_pk_bf16_f32 v167, v58, v59
    v_pk_fma_f32 v[72:73], v[152:153], v[104:105], v[72:73] op_sel_hi:[1,0,1]
    v_pk_fma_f32 v[74:75], v[154:155], v[104:105], v[74:75] op_sel_hi:[1,0,1]
    v_pk_mul_f32 v[184:185], v[72:73], v[212:213] op_sel_hi:[1,0]
    v_pk_mul_f32 v[186:187], v[74:75], v[212:213] op_sel_hi:[1,0]
    v_pk_fma_f32 v[72:73], v[72:73], v[120:121], v[206:207] op_sel_hi:[1,0,0]
    v_pk_fma_f32 v[74:75], v[74:75], v[120:121], v[206:207] op_sel_hi:[1,0,0]
    v_exp_f32_e64 v184, v184 clamp
    v_exp_f32_e64 v185, v185 clamp
    v_exp_f32_e64 v186, v186 clamp
    v_exp_f32_e64 v187, v187 clamp
    v_max_f32 v72, s59, v72
    v_max_f32 v73, s59, v73
    v_max_f32 v74, s59, v74
    v_max_f32 v75, s59, v75
    v_pk_add_f32 v[72:73], v[72:73], v[184:185]
    v_pk_add_f32 v[74:75], v[74:75], v[186:187]
    v_cvt_pk_bf16_f32 v168, v72, v73
    v_cvt_pk_bf16_f32 v169, v74, v75
    s_mov_b32 s56, 7340032
    buffer_store_dwordx4 v[160:163], v201, s[36:39], s56 offen sc1
    buffer_store_dwordx4 v[164:167], v201, s[36:39], s56 offen offset:1024 sc1
    buffer_store_dwordx2 v[168:169], v202, s[36:39], s56 offen offset:2048 sc1
    v_pk_fma_f32 v[12:13], v[136:137], v[108:109], v[12:13] op_sel_hi:[1,0,1]
    v_pk_fma_f32 v[14:15], v[138:139], v[108:109], v[14:15] op_sel_hi:[1,0,1]
    v_pk_mul_f32 v[184:185], v[12:13], v[214:215] op_sel_hi:[1,0]
    v_pk_mul_f32 v[186:187], v[14:15], v[214:215] op_sel_hi:[1,0]
    v_pk_fma_f32 v[12:13], v[12:13], v[124:125], v[206:207] op_sel_hi:[1,0,0]
    v_pk_fma_f32 v[14:15], v[14:15], v[124:125], v[206:207] op_sel_hi:[1,0,0]
    v_exp_f32_e64 v184, v184 clamp
    v_exp_f32_e64 v185, v185 clamp
    v_exp_f32_e64 v186, v186 clamp
    v_exp_f32_e64 v187, v187 clamp
    v_max_f32 v12, s59, v12
    v_max_f32 v13, s59, v13
    v_max_f32 v14, s59, v14
    v_max_f32 v15, s59, v15
    v_pk_add_f32 v[12:13], v[12:13], v[184:185]
    v_pk_add_f32 v[14:15], v[14:15], v[186:187]
    v_cvt_pk_bf16_f32 v172, v12, v13
    v_cvt_pk_bf16_f32 v173, v14, v15
    v_pk_fma_f32 v[28:29], v[140:141], v[108:109], v[28:29] op_sel_hi:[1,0,1]
    v_pk_fma_f32 v[30:31], v[142:143], v[108:109], v[30:31] op_sel_hi:[1,0,1]
    v_pk_mul_f32 v[188:189], v[28:29], v[214:215] op_sel_hi:[1,0]
    v_pk_mul_f32 v[190:191], v[30:31], v[214:215] op_sel_hi:[1,0]
    v_pk_fma_f32 v[28:29], v[28:29], v[124:125], v[206:207] op_sel_hi:[1,0,0]
    v_pk_fma_f32 v[30:31], v[30:31], v[124:125], v[206:207] op_sel_hi:[1,0,0]
    v_exp_f32_e64 v188, v188 clamp
    v_exp_f32_e64 v189, v189 clamp
    v_exp_f32_e64 v190, v190 clamp
    v_exp_f32_e64 v191, v191 clamp
    v_max_f32 v28, s59, v28
    v_max_f32 v29, s59, v29
    v_max_f32 v30, s59, v30
    v_max_f32 v31, s59, v31
    v_pk_add_f32 v[28:29], v[28:29], v[188:189]
    v_pk_add_f32 v[30:31], v[30:31], v[190:191]
    v_cvt_pk_bf16_f32 v174, v28, v29
    v_cvt_pk_bf16_f32 v175, v30, v31
    v_pk_fma_f32 v[44:45], v[144:145], v[108:109], v[44:45] op_sel_hi:[1,0,1]
    v_pk_fma_f32 v[46:47], v[146:147], v[108:109], v[46:47] op_sel_hi:[1,0,1]
    v_pk_mul_f32 v[184:185], v[44:45], v[214:215] op_sel_hi:[1,0]
    v_pk_mul_f32 v[186:187], v[46:47], v[214:215] op_sel_hi:[1,0]
    v_pk_fma_f32 v[44:45], v[44:45], v[124:125], v[206:207] op_sel_hi:[1,0,0]
    v_pk_fma_f32 v[46:47], v[46:47], v[124:125], v[206:207] op_sel_hi:[1,0,0]
    v_exp_f32_e64 v184, v184 clamp
    v_exp_f32_e64 v185, v185 clamp
    v_exp_f32_e64 v186, v186 clamp
    v_exp_f32_e64 v187, v187 clamp
    v_max_f32 v44, s59, v44
    v_max_f32 v45, s59, v45
    v_max_f32 v46, s59, v46
    v_max_f32 v47, s59, v47
    v_pk_add_f32 v[44:45], v[44:45], v[184:185]
    v_pk_add_f32 v[46:47], v[46:47], v[186:187]
    v_cvt_pk_bf16_f32 v176, v44, v45
    v_cvt_pk_bf16_f32 v177, v46, v47
    v_pk_fma_f32 v[60:61], v[148:149], v[108:109], v[60:61] op_sel_hi:[1,0,1]
    v_pk_fma_f32 v[62:63], v[150:151], v[108:109], v[62:63] op_sel_hi:[1,0,1]
    v_pk_mul_f32 v[188:189], v[60:61], v[214:215] op_sel_hi:[1,0]
    v_pk_mul_f32 v[190:191], v[62:63], v[214:215] op_sel_hi:[1,0]
    v_pk_fma_f32 v[60:61], v[60:61], v[124:125], v[206:207] op_sel_hi:[1,0,0]
    v_pk_fma_f32 v[62:63], v[62:63], v[124:125], v[206:207] op_sel_hi:[1,0,0]
    v_exp_f32_e64 v188, v188 clamp
    v_exp_f32_e64 v189, v189 clamp
    v_exp_f32_e64 v190, v190 clamp
    v_exp_f32_e64 v191, v191 clamp
    v_max_f32 v60, s59, v60
    v_max_f32 v61, s59, v61
    v_max_f32 v62, s59, v62
    v_max_f32 v63, s59, v63
    v_pk_add_f32 v[60:61], v[60:61], v[188:189]
    v_pk_add_f32 v[62:63], v[62:63], v[190:191]
    v_cvt_pk_bf16_f32 v178, v60, v61
    v_cvt_pk_bf16_f32 v179, v62, v63
    v_pk_fma_f32 v[76:77], v[152:153], v[108:109], v[76:77] op_sel_hi:[1,0,1]
    v_pk_fma_f32 v[78:79], v[154:155], v[108:109], v[78:79] op_sel_hi:[1,0,1]
    v_pk_mul_f32 v[184:185], v[76:77], v[214:215] op_sel_hi:[1,0]
    v_pk_mul_f32 v[186:187], v[78:79], v[214:215] op_sel_hi:[1,0]
    v_pk_fma_f32 v[76:77], v[76:77], v[124:125], v[206:207] op_sel_hi:[1,0,0]
    v_pk_fma_f32 v[78:79], v[78:79], v[124:125], v[206:207] op_sel_hi:[1,0,0]
    v_exp_f32_e64 v184, v184 clamp
    v_exp_f32_e64 v185, v185 clamp
    v_exp_f32_e64 v186, v186 clamp
    v_exp_f32_e64 v187, v187 clamp
    v_max_f32 v76, s59, v76
    v_max_f32 v77, s59, v77
    v_max_f32 v78, s59, v78
    v_max_f32 v79, s59, v79
    v_pk_add_f32 v[76:77], v[76:77], v[184:185]
    v_pk_add_f32 v[78:79], v[78:79], v[186:187]
    v_cvt_pk_bf16_f32 v180, v76, v77
    v_cvt_pk_bf16_f32 v181, v78, v79
    s_mov_b32 s56, 7360512
    buffer_store_dwordx4 v[172:175], v201, s[36:39], s56 offen sc1
    buffer_store_dwordx4 v[176:179], v201, s[36:39], s56 offen offset:1024 sc1
    buffer_store_dwordx2 v[180:181], v202, s[36:39], s56 offen offset:2048 sc1
    v_pk_fma_f32 v[16:17], v[136:137], v[112:113], v[16:17] op_sel_hi:[1,0,1]
    v_pk_fma_f32 v[18:19], v[138:139], v[112:113], v[18:19] op_sel_hi:[1,0,1]
    v_pk_mul_f32 v[184:185], v[16:17], v[216:217] op_sel_hi:[1,0]
    v_pk_mul_f32 v[186:187], v[18:19], v[216:217] op_sel_hi:[1,0]
    v_pk_fma_f32 v[16:17], v[16:17], v[128:129], v[206:207] op_sel_hi:[1,0,0]
    v_pk_fma_f32 v[18:19], v[18:19], v[128:129], v[206:207] op_sel_hi:[1,0,0]
    v_exp_f32_e64 v184, v184 clamp
    v_exp_f32_e64 v185, v185 clamp
    v_exp_f32_e64 v186, v186 clamp
    v_exp_f32_e64 v187, v187 clamp
    v_max_f32 v16, s59, v16
    v_max_f32 v17, s59, v17
    v_max_f32 v18, s59, v18
    v_max_f32 v19, s59, v19
    v_pk_add_f32 v[16:17], v[16:17], v[184:185]
    v_pk_add_f32 v[18:19], v[18:19], v[186:187]
    v_cvt_pk_bf16_f32 v160, v16, v17
    v_cvt_pk_bf16_f32 v161, v18, v19
    v_pk_fma_f32 v[32:33], v[140:141], v[112:113], v[32:33] op_sel_hi:[1,0,1]
    v_pk_fma_f32 v[34:35], v[142:143], v[112:113], v[34:35] op_sel_hi:[1,0,1]
    v_pk_mul_f32 v[188:189], v[32:33], v[216:217] op_sel_hi:[1,0]
    v_pk_mul_f32 v[190:191], v[34:35], v[216:217] op_sel_hi:[1,0]
    v_pk_fma_f32 v[32:33], v[32:33], v[128:129], v[206:207] op_sel_hi:[1,0,0]
    v_pk_fma_f32 v[34:35], v[34:35], v[128:129], v[206:207] op_sel_hi:[1,0,0]
    v_exp_f32_e64 v188, v188 clamp
    v_exp_f32_e64 v189, v189 clamp
    v_exp_f32_e64 v190, v190 clamp
    v_exp_f32_e64 v191, v191 clamp
    v_max_f32 v32, s59, v32
    v_max_f32 v33, s59, v33
    v_max_f32 v34, s59, v34
    v_max_f32 v35, s59, v35
    v_pk_add_f32 v[32:33], v[32:33], v[188:189]
    v_pk_add_f32 v[34:35], v[34:35], v[190:191]
    v_cvt_pk_bf16_f32 v162, v32, v33
    v_cvt_pk_bf16_f32 v163, v34, v35
    v_pk_fma_f32 v[48:49], v[144:145], v[112:113], v[48:49] op_sel_hi:[1,0,1]
    v_pk_fma_f32 v[50:51], v[146:147], v[112:113], v[50:51] op_sel_hi:[1,0,1]
    v_pk_mul_f32 v[184:185], v[48:49], v[216:217] op_sel_hi:[1,0]
    v_pk_mul_f32 v[186:187], v[50:51], v[216:217] op_sel_hi:[1,0]
    v_pk_fma_f32 v[48:49], v[48:49], v[128:129], v[206:207] op_sel_hi:[1,0,0]
    v_pk_fma_f32 v[50:51], v[50:51], v[128:129], v[206:207] op_sel_hi:[1,0,0]
    v_exp_f32_e64 v184, v184 clamp
    v_exp_f32_e64 v185, v185 clamp
    v_exp_f32_e64 v186, v186 clamp
    v_exp_f32_e64 v187, v187 clamp
    v_max_f32 v48, s59, v48
    v_max_f32 v49, s59, v49
    v_max_f32 v50, s59, v50
    v_max_f32 v51, s59, v51
    v_pk_add_f32 v[48:49], v[48:49], v[184:185]
    v_pk_add_f32 v[50:51], v[50:51], v[186:187]
    v_cvt_pk_bf16_f32 v164, v48, v49
    v_cvt_pk_bf16_f32 v165, v50, v51
    v_pk_fma_f32 v[64:65], v[148:149], v[112:113], v[64:65] op_sel_hi:[1,0,1]
    v_pk_fma_f32 v[66:67], v[150:151], v[112:113], v[66:67] op_sel_hi:[1,0,1]
    v_pk_mul_f32 v[188:189], v[64:65], v[216:217] op_sel_hi:[1,0]
    v_pk_mul_f32 v[190:191], v[66:67], v[216:217] op_sel_hi:[1,0]
    v_pk_fma_f32 v[64:65], v[64:65], v[128:129], v[206:207] op_sel_hi:[1,0,0]
    v_pk_fma_f32 v[66:67], v[66:67], v[128:129], v[206:207] op_sel_hi:[1,0,0]
    v_exp_f32_e64 v188, v188 clamp
    v_exp_f32_e64 v189, v189 clamp
    v_exp_f32_e64 v190, v190 clamp
    v_exp_f32_e64 v191, v191 clamp
    v_max_f32 v64, s59, v64
    v_max_f32 v65, s59, v65
    v_max_f32 v66, s59, v66
    v_max_f32 v67, s59, v67
    v_pk_add_f32 v[64:65], v[64:65], v[188:189]
    v_pk_add_f32 v[66:67], v[66:67], v[190:191]
    v_cvt_pk_bf16_f32 v166, v64, v65
    v_cvt_pk_bf16_f32 v167, v66, v67
    v_pk_fma_f32 v[80:81], v[152:153], v[112:113], v[80:81] op_sel_hi:[1,0,1]
    v_pk_fma_f32 v[82:83], v[154:155], v[112:113], v[82:83] op_sel_hi:[1,0,1]
    v_pk_mul_f32 v[184:185], v[80:81], v[216:217] op_sel_hi:[1,0]
    v_pk_mul_f32 v[186:187], v[82:83], v[216:217] op_sel_hi:[1,0]
    v_pk_fma_f32 v[80:81], v[80:81], v[128:129], v[206:207] op_sel_hi:[1,0,0]
    v_pk_fma_f32 v[82:83], v[82:83], v[128:129], v[206:207] op_sel_hi:[1,0,0]
    v_exp_f32_e64 v184, v184 clamp
    v_exp_f32_e64 v185, v185 clamp
    v_exp_f32_e64 v186, v186 clamp
    v_exp_f32_e64 v187, v187 clamp
    v_max_f32 v80, s59, v80
    v_max_f32 v81, s59, v81
    v_max_f32 v82, s59, v82
    v_max_f32 v83, s59, v83
    v_pk_add_f32 v[80:81], v[80:81], v[184:185]
    v_pk_add_f32 v[82:83], v[82:83], v[186:187]
    v_cvt_pk_bf16_f32 v168, v80, v81
    v_cvt_pk_bf16_f32 v169, v82, v83
    s_mov_b32 s56, 7380992
    buffer_store_dwordx4 v[160:163], v201, s[36:39], s56 offen sc1
    buffer_store_dwordx4 v[164:167], v201, s[36:39], s56 offen offset:1024 sc1
    buffer_store_dwordx2 v[168:169], v202, s[36:39], s56 offen offset:2048 sc1
    v_pk_fma_f32 v[20:21], v[136:137], v[116:117], v[20:21] op_sel_hi:[1,0,1]
    v_pk_fma_f32 v[22:23], v[138:139], v[116:117], v[22:23] op_sel_hi:[1,0,1]
    v_pk_mul_f32 v[184:185], v[20:21], v[218:219] op_sel_hi:[1,0]
    v_pk_mul_f32 v[186:187], v[22:23], v[218:219] op_sel_hi:[1,0]
    v_pk_fma_f32 v[20:21], v[20:21], v[132:133], v[206:207] op_sel_hi:[1,0,0]
    v_pk_fma_f32 v[22:23], v[22:23], v[132:133], v[206:207] op_sel_hi:[1,0,0]
    v_exp_f32_e64 v184, v184 clamp
    v_exp_f32_e64 v185, v185 clamp
    v_exp_f32_e64 v186, v186 clamp
    v_exp_f32_e64 v187, v187 clamp
    v_max_f32 v20, s59, v20
    v_max_f32 v21, s59, v21
    v_max_f32 v22, s59, v22
    v_max_f32 v23, s59, v23
    v_pk_add_f32 v[20:21], v[20:21], v[184:185]
    v_pk_add_f32 v[22:23], v[22:23], v[186:187]
    v_cvt_pk_bf16_f32 v172, v20, v21
    v_cvt_pk_bf16_f32 v173, v22, v23
    v_pk_fma_f32 v[36:37], v[140:141], v[116:117], v[36:37] op_sel_hi:[1,0,1]
    v_pk_fma_f32 v[38:39], v[142:143], v[116:117], v[38:39] op_sel_hi:[1,0,1]
    v_pk_mul_f32 v[188:189], v[36:37], v[218:219] op_sel_hi:[1,0]
    v_pk_mul_f32 v[190:191], v[38:39], v[218:219] op_sel_hi:[1,0]
    v_pk_fma_f32 v[36:37], v[36:37], v[132:133], v[206:207] op_sel_hi:[1,0,0]
    v_pk_fma_f32 v[38:39], v[38:39], v[132:133], v[206:207] op_sel_hi:[1,0,0]
    v_exp_f32_e64 v188, v188 clamp
    v_exp_f32_e64 v189, v189 clamp
    v_exp_f32_e64 v190, v190 clamp
    v_exp_f32_e64 v191, v191 clamp
    v_max_f32 v36, s59, v36
    v_max_f32 v37, s59, v37
    v_max_f32 v38, s59, v38
    v_max_f32 v39, s59, v39
    v_pk_add_f32 v[36:37], v[36:37], v[188:189]
    v_pk_add_f32 v[38:39], v[38:39], v[190:191]
    v_cvt_pk_bf16_f32 v174, v36, v37
    v_cvt_pk_bf16_f32 v175, v38, v39
    v_pk_fma_f32 v[52:53], v[144:145], v[116:117], v[52:53] op_sel_hi:[1,0,1]
    v_pk_fma_f32 v[54:55], v[146:147], v[116:117], v[54:55] op_sel_hi:[1,0,1]
    v_pk_mul_f32 v[184:185], v[52:53], v[218:219] op_sel_hi:[1,0]
    v_pk_mul_f32 v[186:187], v[54:55], v[218:219] op_sel_hi:[1,0]
    v_pk_fma_f32 v[52:53], v[52:53], v[132:133], v[206:207] op_sel_hi:[1,0,0]
    v_pk_fma_f32 v[54:55], v[54:55], v[132:133], v[206:207] op_sel_hi:[1,0,0]
    v_exp_f32_e64 v184, v184 clamp
    v_exp_f32_e64 v185, v185 clamp
    v_exp_f32_e64 v186, v186 clamp
    v_exp_f32_e64 v187, v187 clamp
    v_max_f32 v52, s59, v52
    v_max_f32 v53, s59, v53
    v_max_f32 v54, s59, v54
    v_max_f32 v55, s59, v55
    v_pk_add_f32 v[52:53], v[52:53], v[184:185]
    v_pk_add_f32 v[54:55], v[54:55], v[186:187]
    v_cvt_pk_bf16_f32 v176, v52, v53
    v_cvt_pk_bf16_f32 v177, v54, v55
    v_pk_fma_f32 v[68:69], v[148:149], v[116:117], v[68:69] op_sel_hi:[1,0,1]
    v_pk_fma_f32 v[70:71], v[150:151], v[116:117], v[70:71] op_sel_hi:[1,0,1]
    v_pk_mul_f32 v[188:189], v[68:69], v[218:219] op_sel_hi:[1,0]
    v_pk_mul_f32 v[190:191], v[70:71], v[218:219] op_sel_hi:[1,0]
    v_pk_fma_f32 v[68:69], v[68:69], v[132:133], v[206:207] op_sel_hi:[1,0,0]
    v_pk_fma_f32 v[70:71], v[70:71], v[132:133], v[206:207] op_sel_hi:[1,0,0]
    v_exp_f32_e64 v188, v188 clamp
    v_exp_f32_e64 v189, v189 clamp
    v_exp_f32_e64 v190, v190 clamp
    v_exp_f32_e64 v191, v191 clamp
    v_max_f32 v68, s59, v68
    v_max_f32 v69, s59, v69
    v_max_f32 v70, s59, v70
    v_max_f32 v71, s59, v71
    v_pk_add_f32 v[68:69], v[68:69], v[188:189]
    v_pk_add_f32 v[70:71], v[70:71], v[190:191]
    v_cvt_pk_bf16_f32 v178, v68, v69
    v_cvt_pk_bf16_f32 v179, v70, v71
    v_pk_fma_f32 v[84:85], v[152:153], v[116:117], v[84:85] op_sel_hi:[1,0,1]
    v_pk_fma_f32 v[86:87], v[154:155], v[116:117], v[86:87] op_sel_hi:[1,0,1]
    v_pk_mul_f32 v[184:185], v[84:85], v[218:219] op_sel_hi:[1,0]
    v_pk_mul_f32 v[186:187], v[86:87], v[218:219] op_sel_hi:[1,0]
    v_pk_fma_f32 v[84:85], v[84:85], v[132:133], v[206:207] op_sel_hi:[1,0,0]
    v_pk_fma_f32 v[86:87], v[86:87], v[132:133], v[206:207] op_sel_hi:[1,0,0]
    v_exp_f32_e64 v184, v184 clamp
    v_exp_f32_e64 v185, v185 clamp
    v_exp_f32_e64 v186, v186 clamp
    v_exp_f32_e64 v187, v187 clamp
    v_max_f32 v84, s59, v84
    v_max_f32 v85, s59, v85
    v_max_f32 v86, s59, v86
    v_max_f32 v87, s59, v87
    v_pk_add_f32 v[84:85], v[84:85], v[184:185]
    v_pk_add_f32 v[86:87], v[86:87], v[186:187]
    v_cvt_pk_bf16_f32 v180, v84, v85
    v_cvt_pk_bf16_f32 v181, v86, v87
    s_mov_b32 s56, 7401472
    buffer_store_dwordx4 v[172:175], v201, s[36:39], s56 offen sc1
    buffer_store_dwordx4 v[176:179], v201, s[36:39], s56 offen offset:1024 sc1
    buffer_store_dwordx2 v[180:181], v202, s[36:39], s56 offen offset:2048 sc1
    s_branch L_k1_done
L_k1_K:
    s_and_b32 s59, s3, 3
    s_mov_b32 s42, s59
    s_lshr_b32 s43, s3, 2
    s_lshl_b32 s56, s59, 3
    s_add_u32 s56, s56, s40
    v_lshrrev_b32 v200, 3, v0
    v_add_u32 v200, s56, v200
    v_mul_u32_u24 v200, 1280, v200
    s_and_b32 s56, s3, 1
    s_lshl_b32 s56, s56, 2
    v_lshrrev_b32 v201, 4, v0
    v_add_u32 v201, s56, v201
    v_xor_b32 v201, v201, v0
    v_and_b32 v201, 7, v201
    v_lshl_add_u32 v188, v201, 4, v200
    v_add_u32 v189, 40960, v188
    v_add_u32 v190, 81920, v188
    v_add_u32 v191, 122880, v188
    s_lshl_b32 s48, s59, 10
    s_add_u32 s49, s48, 49152
    s_mul_i32 s44, s70, 245760
    s_mov_b32 s45, s48
    s_lshl_b32 s46, s70, 7
    s_mov_b32 s47, s49
    s_lshl_b32 s56, s59, 6
    s_add_u32 s56, s56, 0
    v_add_u32 v200, s56, v0
    v_mul_u32_u24 v201, 2979, v200
    v_lshrrev_b32 v201, 16, v201
    v_mul_u32_u24 v202, 22, v201
    v_sub_u32 v202, v200, v202
    v_and_b32 v203, 0x13, v201
    v_bfe_u32 v204, v201, 2, 1
    v_lshl_or_b32 v203, v204, 3, v203
    v_bfe_u32 v204, v201, 3, 1
    v_lshl_or_b32 v203, v204, 2, v203
    v_mul_u32_u24 v203, 3840, v203
    v_lshl_add_u32 v203, v202, 4, v203
    v_cmp_le_u32 vcc, 10, v202
    v_mov_b32 v204, 1120
    s_nop 0
    v_cndmask_b32 v204, 0, v204, vcc
    v_add_u32 v203, v203, v204
    s_mul_i32 s56, s41, 160
    s_add_u32 s56, s56, 1280
    v_add_u32 v203, s56, v203
    v_cmp_gt_u32 vcc, 20, v202
    v_cmp_gt_u32 s[60:61], 32, v201
    v_mov_b32 v204, 2146435072
    s_and_b64 vcc, vcc, s[60:61]
    v_cndmask_b32 v184, v204, v203, vcc
    s_lshl_b32 s56, s59, 6
    s_add_u32 s56, s56, 256
    v_add_u32 v200, s56, v0
    v_mul_u32_u24 v201, 2979, v200
    v_lshrrev_b32 v201, 16, v201
    v_mul_u32_u24 v202, 22, v201
    v_sub_u32 v202, v200, v202
    v_and_b32 v203, 0x13, v201
    v_bfe_u32 v204, v201, 2, 1
    v_lshl_or_b32 v203, v204, 3, v203
    v_bfe_u32 v204, v201, 3, 1
    v_lshl_or_b32 v203, v204, 2, v203
    v_mul_u32_u24 v203, 3840, v203
    v_lshl_add_u32 v203, v202, 4, v203
    v_cmp_le_u32 vcc, 10, v202
    v_mov_b32 v204, 1120
    s_nop 0
    v_cndmask_b32 v204, 0, v204, vcc
    v_add_u32 v203, v203, v204
    s_mul_i32 s56, s41, 160
    s_add_u32 s56, s56, 1280
    v_add_u32 v203, s56, v203
    v_cmp_gt_u32 vcc, 20, v202
    v_cmp_gt_u32 s[60:61], 32, v201
    v_mov_b32 v204, 2146435072
    s_and_b64 vcc, vcc, s[60:61]
    v_cndmask_b32 v185, v204, v203, vcc
    s_lshl_b32 s56, s59, 6
    s_add_u32 s56, s56, 512
    v_add_u32 v200, s56, v0
    v_mul_u32_u24 v201, 2979, v200
    v_lshrrev_b32 v201, 16, v201
    v_mul_u32_u24 v202, 22, v201
    v_sub_u32 v202, v200, v202
    v_and_b32 v203, 0x13, v201
    v_bfe_u32 v204, v201, 2, 1
    v_lshl_or_b32 v203, v204, 3, v203
    v_bfe_u32 v204, v201, 3, 1
    v_lshl_or_b32 v203, v204, 2, v203
    v_mul_u32_u24 v203, 3840, v203
    v_lshl_add_u32 v203, v202, 4, v203
    v_cmp_le_u32 vcc, 10, v202
    v_mov_b32 v204, 1120
    s_nop 0
    v_cndmask_b32 v204, 0, v204, vcc
    v_add_u32 v203, v203, v204
    s_mul_i32 s56, s41, 160
    s_add_u32 s56, s56, 1280
    v_add_u32 v203, s56, v203
    v_cmp_gt_u32 vcc, 20, v202
    v_cmp_gt_u32 s[60:61], 32, v201
    v_mov_b32 v204, 2146435072
    s_and_b64 vcc, vcc, s[60:61]
    v_cndmask_b32 v186, v204, v203, vcc
    s_waitcnt lgkmcnt(0)
    s_mov_b32 s20, s4
    s_mov_b32 s21, s5
    s_mov_b32 s22, 2621440
    s_mov_b32 s23, 0x20000
    s_mov_b32 s24, s6
    s_mov_b32 s25, s7
    s_mov_b32 s26, 2457600
    s_mov_b32 s27, 0x20000
    s_cmp_ge_u32 s3, 4
    s_cbranch_scc1 L_k1_K_bpro
    s_add_u32 m0, s47, 0
    s_nop 0
    buffer_load_dwordx4 v188, s[20:23], s46 offen lds
    s_add_u32 m0, s47, 4096
    s_nop 0
    buffer_load_dwordx4 v189, s[20:23], s46 offen lds
    s_add_u32 m0, s47, 8192
    s_nop 0
    buffer_load_dwordx4 v190, s[20:23], s46 offen lds
    s_add_u32 m0, s47, 12288
    s_nop 0
    buffer_load_dwordx4 v191, s[20:23], s46 offen lds
    s_add_u32 s47, s47, 16384
    s_add_u32 s46, s46, 163840
    s_add_u32 m0, s48, 0
    s_nop 0
    buffer_load_dwordx4 v184, s[24:27], s44 offen lds
    s_add_u32 m0, s48, 4096
    s_nop 0
    buffer_load_dwordx4 v185, s[24:27], s44 offen lds
    s_add_u32 m0, s48, 8192
    s_nop 0
    buffer_load_dwordx4 v186, s[24:27], s44 offen lds
    s_add_u32 s44, s44, 122880
    s_cmp_eq_u32 s44, 2457600
    s_cselect_b32 s44, 0, s44
    s_add_u32 m0, s47, 0
    s_nop 0
    buffer_load_dwordx4 v188, s[20:23], s46 offen lds
    s_add_u32 m0, s47, 4096
    s_nop 0
    buffer_load_dwordx4 v189, s[20:23], s46 offen lds
    s_add_u32 m0, s47, 8192
    s_nop 0
    buffer_load_dwordx4 v190, s[20:23], s46 offen lds
    s_add_u32 m0, s47, 12288
    s_nop 0
    buffer_load_dwordx4 v191, s[20:23], s46 offen lds
    s_add_u32 s47, s47, 16384
    s_sub_u32 s46, s46, 163712
    s_cmp_ge_u32 s47, 147456
    s_cselect_b32 s47, s49, s47
    s_cmp_eq_u32 s46, 1280
    s_cselect_b32 s46, 0, s46
    s_add_u32 m0, s48, 12288
    s_nop 0
    buffer_load_dwordx4 v184, s[24:27], s44 offen lds
    s_add_u32 m0, s48, 16384
    s_nop 0
    buffer_load_dwordx4 v185, s[24:27], s44 offen lds
    s_add_u32 m0, s48, 20480
    s_nop 0
    buffer_load_dwordx4 v186, s[24:27], s44 offen lds
    s_add_u32 m0, s47, 0
    s_nop 0
    buffer_load_dwordx4 v188, s[20:23], s46 offen lds
    s_add_u32 m0, s47, 4096
    s_nop 0
    buffer_load_dwordx4 v189, s[20:23], s46 offen lds
    s_add_u32 m0, s47, 8192
    s_nop 0
    buffer_load_dwordx4 v190, s[20:23], s46 offen lds
    s_add_u32 m0, s47, 12288
    s_nop 0
    buffer_load_dwordx4 v191, s[20:23], s46 offen lds
    s_add_u32 s44, s44, 122880
    s_cmp_eq_u32 s44, 2457600
    s_cselect_b32 s44, 0, s44
    s_add_u32 s44, s44, 122880
    s_cmp_eq_u32 s44, 2457600
    s_cselect_b32 s44, 0, s44
    s_add_u32 s44, s44, 122880
    s_cmp_eq_u32 s44, 2457600
    s_cselect_b32 s44, 0, s44
    s_add_u32 s47, s47, 16384
    s_add_u32 s46, s46, 163840
    s_add_u32 s47, s47, 16384
    s_sub_u32 s46, s46, 163712
    s_cmp_ge_u32 s47, 147456
    s_cselect_b32 s47, s49, s47
    s_cmp_eq_u32 s46, 1280
    s_cselect_b32 s46, 0, s46
    s_add_u32 s47, s47, 16384
    s_add_u32 s46, s46, 163840
L_k1_K_bpro:
L_k1_K_common:
    s_mov_b32 s36, s16
    s_mov_b32 s37, s17
    s_mov_b32 s38, 33554432
    s_mov_b32 s39, 0x20000
    s_mov_b32 s28, s18
    s_mov_b32 s29, s19
    s_mov_b32 s30, 256
    s_mov_b32 s31, 0x20000
    s_and_b32 s71, s3, 3
    s_lshl_b32 s72, s67, 2
    s_add_u32 s71, s71, s72
    s_lshr_b32 s72, s71, 3
    s_and_b32 s73, s71, 7
    s_mov_b32 s66, s73
    s_mul_i32 s64, s73, 21504
    s_lshl_b32 s65, s72, 8
    s_add_u32 s64, s64, s65
    s_add_u32 s64, s64, 16334848
    s_cmp_lt_u32 s72, 57
    s_cselect_b32 s76, s12, s14
    s_cselect_b32 s77, s13, s15
    s_cselect_b32 s62, 30, 57
    s_mov_b32 s78, 2211840
    s_movk_i32 s63, 3456
    s_cmp_lt_u32 s72, 30
    s_cselect_b32 s76, s6, s76
    s_cselect_b32 s77, s7, s77
    s_cselect_b32 s62, 0, s62
    s_cselect_b32 s78, 2457600, s78
    s_cselect_b32 s63, 3840, s63
    s_mov_b32 s79, 0x20000
    s_sub_u32 s72, s72, s62
    s_lshl_b32 s72, s72, 7
    s_mul_i32 s73, s73, 80
    s_mul_i32 s73, s73, s63
    s_add_u32 s72, s72, s73
    s_lshl_b32 s73, s63, 3
    s_cmp_ge_u32 s71, 672
    s_cselect_b32 s72, 2146435072, s72
    v_lshrrev_b32 v2, 3, v0
    v_and_b32 v3, 7, v0
    v_mul_u32_u24 v1, s63, v2
    v_lshl_add_u32 v1, v3, 4, v1
    v_and_b32 v2, 15, v0
    v_and_b32 v3, 1, v0
    v_lshlrev_b32 v3, 4, v3
    v_mov_b32 v4, 0x3f80
    v_lshlrev_b32 v3, v3, v4
    v_lshrrev_b32 v2, 1, v2
    v_cmp_eq_u32 vcc, 0, v2
    s_nop 1
    v_cndmask_b32 v4, 0, v3, vcc
    v_cmp_eq_u32 vcc, 1, v2
    s_nop 1
    v_cndmask_b32 v5, 0, v3, vcc
    v_cmp_eq_u32 vcc, 2, v2
    s_nop 1
    v_cndmask_b32 v6, 0, v3, vcc
    v_cmp_eq_u32 vcc, 3, v2
    s_nop 1
    v_cndmask_b32 v7, 0, v3, vcc
    s_cmp_ge_u32 s71, 672
    s_cselect_b32 s71, 2146435072, s64
    v_bfe_u32 v2, v0, 4, 1
    v_lshlrev_b32 v2, 7, v2
    v_and_b32 v3, 7, v0
    v_lshl_add_u32 v2, v3, 2, v2
    s_lshl_b32 s95, s41, 7
    s_lshr_b32 s56, s40, 6
    s_add_u32 s95, s95, s56
    s_add_u32 s95, s95, 16254976
    s_mov_b32 s75, 0
    v_and_b32 v200, 15, v0
    v_lshrrev_b32 v201, 4, v0
    v_lshrrev_b32 v202, 1, v200
    v_xor_b32 v202, v202, v201
    s_lshl_b32 s56, s42, 13
    v_lshlrev_b32 v203, 7, v200
    v_add_u32 v203, s56, v203
    v_lshl_add_u32 v192, v202, 4, v203
    v_xor_b32 v193, 64, v192
    v_lshrrev_b32 v202, 5, v0
    v_lshlrev_b32 v202, 4, v202
    v_bfe_u32 v203, v0, 4, 1
    v_lshl_or_b32 v202, v203, 2, v202
    v_bfe_u32 v203, v0, 2, 2
    v_or_b32 v202, v202, v203
    v_mul_u32_u24 v203, 352, v202
    v_and_b32 v204, 3, v0
    s_mul_i32 s56, s43, 80
    v_add_u32 v203, s56, v203
    v_lshl_add_u32 v194, v204, 3, v203
    v_and_b32 v202, 1, v204
    v_mul_u32_u24 v202, 40, v202
    v_add_u32 v203, v202, v203
    v_lshrrev_b32 v204, 1, v204
    v_xor_b32 v204, s43, v204
    v_mul_u32_u24 v204, 160, v204
    v_add_u32 v195, v204, v203
    v_mov_b32 v8, 0
    v_mov_b32 v9, 0
    v_mov_b32 v10, 0
    v_mov_b32 v11, 0
    v_mov_b32 v12, 0
    v_mov_b32 v13, 0
    v_mov_b32 v14, 0
    v_mov_b32 v15, 0
    v_mov_b32 v16, 0
    v_mov_b32 v17, 0
    v_mov_b32 v18, 0
    v_mov_b32 v19, 0
    v_mov_b32 v20, 0
    v_mov_b32 v21, 0
    v_mov_b32 v22, 0
    v_mov_b32 v23, 0
    v_mov_b32 v24, 0
    v_mov_b32 v25, 0
    v_mov_b32 v26, 0
    v_mov_b32 v27, 0
    v_mov_b32 v28, 0
    v_mov_b32 v29, 0
    v_mov_b32 v30, 0
    v_mov_b32 v31, 0
    v_mov_b32 v32, 0
    v_mov_b32 v33, 0
    v_mov_b32 v34, 0
    v_mov_b32 v35, 0
    v_mov_b32 v36, 0
    v_mov_b32 v37, 0
    v_mov_b32 v38, 0
    v_mov_b32 v39, 0
    v_mov_b32 v40, 0
    v_mov_b32 v41, 0
    v_mov_b32 v42, 0
    v_mov_b32 v43, 0
    v_mov_b32 v44, 0
    v_mov_b32 v45, 0
    v_mov_b32 v46, 0
    v_mov_b32 v47, 0
    v_mov_b32 v48, 0
    v_mov_b32 v49, 0
    v_mov_b32 v50, 0
    v_mov_b32 v51, 0
    v_mov_b32 v52, 0
    v_mov_b32 v53, 0
    v_mov_b32 v54, 0
    v_mov_b32 v55, 0
    v_mov_b32 v56, 0
    v_mov_b32 v57, 0
    v_mov_b32 v58, 0
    v_mov_b32 v59, 0
    v_mov_b32 v60, 0
    v_mov_b32 v61, 0
    v_mov_b32 v62, 0
    v_mov_b32 v63, 0
    v_mov_b32 v64, 0
    v_mov_b32 v65, 0
    v_mov_b32 v66, 0
    v_mov_b32 v67, 0
    v_mov_b32 v68, 0
    v_mov_b32 v69, 0
    v_mov_b32 v70, 0
    v_mov_b32 v71, 0
    v_mov_b32 v72, 0
    v_mov_b32 v73, 0
    v_mov_b32 v74, 0
    v_mov_b32 v75, 0
    v_mov_b32 v76, 0
    v_mov_b32 v77, 0
    v_mov_b32 v78, 0
    v_mov_b32 v79, 0
    v_mov_b32 v80, 0
    v_mov_b32 v81, 0
    v_mov_b32 v82, 0
    v_mov_b32 v83, 0
    v_mov_b32 v84, 0
    v_mov_b32 v85, 0
    v_mov_b32 v86, 0
    v_mov_b32 v87, 0
    v_lshlrev_b32 v200, 4, v0
    s_lshl_b32 s56, s59, 10
    s_add_u32 s56, s56, 147456
    v_add_u32 v201, s56, v200
    v_and_b32 v202, 15, v0
    v_lshlrev_b32 v202, 2, v202
    v_and_b32 v205, 7, v0
    v_lshlrev_b32 v205, 5, v205
    s_movk_i32 s69, 21504
    s_cmp_lt_u32 s59, 2
    s_cselect_b32 s69, 268304384, s69
    s_lshl_b32 s68, s40, 2
    s_add_u32 s68, s68, 16318464
    s_add_u32 s56, s68, 8192
    s_cmp_eq_u32 s59, 1
    s_cselect_b32 s68, s56, s68
    s_mul_i32 s56, s41, 320
    s_add_u32 s57, s56, 16337408
    s_cmp_eq_u32 s59, 2
    s_cselect_b32 s68, s57, s68
    s_add_u32 s57, s56, 16339968
    s_cmp_eq_u32 s59, 3
    s_cselect_b32 s68, s57, s68
    s_mov_b32 s52, 0
    s_mov_b32 s53, 49152
    s_mov_b32 s54, 0
    s_mov_b32 s74, 24576
    s_cmp_ge_u32 s3, 4
    s_cbranch_scc1 L_k1_K_pre1
L_k1_K_pre0:
    s_waitcnt vmcnt(0)
    s_barrier
    v_add_u32 v197, s53, v192
    ds_read_b128 v[104:107], v197 offset:0
    ds_read_b128 v[108:111], v197 offset:2048
    ds_read_b128 v[112:115], v197 offset:4096
    ds_read_b128 v[116:119], v197 offset:6144
    ds_read_b64_tr_b16 v[136:137], v194 offset:0
    ds_read_b64_tr_b16 v[138:139], v194 offset:2816
    ds_read_b64_tr_b16 v[140:141], v194 offset:40
    ds_read_b64_tr_b16 v[142:143], v194 offset:2856
    ds_read_b64_tr_b16 v[144:145], v194 offset:160
    ds_read_b64_tr_b16 v[146:147], v194 offset:2976
    ds_read_b64_tr_b16 v[148:149], v194 offset:200
    ds_read_b64_tr_b16 v[150:151], v194 offset:3016
    ds_read_b64_tr_b16 v[152:153], v195 offset:32
    ds_read_b64_tr_b16 v[154:155], v195 offset:2848
.p2align 3
L_k1_K_loop0:
    s_waitcnt lgkmcnt(8)
    v_mfma_f32_16x16x32_bf16 v[8:11], v[104:107], v[136:139], v[8:11]
    v_mfma_f32_16x16x32_bf16 v[12:15], v[108:111], v[136:139], v[12:15]
    s_cmp_eq_u32 s54, 8
    s_cselect_b32 s44, 2146435072, s44
    v_mfma_f32_16x16x32_bf16 v[16:19], v[112:115], v[136:139], v[16:19]
    v_mfma_f32_16x16x32_bf16 v[20:23], v[116:119], v[136:139], v[20:23]
    s_waitcnt lgkmcnt(6)
    v_mfma_f32_16x16x32_bf16 v[24:27], v[104:107], v[140:143], v[24:27]
    v_mfma_f32_16x16x32_bf16 v[28:31], v[108:111], v[140:143], v[28:31]
    v_mfma_f32_16x16x32_bf16 v[32:35], v[112:115], v[140:143], v[32:35]
    v_mfma_f32_16x16x32_bf16 v[36:39], v[116:119], v[140:143], v[36:39]
    s_waitcnt lgkmcnt(0) vmcnt(14)
    s_barrier
    v_add_u32 v197, s53, v193
    v_mfma_f32_16x16x32_bf16 v[40:43], v[104:107], v[144:147], v[40:43]
    ds_read_b128 v[120:123], v197 offset:0
    ds_read_b128 v[124:127], v197 offset:2048
    v_mfma_f32_16x16x32_bf16 v[44:47], v[108:111], v[144:147], v[44:47]
    ds_read_b128 v[128:131], v197 offset:4096
    ds_read_b128 v[132:135], v197 offset:6144
    v_mfma_f32_16x16x32_bf16 v[48:51], v[112:115], v[144:147], v[48:51]
    ds_read_b64_tr_b16 v[160:161], v194 offset:12288
    ds_read_b64_tr_b16 v[162:163], v194 offset:15104
    v_mfma_f32_16x16x32_bf16 v[52:55], v[116:119], v[144:147], v[52:55]
    ds_read_b64_tr_b16 v[164:165], v194 offset:12328
    ds_read_b64_tr_b16 v[166:167], v194 offset:15144
    s_add_u32 m0, s45, 0
    v_mfma_f32_16x16x32_bf16 v[56:59], v[104:107], v[148:151], v[56:59]
    buffer_load_dwordx4 v184, s[24:27], s44 offen lds
    ds_read_b64_tr_b16 v[168:169], v194 offset:12448
    ds_read_b64_tr_b16 v[170:171], v194 offset:15264
    s_add_u32 m0, s45, 4096
    v_mfma_f32_16x16x32_bf16 v[60:63], v[108:111], v[148:151], v[60:63]
    buffer_load_dwordx4 v185, s[24:27], s44 offen lds
    ds_read_b64_tr_b16 v[172:173], v194 offset:12488
    ds_read_b64_tr_b16 v[174:175], v194 offset:15304
    s_add_u32 m0, s45, 8192
    v_mfma_f32_16x16x32_bf16 v[64:67], v[112:115], v[148:151], v[64:67]
    buffer_load_dwordx4 v186, s[24:27], s44 offen lds
    ds_read_b64_tr_b16 v[176:177], v195 offset:12320
    s_add_u32 m0, s47, 0
    v_mfma_f32_16x16x32_bf16 v[68:71], v[116:119], v[148:151], v[68:71]
    buffer_load_dwordx4 v188, s[20:23], s46 offen lds
    ds_read_b64_tr_b16 v[178:179], v195 offset:15136
    s_add_u32 m0, s47, 4096
    v_mfma_f32_16x16x32_bf16 v[72:75], v[104:107], v[152:155], v[72:75]
    buffer_load_dwordx4 v189, s[20:23], s46 offen lds
    s_add_u32 m0, s47, 8192
    v_mfma_f32_16x16x32_bf16 v[76:79], v[108:111], v[152:155], v[76:79]
    buffer_load_dwordx4 v190, s[20:23], s46 offen lds
    s_add_u32 m0, s47, 12288
    v_mfma_f32_16x16x32_bf16 v[80:83], v[112:115], v[152:155], v[80:83]
    buffer_load_dwordx4 v191, s[20:23], s46 offen lds
    s_add_u32 s53, s53, 32768
    s_cmp_eq_u32 s53, 147456
    s_cselect_b32 s53, 49152, s53
    v_mfma_f32_16x16x32_bf16 v[84:87], v[116:119], v[152:155], v[84:87]
    s_add_u32 s44, s44, 122880
    s_cmp_eq_u32 s44, 2457600
    s_cselect_b32 s44, 0, s44
    s_add_u32 s47, s47, 16384
    s_sub_u32 s46, s46, 163712
    s_cmp_ge_u32 s47, 147456
    s_cselect_b32 s47, s49, s47
    s_cmp_eq_u32 s46, 1280
    s_cselect_b32 s46, 0, s46
    s_cmp_eq_u32 s54, 7
    s_cselect_b32 s46, 2146435072, s46
    s_waitcnt lgkmcnt(8)
    v_mfma_f32_16x16x32_bf16 v[8:11], v[120:123], v[160:163], v[8:11]
    v_mfma_f32_16x16x32_bf16 v[12:15], v[124:127], v[160:163], v[12:15]
    v_mfma_f32_16x16x32_bf16 v[16:19], v[128:131], v[160:163], v[16:19]
    v_mfma_f32_16x16x32_bf16 v[20:23], v[132:135], v[160:163], v[20:23]
    s_waitcnt lgkmcnt(6)
    v_mfma_f32_16x16x32_bf16 v[24:27], v[120:123], v[164:167], v[24:27]
    v_mfma_f32_16x16x32_bf16 v[28:31], v[124:127], v[164:167], v[28:31]
    v_mfma_f32_16x16x32_bf16 v[32:35], v[128:131], v[164:167], v[32:35]
    v_mfma_f32_16x16x32_bf16 v[36:39], v[132:135], v[164:167], v[36:39]
    s_waitcnt lgkmcnt(0) vmcnt(14)
    s_barrier
    v_add_u32 v197, s53, v192
    v_add_u32 v194, s74, v194
    v_add_u32 v195, s74, v195
    v_mfma_f32_16x16x32_bf16 v[40:43], v[120:123], v[168:171], v[40:43]
    ds_read_b128 v[104:107], v197 offset:0
    ds_read_b128 v[108:111], v197 offset:2048
    v_mfma_f32_16x16x32_bf16 v[44:47], v[124:127], v[168:171], v[44:47]
    ds_read_b128 v[112:115], v197 offset:4096
    ds_read_b128 v[116:119], v197 offset:6144
    v_mfma_f32_16x16x32_bf16 v[48:51], v[128:131], v[168:171], v[48:51]
    ds_read_b64_tr_b16 v[136:137], v194 offset:0
    ds_read_b64_tr_b16 v[138:139], v194 offset:2816
    v_mfma_f32_16x16x32_bf16 v[52:55], v[132:135], v[168:171], v[52:55]
    ds_read_b64_tr_b16 v[140:141], v194 offset:40
    ds_read_b64_tr_b16 v[142:143], v194 offset:2856
    s_add_u32 m0, s45, 12288
    v_mfma_f32_16x16x32_bf16 v[56:59], v[120:123], v[172:175], v[56:59]
    buffer_load_dwordx4 v184, s[24:27], s44 offen lds
    ds_read_b64_tr_b16 v[144:145], v194 offset:160
    ds_read_b64_tr_b16 v[146:147], v194 offset:2976
    s_add_u32 m0, s45, 16384
    v_mfma_f32_16x16x32_bf16 v[60:63], v[124:127], v[172:175], v[60:63]
    buffer_load_dwordx4 v185, s[24:27], s44 offen lds
    ds_read_b64_tr_b16 v[148:149], v194 offset:200
    ds_read_b64_tr_b16 v[150:151], v194 offset:3016
    s_add_u32 m0, s45, 20480
    v_mfma_f32_16x16x32_bf16 v[64:67], v[128:131], v[172:175], v[64:67]
    buffer_load_dwordx4 v186, s[24:27], s44 offen lds
    ds_read_b64_tr_b16 v[152:153], v195 offset:32
    s_add_u32 m0, s47, 0
    v_mfma_f32_16x16x32_bf16 v[68:71], v[132:135], v[172:175], v[68:71]
    buffer_load_dwordx4 v188, s[20:23], s46 offen lds
    ds_read_b64_tr_b16 v[154:155], v195 offset:2848
    s_add_u32 m0, s47, 4096
    v_mfma_f32_16x16x32_bf16 v[72:75], v[120:123], v[176:179], v[72:75]
    buffer_load_dwordx4 v189, s[20:23], s46 offen lds
    s_add_u32 m0, s47, 8192
    v_mfma_f32_16x16x32_bf16 v[76:79], v[124:127], v[176:179], v[76:79]
    buffer_load_dwordx4 v190, s[20:23], s46 offen lds
    s_add_u32 m0, s47, 12288
    v_mfma_f32_16x16x32_bf16 v[80:83], v[128:131], v[176:179], v[80:83]
    buffer_load_dwordx4 v191, s[20:23], s46 offen lds
    s_add_u32 s44, s44, 122880
    s_cmp_eq_u32 s44, 2457600
    s_cselect_b32 s44, 0, s44
    v_mfma_f32_16x16x32_bf16 v[84:87], v[132:135], v[176:179], v[84:87]
    s_add_u32 s47, s47, 16384
    s_add_u32 s46, s46, 163840
    s_add_u32 s45, s45, s74
    s_sub_u32 s74, 0, s74
    s_add_u32 s54, s54, 1
    s_cmp_lt_u32 s54, 10
    s_cbranch_scc1 L_k1_K_loop0
    s_branch L_k1_K_epi
L_k1_K_pre1:
    s_add_u32 s44, s44, 122880
    s_cmp_eq_u32 s44, 2457600
    s_cselect_b32 s44, 0, s44
    s_add_u32 s44, s44, 122880
    s_cmp_eq_u32 s44, 2457600
    s_cselect_b32 s44, 0, s44
    s_add_u32 s47, s47, 16384
    s_add_u32 s46, s46, 163840
    s_add_u32 s47, s47, 16384
    s_sub_u32 s46, s46, 163712
    s_cmp_ge_u32 s47, 147456
    s_cselect_b32 s47, s49, s47
    s_cmp_eq_u32 s46, 1280
    s_cselect_b32 s46, 0, s46
    s_add_u32 s47, s47, 16384
    s_add_u32 s46, s46, 163840
    s_add_u32 m0, s48, 24576
    s_nop 0
    buffer_load_dwordx4 v184, s[24:27], s44 offen lds
    s_add_u32 m0, s48, 28672
    s_nop 0
    buffer_load_dwordx4 v185, s[24:27], s44 offen lds
    s_add_u32 m0, s48, 32768
    s_nop 0
    buffer_load_dwordx4 v186, s[24:27], s44 offen lds
    s_add_u32 s44, s44, 122880
    s_cmp_eq_u32 s44, 2457600
    s_cselect_b32 s44, 0, s44
    s_add_u32 m0, s47, 0
    s_nop 0
    buffer_load_dwordx4 v188, s[20:23], s46 offen lds
    s_add_u32 m0, s47, 4096
    s_nop 0
    buffer_load_dwordx4 v189, s[20:23], s46 offen lds
    s_add_u32 m0, s47, 8192
    s_nop 0
    buffer_load_dwordx4 v190, s[20:23], s46 offen lds
    s_add_u32 m0, s47, 12288
    s_nop 0
    buffer_load_dwordx4 v191, s[20:23], s46 offen lds
    s_add_u32 s47, s47, 16384
    s_sub_u32 s46, s46, 163712
    s_cmp_ge_u32 s47, 147456
    s_cselect_b32 s47, s49, s47
    s_cmp_eq_u32 s46, 1280
    s_cselect_b32 s46, 0, s46
    s_barrier
    v_add_u32 v197, s53, v192
    ds_read_b128 v[104:107], v197 offset:0
    ds_read_b128 v[108:111], v197 offset:2048
    ds_read_b128 v[112:115], v197 offset:4096
    ds_read_b128 v[116:119], v197 offset:6144
    ds_read_b64_tr_b16 v[136:137], v194 offset:0
    ds_read_b64_tr_b16 v[138:139], v194 offset:2816
    ds_read_b64_tr_b16 v[140:141], v194 offset:40
    ds_read_b64_tr_b16 v[142:143], v194 offset:2856
    ds_read_b64_tr_b16 v[144:145], v194 offset:160
    ds_read_b64_tr_b16 v[146:147], v194 offset:2976
    ds_read_b64_tr_b16 v[148:149], v194 offset:200
    ds_read_b64_tr_b16 v[150:151], v194 offset:3016
    ds_read_b64_tr_b16 v[152:153], v195 offset:32
    ds_read_b64_tr_b16 v[154:155], v195 offset:2848
    s_add_u32 m0, s48, 36864
    s_nop 0
    buffer_load_dwordx4 v184, s[24:27], s44 offen lds
    s_add_u32 m0, s48, 40960
    s_nop 0
    buffer_load_dwordx4 v185, s[24:27], s44 offen lds
    s_add_u32 m0, s48, 45056
    s_nop 0
    buffer_load_dwordx4 v186, s[24:27], s44 offen lds
    s_add_u32 m0, s47, 0
    s_nop 0
    buffer_load_dwordx4 v188, s[20:23], s46 offen lds
    s_add_u32 m0, s47, 4096
    s_nop 0
    buffer_load_dwordx4 v189, s[20:23], s46 offen lds
    s_add_u32 m0, s47, 8192
    s_nop 0
    buffer_load_dwordx4 v190, s[20:23], s46 offen lds
    s_add_u32 m0, s47, 12288
    s_nop 0
    buffer_load_dwordx4 v191, s[20:23], s46 offen lds
    s_cmp_lt_u32 s66, 5
    s_cbranch_scc0 L_ax_37
    buffer_load_dwordx4 v[212:215], v1, s[76:79], s72 offen
    s_add_u32 s72, s72, s73
    buffer_load_dwordx4 v[216:219], v1, s[76:79], s72 offen
    s_add_u32 s72, s72, s73
    buffer_load_dwordx4 v[220:223], v1, s[76:79], s72 offen
    s_add_u32 s72, s72, s73
    buffer_load_dwordx4 v[224:227], v1, s[76:79], s72 offen
    s_add_u32 s72, s72, s73
    buffer_load_dwordx4 v[228:231], v1, s[76:79], s72 offen
    s_add_u32 s72, s72, s73
    buffer_load_dwordx4 v[232:235], v1, s[76:79], s72 offen
    s_add_u32 s72, s72, s73
    buffer_load_dwordx4 v[236:239], v1, s[76:79], s72 offen
    s_add_u32 s72, s72, s73
    buffer_load_dwordx4 v[240:243], v1, s[76:79], s72 offen
    s_add_u32 s72, s72, s73
    buffer_load_dwordx4 v[184:187], v1, s[76:79], s72 offen
    s_add_u32 s72, s72, s73
    buffer_load_dwordx4 v[188:191], v1, s[76:79], s72 offen
L_ax_37:
.p2align 3
L_k1_K_loop1:
    s_waitcnt lgkmcnt(8)
    v_mfma_f32_16x16x32_bf16 v[8:11], v[104:107], v[136:139], v[8:11]
    v_mfma_f32_16x16x32_bf16 v[12:15], v[108:111], v[136:139], v[12:15]
    v_mfma_f32_16x16x32_bf16 v[16:19], v[112:115], v[136:139], v[16:19]
    v_mfma_f32_16x16x32_bf16 v[20:23], v[116:119], v[136:139], v[20:23]
    s_waitcnt lgkmcnt(6)
    v_mfma_f32_16x16x32_bf16 v[24:27], v[104:107], v[140:143], v[24:27]
    v_mfma_f32_16x16x32_bf16 v[28:31], v[108:111], v[140:143], v[28:31]
    v_mfma_f32_16x16x32_bf16 v[32:35], v[112:115], v[140:143], v[32:35]
    v_mfma_f32_16x16x32_bf16 v[36:39], v[116:119], v[140:143], v[36:39]
    s_waitcnt lgkmcnt(0)
    s_barrier
    v_add_u32 v197, s53, v193
    v_mfma_f32_16x16x32_bf16 v[40:43], v[104:107], v[144:147], v[40:43]
    ds_read_b128 v[120:123], v197 offset:0
    ds_read_b128 v[124:127], v197 offset:2048
    v_mfma_f32_16x16x32_bf16 v[44:47], v[108:111], v[144:147], v[44:47]
    ds_read_b128 v[128:131], v197 offset:4096
    ds_read_b128 v[132:135], v197 offset:6144
    v_mfma_f32_16x16x32_bf16 v[48:51], v[112:115], v[144:147], v[48:51]
    ds_read_b64_tr_b16 v[160:161], v194 offset:12288
    ds_read_b64_tr_b16 v[162:163], v194 offset:15104
    v_mfma_f32_16x16x32_bf16 v[52:55], v[116:119], v[144:147], v[52:55]
    ds_read_b64_tr_b16 v[164:165], v194 offset:12328
    ds_read_b64_tr_b16 v[166:167], v194 offset:15144
    v_mfma_f32_16x16x32_bf16 v[56:59], v[104:107], v[148:151], v[56:59]
    ds_read_b64_tr_b16 v[168:169], v194 offset:12448
    ds_read_b64_tr_b16 v[170:171], v194 offset:15264
    v_mfma_f32_16x16x32_bf16 v[60:63], v[108:111], v[148:151], v[60:63]
    ds_read_b64_tr_b16 v[172:173], v194 offset:12488
    ds_read_b64_tr_b16 v[174:175], v194 offset:15304
    v_mfma_f32_16x16x32_bf16 v[64:67], v[112:115], v[148:151], v[64:67]
    ds_read_b64_tr_b16 v[176:177], v195 offset:12320
    v_mfma_f32_16x16x32_bf16 v[68:71], v[116:119], v[148:151], v[68:71]
    ds_read_b64_tr_b16 v[178:179], v195 offset:15136
    v_mfma_f32_16x16x32_bf16 v[72:75], v[104:107], v[152:155], v[72:75]
    s_bitcmp1_b32 791, s54
    s_cbranch_scc1 L_k1_K_ev0
L_k1_K_evr0:
    v_mfma_f32_16x16x32_bf16 v[76:79], v[108:111], v[152:155], v[76:79]
    s_add_u32 s53, s53, 32768
    s_cmp_eq_u32 s53, 147456
    s_cselect_b32 s53, 49152, s53
    v_mfma_f32_16x16x32_bf16 v[80:83], v[112:115], v[152:155], v[80:83]
    v_mfma_f32_16x16x32_bf16 v[84:87], v[116:119], v[152:155], v[84:87]
    s_waitcnt lgkmcnt(8)
    v_mfma_f32_16x16x32_bf16 v[8:11], v[120:123], v[160:163], v[8:11]
    v_mfma_f32_16x16x32_bf16 v[12:15], v[124:127], v[160:163], v[12:15]
    v_mfma_f32_16x16x32_bf16 v[16:19], v[128:131], v[160:163], v[16:19]
    v_mfma_f32_16x16x32_bf16 v[20:23], v[132:135], v[160:163], v[20:23]
    s_waitcnt lgkmcnt(6)
    v_mfma_f32_16x16x32_bf16 v[24:27], v[120:123], v[164:167], v[24:27]
    v_mfma_f32_16x16x32_bf16 v[28:31], v[124:127], v[164:167], v[28:31]
    v_mfma_f32_16x16x32_bf16 v[32:35], v[128:131], v[164:167], v[32:35]
    v_mfma_f32_16x16x32_bf16 v[36:39], v[132:135], v[164:167], v[36:39]
    s_waitcnt lgkmcnt(0)
    s_barrier
    v_add_u32 v197, s53, v192
    v_add_u32 v194, s74, v194
    v_add_u32 v195, s74, v195
    v_mfma_f32_16x16x32_bf16 v[40:43], v[120:123], v[168:171], v[40:43]
    ds_read_b128 v[104:107], v197 offset:0
    ds_read_b128 v[108:111], v197 offset:2048
    v_mfma_f32_16x16x32_bf16 v[44:47], v[124:127], v[168:171], v[44:47]
    ds_read_b128 v[112:115], v197 offset:4096
    ds_read_b128 v[116:119], v197 offset:6144
    v_mfma_f32_16x16x32_bf16 v[48:51], v[128:131], v[168:171], v[48:51]
    ds_read_b64_tr_b16 v[136:137], v194 offset:0
    ds_read_b64_tr_b16 v[138:139], v194 offset:2816
    v_mfma_f32_16x16x32_bf16 v[52:55], v[132:135], v[168:171], v[52:55]
    ds_read_b64_tr_b16 v[140:141], v194 offset:40
    ds_read_b64_tr_b16 v[142:143], v194 offset:2856
    v_mfma_f32_16x16x32_bf16 v[56:59], v[120:123], v[172:175], v[56:59]
    ds_read_b64_tr_b16 v[144:145], v194 offset:160
    ds_read_b64_tr_b16 v[146:147], v194 offset:2976
    v_mfma_f32_16x16x32_bf16 v[60:63], v[124:127], v[172:175], v[60:63]
    ds_read_b64_tr_b16 v[148:149], v194 offset:200
    ds_read_b64_tr_b16 v[150:151], v194 offset:3016
    v_mfma_f32_16x16x32_bf16 v[64:67], v[128:131], v[172:175], v[64:67]
    ds_read_b64_tr_b16 v[152:153], v195 offset:32
    v_mfma_f32_16x16x32_bf16 v[68:71], v[132:135], v[172:175], v[68:71]
    ds_read_b64_tr_b16 v[154:155], v195 offset:2848
    v_mfma_f32_16x16x32_bf16 v[72:75], v[120:123], v[176:179], v[72:75]
    s_bitcmp1_b32 77, s54
    s_cbranch_scc1 L_k1_K_ev1
L_k1_K_evr1:
    v_mfma_f32_16x16x32_bf16 v[76:79], v[124:127], v[176:179], v[76:79]
    s_sub_u32 s74, 0, s74
    s_add_u32 s54, s54, 1
    v_mfma_f32_16x16x32_bf16 v[80:83], v[128:131], v[176:179], v[80:83]
    v_mfma_f32_16x16x32_bf16 v[84:87], v[132:135], v[176:179], v[84:87]
    s_cmp_lt_u32 s54, 10
    s_cbranch_scc1 L_k1_K_loop1
    s_branch L_k1_K_epi
L_k1_K_ev0:
    s_cmp_eq_u32 s54, 0
    s_cbranch_scc1 L_ev_38
    s_cmp_eq_u32 s54, 1
    s_cbranch_scc1 L_ev_39
    s_cmp_eq_u32 s54, 2
    s_cbranch_scc1 L_ev_40
    s_cmp_eq_u32 s54, 4
    s_cbranch_scc1 L_ev_41
    s_cmp_eq_u32 s54, 8
    s_cbranch_scc1 L_ev_42
    s_waitcnt vmcnt(0)
    v_add_f32 v212, v212, v216
    v_add_f32 v212, v212, v220
    v_add_f32 v212, v212, v224
    v_add_f32 v212, v212, v228
    v_add_f32 v212, v212, v232
    v_add_f32 v212, v212, v236
    v_add_f32 v212, v212, v240
    v_add_f32 v213, v213, v217
    v_add_f32 v213, v213, v221
    v_add_f32 v213, v213, v225
    v_add_f32 v213, v213, v229
    v_add_f32 v213, v213, v233
    v_add_f32 v213, v213, v237
    v_add_f32 v213, v213, v241
    v_add_f32 v214, v214, v218
    v_add_f32 v214, v214, v222
    v_add_f32 v214, v214, v226
    v_add_f32 v214, v214, v230
    v_add_f32 v214, v214, v234
    v_add_f32 v214, v214, v238
    v_add_f32 v214, v214, v242
    v_add_f32 v215, v215, v219
    v_add_f32 v215, v215, v223
    v_add_f32 v215, v215, v227
    v_add_f32 v215, v215, v231
    v_add_f32 v215, v215, v235
    v_add_f32 v215, v215, v239
    v_add_f32 v215, v215, v243
    ds_write_b128 v201, v[212:215]
    s_branch L_k1_K_evr0
L_ev_38:
    s_waitcnt vmcnt(7)
    s_branch L_k1_K_evr0
L_ev_39:
    s_cmp_lt_u32 s66, 5
    s_cbranch_scc1 L_ax_44
    buffer_load_dwordx4 v[212:215], v1, s[76:79], s72 offen
    s_add_u32 s72, s72, s73
    buffer_load_dwordx4 v[216:219], v1, s[76:79], s72 offen
    s_add_u32 s72, s72, s73
    buffer_load_dwordx4 v[220:223], v1, s[76:79], s72 offen
    s_add_u32 s72, s72, s73
    buffer_load_dwordx4 v[224:227], v1, s[76:79], s72 offen
    s_add_u32 s72, s72, s73
    buffer_load_dwordx4 v[228:231], v1, s[76:79], s72 offen
    s_add_u32 s72, s72, s73
    buffer_load_dwordx4 v[232:235], v1, s[76:79], s72 offen
    s_add_u32 s72, s72, s73
    buffer_load_dwordx4 v[236:239], v1, s[76:79], s72 offen
    s_add_u32 s72, s72, s73
    buffer_load_dwordx4 v[240:243], v1, s[76:79], s72 offen
    s_add_u32 s72, s72, s73
    buffer_load_dwordx4 v[184:187], v1, s[76:79], s72 offen
    s_add_u32 s72, s72, s73
    buffer_load_dwordx4 v[188:191], v1, s[76:79], s72 offen
L_ax_44:
    s_branch L_k1_K_evr0
L_ev_40:
    s_waitcnt vmcnt(0)
    v_mfma_f32_16x16x32_bf16 v[208:211], v[212:215], v[4:7], 0
    v_mfma_f32_16x16x32_bf16 v[208:211], v[216:219], v[4:7], v[208:211]
    v_mfma_f32_16x16x32_bf16 v[208:211], v[220:223], v[4:7], v[208:211]
    v_mfma_f32_16x16x32_bf16 v[208:211], v[224:227], v[4:7], v[208:211]
    v_mfma_f32_16x16x32_bf16 v[208:211], v[228:231], v[4:7], v[208:211]
    v_mfma_f32_16x16x32_bf16 v[208:211], v[232:235], v[4:7], v[208:211]
    v_mfma_f32_16x16x32_bf16 v[208:211], v[236:239], v[4:7], v[208:211]
    v_mfma_f32_16x16x32_bf16 v[208:211], v[240:243], v[4:7], v[208:211]
    v_mfma_f32_16x16x32_bf16 v[208:211], v[184:187], v[4:7], v[208:211]
    v_mfma_f32_16x16x32_bf16 v[208:211], v[188:191], v[4:7], v[208:211]
    s_branch L_k1_K_evr0
L_ev_41:
    s_cmp_eq_u32 s3, 4
    s_cbranch_scc0 L_ar_45
    s_and_b32 s56, s2, 7
    s_lshl_b32 s56, s56, 5
    v_mov_b32 v184, 1
    v_mov_b32 v185, 0
    s_mov_b64 exec, 1
    buffer_atomic_add v184, v185, s[28:31], s56 offen sc1
    s_mov_b64 exec, -1
L_ar_45:
    s_branch L_k1_K_evr0
L_ev_42:
    s_mov_b32 s56, 0
L_sp_46:
    s_waitcnt vmcnt(0)
    v_cmp_ne_u32 vcc, 32, v184
    s_add_u32 s56, s56, 1
    s_nop 2
    s_cmp_eq_u64 vcc, 0
    s_cbranch_scc1 L_sp_46b
    s_cmp_gt_u32 s56, 0x8000
    s_cbranch_scc1 L_sp_46b
    s_sleep 1
    buffer_load_dword v184, v205, s[28:31], 0 offen sc1
    s_branch L_sp_46
L_sp_46b:
    buffer_load_dwordx4 v[212:215], v200, s[36:39], s68 offen sc1
    s_add_u32 s68, s68, s69
    buffer_load_dwordx4 v[216:219], v200, s[36:39], s68 offen sc1
    s_add_u32 s68, s68, s69
    buffer_load_dwordx4 v[220:223], v200, s[36:39], s68 offen sc1
    s_add_u32 s68, s68, s69
    buffer_load_dwordx4 v[224:227], v200, s[36:39], s68 offen sc1
    s_add_u32 s68, s68, s69
    buffer_load_dwordx4 v[228:231], v200, s[36:39], s68 offen sc1
    s_add_u32 s68, s68, s69
    buffer_load_dwordx4 v[232:235], v200, s[36:39], s68 offen sc1
    s_add_u32 s68, s68, s69
    buffer_load_dwordx4 v[236:239], v200, s[36:39], s68 offen sc1
    s_add_u32 s68, s68, s69
    buffer_load_dwordx4 v[240:243], v200, s[36:39], s68 offen sc1
    s_branch L_k1_K_evr0
L_k1_K_ev1:
    s_cmp_eq_u32 s54, 0
    s_cbranch_scc1 L_ev_47
    s_cmp_eq_u32 s54, 2
    s_cbranch_scc1 L_ev_48
    s_cmp_eq_u32 s54, 3
    s_cbranch_scc1 L_ev_49
    buffer_load_dword v184, v205, s[28:31], 0 offen sc1
    s_branch L_k1_K_evr1
L_ev_47:
    s_cmp_lt_u32 s66, 5
    s_cbranch_scc1 L_g1_51
    s_waitcnt vmcnt(0)
    s_branch L_g1_52
L_g1_51:
    s_waitcnt vmcnt(10)
L_g1_52:
    s_branch L_k1_K_evr1
L_ev_48:
    v_mov_b32 v212, v208
    v_mov_b32 v213, v209
    v_mov_b32 v214, v210
    v_mov_b32 v215, v211
    s_nop 1
    v_permlane32_swap_b32 v208, v212
    v_permlane32_swap_b32 v209, v213
    v_permlane32_swap_b32 v210, v214
    v_permlane32_swap_b32 v211, v215
    v_add_f32 v208, v208, v212
    v_add_f32 v209, v209, v213
    v_add_f32 v210, v210, v214
    v_add_f32 v211, v211, v215
    s_mov_b64 exec, 0x00ff00ff
    buffer_store_dword v208, v2, s[36:39], s71 offen offset:0 sc1
    buffer_store_dword v209, v2, s[36:39], s71 offen offset:32 sc1
    buffer_store_dword v210, v2, s[36:39], s71 offen offset:64 sc1
    buffer_store_dword v211, v2, s[36:39], s71 offen offset:96 sc1
    s_mov_b64 exec, -1
    s_cmp_eq_u32 s3, 5
    s_cbranch_scc0 L_fl_53
    v_mov_b32 v220, 0
    v_mov_b32 v221, 0
    s_mov_b64 exec, 1
    s_and_b32 s56, s2, 7
    s_lshl_b32 s56, s56, 9
    s_bfe_u32 s57, s2, 0x20003
    s_lshl_b32 s57, s57, 7
    s_add_u32 s56, s56, s57
    s_lshr_b32 s57, s2, 5
    s_lshl_b32 s57, s57, 2
    s_add_u32 s56, s56, s57
    s_add_u32 s56, s56, 16257024
    buffer_store_dword v220, v221, s[36:39], s56 offen sc1
    s_mov_b64 exec, -1
L_fl_53:
    s_cmp_eq_u32 s3, 4
    s_cbranch_scc0 L_fl_54
    v_mov_b32 v220, 0
    v_mov_b32 v221, 0
    s_mov_b64 exec, 1
    buffer_store_dword v220, v221, s[36:39], s95 offen sc1
    s_mov_b64 exec, -1
L_fl_54:
    s_branch L_k1_K_evr1
L_ev_49:
    s_waitcnt vmcnt(0)
    s_branch L_k1_K_evr1
.p2align 3
L_k1_K_epi:
    s_waitcnt lgkmcnt(0)
    v_lshrrev_b32 v203, 4, v0
    v_lshlrev_b32 v204, 4, v203
    s_lshl_b32 s56, s42, 8
    s_add_u32 s56, s56, 147456
    v_add_u32 v201, s56, v204
    ds_read_b128 v[104:107], v201 offset:0
    ds_read_b128 v[120:123], v201 offset:1024
    ds_read_b128 v[108:111], v201 offset:64
    ds_read_b128 v[124:127], v201 offset:1088
    ds_read_b128 v[112:115], v201 offset:128
    ds_read_b128 v[128:131], v201 offset:1152
    ds_read_b128 v[116:119], v201 offset:192
    ds_read_b128 v[132:135], v201 offset:1216
    s_mul_i32 s56, s43, 160
    s_add_u32 s56, s56, 149504
    v_add_u32 v201, s56, v202
    ds_read_b32 v136, v201 offset:0
    ds_read_b32 v140, v201 offset:80
    ds_read_b32 v144, v201 offset:1024
    ds_read_b32 v148, v201 offset:1104
    v_bfe_u32 v201, v0, 2, 1
    v_mul_u32_u24 v201, 80, v201
    v_and_b32 v204, 3, v0
    v_lshl_add_u32 v201, v204, 2, v201
    v_bfe_u32 v204, v0, 3, 1
    v_xor_b32 v204, s43, v204
    v_lshl_add_u32 v201, v204, 10, v201
    v_add_u32 v201, s56, v201
    ds_read_b32 v152, v201 offset:64
    v_mov_b32 v204, 1.0
    s_mov_b32 s58, 0x3fb8aa3b
    s_mov_b32 s59, 0x358637bd
    v_mov_b32 v206, s59
    v_bfe_u32 v201, v0, 3, 1
    v_cmp_eq_u32 s[60:61], s43, v201
    v_bfe_u32 v201, v0, 2, 1
    v_cmp_eq_u32 s[62:63], 1, v201
    v_bfe_u32 v201, v0, 4, 1
    v_cmp_eq_u32 s[64:65], 1, v201
    s_waitcnt lgkmcnt(0)
    v_mul_f32 v212, s58, v120
    v_mul_f32 v213, s58, v121
    v_mul_f32 v214, s58, v122
    v_mul_f32 v215, s58, v123
    v_mul_f32 v216, s58, v124
    v_mul_f32 v217, s58, v125
    v_mul_f32 v218, s58, v126
    v_mul_f32 v219, s58, v127
    v_mul_f32 v220, s58, v128
    v_mul_f32 v221, s58, v129
    v_mul_f32 v222, s58, v130
    v_mul_f32 v223, s58, v131
    v_mul_f32 v224, s58, v132
    v_mul_f32 v225, s58, v133
    v_mul_f32 v226, s58, v134
    v_mul_f32 v227, s58, v135
    v_pk_fma_f32 v[8:9], v[104:105], v[136:137], v[8:9] op_sel_hi:[1,0,1]
    v_pk_fma_f32 v[10:11], v[106:107], v[136:137], v[10:11] op_sel_hi:[1,0,1]
    v_pk_mul_f32 v[184:185], v[8:9], v[212:213]
    v_pk_mul_f32 v[186:187], v[10:11], v[214:215]
    v_pk_fma_f32 v[8:9], v[8:9], v[120:121], v[206:207] op_sel_hi:[1,1,0]
    v_pk_fma_f32 v[10:11], v[10:11], v[122:123], v[206:207] op_sel_hi:[1,1,0]
    v_exp_f32_e64 v184, v184 clamp
    v_exp_f32_e64 v185, v185 clamp
    v_exp_f32_e64 v186, v186 clamp
    v_exp_f32_e64 v187, v187 clamp
    v_max_f32 v8, s59, v8
    v_max_f32 v9, s59, v9
    v_max_f32 v10, s59, v10
    v_max_f32 v11, s59, v11
    v_pk_add_f32 v[8:9], v[8:9], v[184:185]
    v_pk_add_f32 v[10:11], v[10:11], v[186:187]
    v_cvt_pk_bf16_f32 v8, v8, v9
    v_cvt_pk_bf16_f32 v9, v10, v11
    v_pk_fma_f32 v[24:25], v[104:105], v[140:141], v[24:25] op_sel_hi:[1,0,1]
    v_pk_fma_f32 v[26:27], v[106:107], v[140:141], v[26:27] op_sel_hi:[1,0,1]
    v_pk_mul_f32 v[188:189], v[24:25], v[212:213]
    v_pk_mul_f32 v[190:191], v[26:27], v[214:215]
    v_pk_fma_f32 v[24:25], v[24:25], v[120:121], v[206:207] op_sel_hi:[1,1,0]
    v_pk_fma_f32 v[26:27], v[26:27], v[122:123], v[206:207] op_sel_hi:[1,1,0]
    v_exp_f32_e64 v188, v188 clamp
    v_exp_f32_e64 v189, v189 clamp
    v_exp_f32_e64 v190, v190 clamp
    v_exp_f32_e64 v191, v191 clamp
    v_max_f32 v24, s59, v24
    v_max_f32 v25, s59, v25
    v_max_f32 v26, s59, v26
    v_max_f32 v27, s59, v27
    v_pk_add_f32 v[24:25], v[24:25], v[188:189]
    v_pk_add_f32 v[26:27], v[26:27], v[190:191]
    v_cvt_pk_bf16_f32 v24, v24, v25
    v_cvt_pk_bf16_f32 v25, v26, v27
    v_pk_fma_f32 v[40:41], v[104:105], v[144:145], v[40:41] op_sel_hi:[1,0,1]
    v_pk_fma_f32 v[42:43], v[106:107], v[144:145], v[42:43] op_sel_hi:[1,0,1]
    v_pk_mul_f32 v[40:41], v[40:41], v[120:121]
    v_pk_mul_f32 v[42:43], v[42:43], v[122:123]
    v_cvt_pk_bf16_f32 v40, v40, v41
    v_cvt_pk_bf16_f32 v41, v42, v43
    v_pk_fma_f32 v[56:57], v[104:105], v[148:149], v[56:57] op_sel_hi:[1,0,1]
    v_pk_fma_f32 v[58:59], v[106:107], v[148:149], v[58:59] op_sel_hi:[1,0,1]
    v_pk_mul_f32 v[56:57], v[56:57], v[120:121]
    v_pk_mul_f32 v[58:59], v[58:59], v[122:123]
    v_cvt_pk_bf16_f32 v56, v56, v57
    v_cvt_pk_bf16_f32 v57, v58, v59
    v_pk_fma_f32 v[72:73], v[104:105], v[152:153], v[72:73] op_sel_hi:[1,0,1]
    v_pk_fma_f32 v[74:75], v[106:107], v[152:153], v[74:75] op_sel_hi:[1,0,1]
    v_pk_mul_f32 v[168:169], v[72:73], v[120:121]
    v_pk_mul_f32 v[170:171], v[74:75], v[122:123]
    v_cndmask_b32 v168, v168, v204, s[60:61]
    v_cndmask_b32 v169, v169, v204, s[60:61]
    v_cndmask_b32 v170, v170, v204, s[60:61]
    v_cndmask_b32 v171, v171, v204, s[60:61]
    v_cvt_pk_bf16_f32 v160, v168, v169
    v_cvt_pk_bf16_f32 v161, v170, v171
    v_pk_mul_f32 v[184:185], v[72:73], v[212:213]
    v_pk_mul_f32 v[186:187], v[74:75], v[214:215]
    v_pk_fma_f32 v[72:73], v[72:73], v[120:121], v[206:207] op_sel_hi:[1,1,0]
    v_pk_fma_f32 v[74:75], v[74:75], v[122:123], v[206:207] op_sel_hi:[1,1,0]
    v_exp_f32_e64 v184, v184 clamp
    v_exp_f32_e64 v185, v185 clamp
    v_exp_f32_e64 v186, v186 clamp
    v_exp_f32_e64 v187, v187 clamp
    v_max_f32 v72, s59, v72
    v_max_f32 v73, s59, v73
    v_max_f32 v74, s59, v74
    v_max_f32 v75, s59, v75
    v_pk_add_f32 v[72:73], v[72:73], v[184:185]
    v_pk_add_f32 v[74:75], v[74:75], v[186:187]
    v_cvt_pk_bf16_f32 v72, v72, v73
    v_cvt_pk_bf16_f32 v73, v74, v75
    v_pk_fma_f32 v[12:13], v[108:109], v[136:137], v[12:13] op_sel_hi:[1,0,1]
    v_pk_fma_f32 v[14:15], v[110:111], v[136:137], v[14:15] op_sel_hi:[1,0,1]
    v_pk_mul_f32 v[184:185], v[12:13], v[216:217]
    v_pk_mul_f32 v[186:187], v[14:15], v[218:219]
    v_pk_fma_f32 v[12:13], v[12:13], v[124:125], v[206:207] op_sel_hi:[1,1,0]
    v_pk_fma_f32 v[14:15], v[14:15], v[126:127], v[206:207] op_sel_hi:[1,1,0]
    v_exp_f32_e64 v184, v184 clamp
    v_exp_f32_e64 v185, v185 clamp
    v_exp_f32_e64 v186, v186 clamp
    v_exp_f32_e64 v187, v187 clamp
    v_max_f32 v12, s59, v12
    v_max_f32 v13, s59, v13
    v_max_f32 v14, s59, v14
    v_max_f32 v15, s59, v15
    v_pk_add_f32 v[12:13], v[12:13], v[184:185]
    v_pk_add_f32 v[14:15], v[14:15], v[186:187]
    v_cvt_pk_bf16_f32 v10, v12, v13
    v_cvt_pk_bf16_f32 v11, v14, v15
    v_pk_fma_f32 v[28:29], v[108:109], v[140:141], v[28:29] op_sel_hi:[1,0,1]
    v_pk_fma_f32 v[30:31], v[110:111], v[140:141], v[30:31] op_sel_hi:[1,0,1]
    v_pk_mul_f32 v[188:189], v[28:29], v[216:217]
    v_pk_mul_f32 v[190:191], v[30:31], v[218:219]
    v_pk_fma_f32 v[28:29], v[28:29], v[124:125], v[206:207] op_sel_hi:[1,1,0]
    v_pk_fma_f32 v[30:31], v[30:31], v[126:127], v[206:207] op_sel_hi:[1,1,0]
    v_exp_f32_e64 v188, v188 clamp
    v_exp_f32_e64 v189, v189 clamp
    v_exp_f32_e64 v190, v190 clamp
    v_exp_f32_e64 v191, v191 clamp
    v_max_f32 v28, s59, v28
    v_max_f32 v29, s59, v29
    v_max_f32 v30, s59, v30
    v_max_f32 v31, s59, v31
    v_pk_add_f32 v[28:29], v[28:29], v[188:189]
    v_pk_add_f32 v[30:31], v[30:31], v[190:191]
    v_cvt_pk_bf16_f32 v26, v28, v29
    v_cvt_pk_bf16_f32 v27, v30, v31
    v_pk_fma_f32 v[44:45], v[108:109], v[144:145], v[44:45] op_sel_hi:[1,0,1]
    v_pk_fma_f32 v[46:47], v[110:111], v[144:145], v[46:47] op_sel_hi:[1,0,1]
    v_pk_mul_f32 v[44:45], v[44:45], v[124:125]
    v_pk_mul_f32 v[46:47], v[46:47], v[126:127]
    v_cvt_pk_bf16_f32 v42, v44, v45
    v_cvt_pk_bf16_f32 v43, v46, v47
    v_pk_fma_f32 v[60:61], v[108:109], v[148:149], v[60:61] op_sel_hi:[1,0,1]
    v_pk_fma_f32 v[62:63], v[110:111], v[148:149], v[62:63] op_sel_hi:[1,0,1]
    v_pk_mul_f32 v[60:61], v[60:61], v[124:125]
    v_pk_mul_f32 v[62:63], v[62:63], v[126:127]
    v_cvt_pk_bf16_f32 v58, v60, v61
    v_cvt_pk_bf16_f32 v59, v62, v63
    v_pk_fma_f32 v[76:77], v[108:109], v[152:153], v[76:77] op_sel_hi:[1,0,1]
    v_pk_fma_f32 v[78:79], v[110:111], v[152:153], v[78:79] op_sel_hi:[1,0,1]
    v_pk_mul_f32 v[168:169], v[76:77], v[124:125]
    v_pk_mul_f32 v[170:171], v[78:79], v[126:127]
    v_cndmask_b32 v168, v168, v204, s[60:61]
    v_cndmask_b32 v169, v169, v204, s[60:61]
    v_cndmask_b32 v170, v170, v204, s[60:61]
    v_cndmask_b32 v171, v171, v204, s[60:61]
    v_cvt_pk_bf16_f32 v162, v168, v169
    v_cvt_pk_bf16_f32 v163, v170, v171
    v_pk_mul_f32 v[184:185], v[76:77], v[216:217]
    v_pk_mul_f32 v[186:187], v[78:79], v[218:219]
    v_pk_fma_f32 v[76:77], v[76:77], v[124:125], v[206:207] op_sel_hi:[1,1,0]
    v_pk_fma_f32 v[78:79], v[78:79], v[126:127], v[206:207] op_sel_hi:[1,1,0]
    v_exp_f32_e64 v184, v184 clamp
    v_exp_f32_e64 v185, v185 clamp
    v_exp_f32_e64 v186, v186 clamp
    v_exp_f32_e64 v187, v187 clamp
    v_max_f32 v76, s59, v76
    v_max_f32 v77, s59, v77
    v_max_f32 v78, s59, v78
    v_max_f32 v79, s59, v79
    v_pk_add_f32 v[76:77], v[76:77], v[184:185]
    v_pk_add_f32 v[78:79], v[78:79], v[186:187]
    v_cvt_pk_bf16_f32 v74, v76, v77
    v_cvt_pk_bf16_f32 v75, v78, v79
    v_pk_fma_f32 v[16:17], v[112:113], v[136:137], v[16:17] op_sel_hi:[1,0,1]
    v_pk_fma_f32 v[18:19], v[114:115], v[136:137], v[18:19] op_sel_hi:[1,0,1]
    v_pk_mul_f32 v[184:185], v[16:17], v[220:221]
    v_pk_mul_f32 v[186:187], v[18:19], v[222:223]
    v_pk_fma_f32 v[16:17], v[16:17], v[128:129], v[206:207] op_sel_hi:[1,1,0]
    v_pk_fma_f32 v[18:19], v[18:19], v[130:131], v[206:207] op_sel_hi:[1,1,0]
    v_exp_f32_e64 v184, v184 clamp
    v_exp_f32_e64 v185, v185 clamp
    v_exp_f32_e64 v186, v186 clamp
    v_exp_f32_e64 v187, v187 clamp
    v_max_f32 v16, s59, v16
    v_max_f32 v17, s59, v17
    v_max_f32 v18, s59, v18
    v_max_f32 v19, s59, v19
    v_pk_add_f32 v[16:17], v[16:17], v[184:185]
    v_pk_add_f32 v[18:19], v[18:19], v[186:187]
    v_cvt_pk_bf16_f32 v16, v16, v17
    v_cvt_pk_bf16_f32 v17, v18, v19
    v_pk_fma_f32 v[32:33], v[112:113], v[140:141], v[32:33] op_sel_hi:[1,0,1]
    v_pk_fma_f32 v[34:35], v[114:115], v[140:141], v[34:35] op_sel_hi:[1,0,1]
    v_pk_mul_f32 v[188:189], v[32:33], v[220:221]
    v_pk_mul_f32 v[190:191], v[34:35], v[222:223]
    v_pk_fma_f32 v[32:33], v[32:33], v[128:129], v[206:207] op_sel_hi:[1,1,0]
    v_pk_fma_f32 v[34:35], v[34:35], v[130:131], v[206:207] op_sel_hi:[1,1,0]
    v_exp_f32_e64 v188, v188 clamp
    v_exp_f32_e64 v189, v189 clamp
    v_exp_f32_e64 v190, v190 clamp
    v_exp_f32_e64 v191, v191 clamp
    v_max_f32 v32, s59, v32
    v_max_f32 v33, s59, v33
    v_max_f32 v34, s59, v34
    v_max_f32 v35, s59, v35
    v_pk_add_f32 v[32:33], v[32:33], v[188:189]
    v_pk_add_f32 v[34:35], v[34:35], v[190:191]
    v_cvt_pk_bf16_f32 v32, v32, v33
    v_cvt_pk_bf16_f32 v33, v34, v35
    v_pk_fma_f32 v[48:49], v[112:113], v[144:145], v[48:49] op_sel_hi:[1,0,1]
    v_pk_fma_f32 v[50:51], v[114:115], v[144:145], v[50:51] op_sel_hi:[1,0,1]
    v_pk_mul_f32 v[48:49], v[48:49], v[128:129]
    v_pk_mul_f32 v[50:51], v[50:51], v[130:131]
    v_cvt_pk_bf16_f32 v48, v48, v49
    v_cvt_pk_bf16_f32 v49, v50, v51
    v_pk_fma_f32 v[64:65], v[112:113], v[148:149], v[64:65] op_sel_hi:[1,0,1]
    v_pk_fma_f32 v[66:67], v[114:115], v[148:149], v[66:67] op_sel_hi:[1,0,1]
    v_pk_mul_f32 v[64:65], v[64:65], v[128:129]
    v_pk_mul_f32 v[66:67], v[66:67], v[130:131]
    v_cvt_pk_bf16_f32 v64, v64, v65
    v_cvt_pk_bf16_f32 v65, v66, v67
    v_pk_fma_f32 v[80:81], v[112:113], v[152:153], v[80:81] op_sel_hi:[1,0,1]
    v_pk_fma_f32 v[82:83], v[114:115], v[152:153], v[82:83] op_sel_hi:[1,0,1]
    v_pk_mul_f32 v[168:169], v[80:81], v[128:129]
    v_pk_mul_f32 v[170:171], v[82:83], v[130:131]
    v_cndmask_b32 v168, v168, v204, s[60:61]
    v_cndmask_b32 v169, v169, v204, s[60:61]
    v_cndmask_b32 v170, v170, v204, s[60:61]
    v_cndmask_b32 v171, v171, v204, s[60:61]
    v_cvt_pk_bf16_f32 v164, v168, v169
    v_cvt_pk_bf16_f32 v165, v170, v171
    v_pk_mul_f32 v[184:185], v[80:81], v[220:221]
    v_pk_mul_f32 v[186:187], v[82:83], v[222:223]
    v_pk_fma_f32 v[80:81], v[80:81], v[128:129], v[206:207] op_sel_hi:[1,1,0]
    v_pk_fma_f32 v[82:83], v[82:83], v[130:131], v[206:207] op_sel_hi:[1,1,0]
    v_exp_f32_e64 v184, v184 clamp
    v_exp_f32_e64 v185, v185 clamp
    v_exp_f32_e64 v186, v186 clamp
    v_exp_f32_e64 v187, v187 clamp
    v_max_f32 v80, s59, v80
    v_max_f32 v81, s59, v81
    v_max_f32 v82, s59, v82
    v_max_f32 v83, s59, v83
    v_pk_add_f32 v[80:81], v[80:81], v[184:185]
    v_pk_add_f32 v[82:83], v[82:83], v[186:187]
    v_cvt_pk_bf16_f32 v80, v80, v81
    v_cvt_pk_bf16_f32 v81, v82, v83
    v_pk_fma_f32 v[20:21], v[116:117], v[136:137], v[20:21] op_sel_hi:[1,0,1]
    v_pk_fma_f32 v[22:23], v[118:119], v[136:137], v[22:23] op_sel_hi:[1,0,1]
    v_pk_mul_f32 v[184:185], v[20:21], v[224:225]
    v_pk_mul_f32 v[186:187], v[22:23], v[226:227]
    v_pk_fma_f32 v[20:21], v[20:21], v[132:133], v[206:207] op_sel_hi:[1,1,0]
    v_pk_fma_f32 v[22:23], v[22:23], v[134:135], v[206:207] op_sel_hi:[1,1,0]
    v_exp_f32_e64 v184, v184 clamp
    v_exp_f32_e64 v185, v185 clamp
    v_exp_f32_e64 v186, v186 clamp
    v_exp_f32_e64 v187, v187 clamp
    v_max_f32 v20, s59, v20
    v_max_f32 v21, s59, v21
    v_max_f32 v22, s59, v22
    v_max_f32 v23, s59, v23
    v_pk_add_f32 v[20:21], v[20:21], v[184:185]
    v_pk_add_f32 v[22:23], v[22:23], v[186:187]
    v_cvt_pk_bf16_f32 v18, v20, v21
    v_cvt_pk_bf16_f32 v19, v22, v23
    v_pk_fma_f32 v[36:37], v[116:117], v[140:141], v[36:37] op_sel_hi:[1,0,1]
    v_pk_fma_f32 v[38:39], v[118:119], v[140:141], v[38:39] op_sel_hi:[1,0,1]
    v_pk_mul_f32 v[188:189], v[36:37], v[224:225]
    v_pk_mul_f32 v[190:191], v[38:39], v[226:227]
    v_pk_fma_f32 v[36:37], v[36:37], v[132:133], v[206:207] op_sel_hi:[1,1,0]
    v_pk_fma_f32 v[38:39], v[38:39], v[134:135], v[206:207] op_sel_hi:[1,1,0]
    v_exp_f32_e64 v188, v188 clamp
    v_exp_f32_e64 v189, v189 clamp
    v_exp_f32_e64 v190, v190 clamp
    v_exp_f32_e64 v191, v191 clamp
    v_max_f32 v36, s59, v36
    v_max_f32 v37, s59, v37
    v_max_f32 v38, s59, v38
    v_max_f32 v39, s59, v39
    v_pk_add_f32 v[36:37], v[36:37], v[188:189]
    v_pk_add_f32 v[38:39], v[38:39], v[190:191]
    v_cvt_pk_bf16_f32 v34, v36, v37
    v_cvt_pk_bf16_f32 v35, v38, v39
    v_pk_fma_f32 v[52:53], v[116:117], v[144:145], v[52:53] op_sel_hi:[1,0,1]
    v_pk_fma_f32 v[54:55], v[118:119], v[144:145], v[54:55] op_sel_hi:[1,0,1]
    v_pk_mul_f32 v[52:53], v[52:53], v[132:133]
    v_pk_mul_f32 v[54:55], v[54:55], v[134:135]
    v_cvt_pk_bf16_f32 v50, v52, v53
    v_cvt_pk_bf16_f32 v51, v54, v55
    v_pk_fma_f32 v[68:69], v[116:117], v[148:149], v[68:69] op_sel_hi:[1,0,1]
    v_pk_fma_f32 v[70:71], v[118:119], v[148:149], v[70:71] op_sel_hi:[1,0,1]
    v_pk_mul_f32 v[68:69], v[68:69], v[132:133]
    v_pk_mul_f32 v[70:71], v[70:71], v[134:135]
    v_cvt_pk_bf16_f32 v66, v68, v69
    v_cvt_pk_bf16_f32 v67, v70, v71
    v_pk_fma_f32 v[84:85], v[116:117], v[152:153], v[84:85] op_sel_hi:[1,0,1]
    v_pk_fma_f32 v[86:87], v[118:119], v[152:153], v[86:87] op_sel_hi:[1,0,1]
    v_pk_mul_f32 v[168:169], v[84:85], v[132:133]
    v_pk_mul_f32 v[170:171], v[86:87], v[134:135]
    v_cndmask_b32 v168, v168, v204, s[60:61]
    v_cndmask_b32 v169, v169, v204, s[60:61]
    v_cndmask_b32 v170, v170, v204, s[60:61]
    v_cndmask_b32 v171, v171, v204, s[60:61]
    v_cvt_pk_bf16_f32 v166, v168, v169
    v_cvt_pk_bf16_f32 v167, v170, v171
    v_pk_mul_f32 v[184:185], v[84:85], v[224:225]
    v_pk_mul_f32 v[186:187], v[86:87], v[226:227]
    v_pk_fma_f32 v[84:85], v[84:85], v[132:133], v[206:207] op_sel_hi:[1,1,0]
    v_pk_fma_f32 v[86:87], v[86:87], v[134:135], v[206:207] op_sel_hi:[1,1,0]
    v_exp_f32_e64 v184, v184 clamp
    v_exp_f32_e64 v185, v185 clamp
    v_exp_f32_e64 v186, v186 clamp
    v_exp_f32_e64 v187, v187 clamp
    v_max_f32 v84, s59, v84
    v_max_f32 v85, s59, v85
    v_max_f32 v86, s59, v86
    v_max_f32 v87, s59, v87
    v_pk_add_f32 v[84:85], v[84:85], v[184:185]
    v_pk_add_f32 v[86:87], v[86:87], v[186:187]
    v_cvt_pk_bf16_f32 v82, v84, v85
    v_cvt_pk_bf16_f32 v83, v86, v87
    s_nop 1
    v_mfma_f32_16x16x32_bf16 v[12:15], v[8:11], v[40:43], 0
    v_mfma_f32_16x16x32_bf16 v[28:31], v[24:27], v[56:59], 0
    v_mfma_f32_16x16x32_bf16 v[44:47], v[72:75], v[40:43], 0
    v_mfma_f32_16x16x32_bf16 v[60:63], v[72:75], v[56:59], 0
    v_mfma_f32_16x16x32_bf16 v[76:79], v[8:11], v[160:163], 0
    v_mfma_f32_16x16x32_bf16 v[20:23], v[24:27], v[160:163], 0
    v_mfma_f32_16x16x32_bf16 v[36:39], v[72:75], v[160:163], 0
    v_mfma_f32_16x16x32_bf16 v[12:15], v[16:19], v[48:51], v[12:15]
    v_mfma_f32_16x16x32_bf16 v[28:31], v[32:35], v[64:67], v[28:31]
    v_mfma_f32_16x16x32_bf16 v[44:47], v[80:83], v[48:51], v[44:47]
    v_mfma_f32_16x16x32_bf16 v[60:63], v[80:83], v[64:67], v[60:63]
    v_mfma_f32_16x16x32_bf16 v[76:79], v[16:19], v[164:167], v[76:79]
    v_mfma_f32_16x16x32_bf16 v[20:23], v[32:35], v[164:167], v[20:23]
    v_mfma_f32_16x16x32_bf16 v[36:39], v[80:83], v[164:167], v[36:39]
    s_mul_i32 s56, s3, 5120
    v_add_u32 v201, s56, v200
    s_waitcnt vmcnt(0)
    s_barrier
    s_nop 7
    v_cndmask_b32 v44, v44, v60, s[64:65]
    v_cndmask_b32 v76, v76, v20, s[62:63]
    v_cndmask_b32 v45, v45, v61, s[64:65]
    v_cndmask_b32 v77, v77, v21, s[62:63]
    v_cndmask_b32 v46, v46, v62, s[64:65]
    v_cndmask_b32 v78, v78, v22, s[62:63]
    v_cndmask_b32 v47, v47, v63, s[64:65]
    v_cndmask_b32 v79, v79, v23, s[62:63]
    ds_write_b128 v201, v[12:15] offset:0
    ds_write_b128 v201, v[28:31] offset:1024
    ds_write_b128 v201, v[76:79] offset:2048
    ds_write_b128 v201, v[44:47] offset:3072
    ds_write_b128 v201, v[36:39] offset:4096
    s_cmp_ge_u32 s3, 3
    s_cselect_b32 s56, 17408, 0
    s_lshl_b32 s57, s3, 10
    s_add_u32 s56, s56, s57
    v_add_u32 v202, s56, v200
    s_sub_u32 s57, s57, 3072
    v_lshrrev_b32 v203, 5, v0
    v_mul_u32_u24 v203, 20480, v203
    v_add_u32 v203, v203, v200
    v_add_u32 v203, s57, v203
    s_cmp_ge_u32 s3, 6
    s_cselect_b64 vcc, -1, 0
    v_cndmask_b32 v202, v202, v203, vcc
    s_waitcnt lgkmcnt(0)
    s_barrier
    ds_read_b128 v[104:107], v202 offset:0
    ds_read_b128 v[108:111], v202 offset:5120
    ds_read_b128 v[112:115], v202 offset:10240
    ds_read_b128 v[116:119], v202 offset:15360
    s_lshl_b32 s56, s41, 3
    s_lshr_b32 s57, s40, 8
    s_add_u32 s56, s56, s57
    s_lshl_b32 s56, s56, 3
    s_add_u32 s56, s56, s3
    s_lshl_b32 s56, s56, 10
    s_add_u32 s56, s56, 9961472
    s_waitcnt lgkmcnt(0)
    v_add_f32 v104, v104, v108
    v_add_f32 v112, v112, v116
    v_add_f32 v105, v105, v109
    v_add_f32 v113, v113, v117
    v_add_f32 v106, v106, v110
    v_add_f32 v114, v114, v118
    v_add_f32 v107, v107, v111
    v_add_f32 v115, v115, v119
    v_add_f32 v104, v104, v112
    v_add_f32 v105, v105, v113
    v_add_f32 v106, v106, v114
    v_add_f32 v107, v107, v115
    buffer_store_dwordx4 v[104:107], v200, s[36:39], s56 offen sc1
    s_branch L_k1_done
L_k1_R:
    s_lshl_b32 s72, s41, 3
    s_add_u32 s72, s72, s3
    s_mul_i32 s44, s72, 20480
    s_add_u32 s45, s44, 10240
    v_lshrrev_b32 v2, 3, v0
    v_and_b32 v3, 7, v0
    v_mul_u32_u24 v4, 1280, v2
    v_lshl_add_u32 v4, v3, 4, v4
    v_lshlrev_b32 v5, 2, v2
    s_waitcnt lgkmcnt(0)
    s_mov_b32 s20, s4
    s_mov_b32 s21, s5
    s_mov_b32 s22, 2621440
    s_mov_b32 s23, 0x20000
    buffer_load_dwordx4 v[16:19], v4, s[20:23], s44 offen offset:0
    buffer_load_dwordx4 v[20:23], v4, s[20:23], s44 offen offset:128
    buffer_load_dwordx4 v[24:27], v4, s[20:23], s44 offen offset:256
    buffer_load_dwordx4 v[28:31], v4, s[20:23], s44 offen offset:384
    buffer_load_dwordx4 v[32:35], v4, s[20:23], s44 offen offset:512
    buffer_load_dwordx4 v[36:39], v4, s[20:23], s44 offen offset:640
    buffer_load_dwordx4 v[40:43], v4, s[20:23], s44 offen offset:768
    buffer_load_dwordx4 v[44:47], v4, s[20:23], s44 offen offset:896
    buffer_load_dwordx4 v[48:51], v4, s[20:23], s44 offen offset:1024
    buffer_load_dwordx4 v[52:55], v4, s[20:23], s44 offen offset:1152
    buffer_load_dwordx4 v[56:59], v4, s[20:23], s45 offen offset:0
    buffer_load_dwordx4 v[60:63], v4, s[20:23], s45 offen offset:128
    buffer_load_dwordx4 v[64:67], v4, s[20:23], s45 offen offset:256
    buffer_load_dwordx4 v[68:71], v4, s[20:23], s45 offen offset:384
    buffer_load_dwordx4 v[72:75], v4, s[20:23], s45 offen offset:512
    buffer_load_dwordx4 v[76:79], v4, s[20:23], s45 offen offset:640
    buffer_load_dwordx4 v[80:83], v4, s[20:23], s45 offen offset:768
    buffer_load_dwordx4 v[84:87], v4, s[20:23], s45 offen offset:896
    buffer_load_dwordx4 v[88:91], v4, s[20:23], s45 offen offset:1024
    buffer_load_dwordx4 v[92:95], v4, s[20:23], s45 offen offset:1152
    s_mov_b32 s36, s16
    s_mov_b32 s37, s17
    s_mov_b32 s38, 33554432
    s_mov_b32 s39, 0x20000
    s_mov_b32 s28, s18
    s_mov_b32 s29, s19
    s_mov_b32 s30, 256
    s_mov_b32 s31, 0x20000
    s_mov_b32 s24, s10
    s_mov_b32 s25, s11
    s_mov_b32 s26, 2211840
    s_mov_b32 s27, 0x20000
    s_mov_b32 s32, s8
    s_mov_b32 s33, s9
    s_mov_b32 s34, 819200
    s_mov_b32 s35, 0x20000
    v_lshlrev_b32 v112, 4, v0
    v_cmp_eq_u32 s[60:61], 0, v3
    v_add_u32 v113, 0, v0
    v_mul_u32_u24 v114, 1639, v113
    v_lshrrev_b32 v114, 16, v114
    v_mul_u32_u24 v116, 40, v114
    v_sub_u32 v113, v113, v116
    v_lshlrev_b32 v113, 4, v113
    v_mul_u32_u24 v100, 1280, v114
    v_add_u32 v100, v100, v113
    v_lshrrev_b32 v116, 2, v114
    v_mul_u32_u24 v116, 20480, v116
    v_add_u32 v105, v100, v116
    v_add_u32 v113, 64, v0
    v_mul_u32_u24 v114, 1639, v113
    v_lshrrev_b32 v114, 16, v114
    v_mul_u32_u24 v116, 40, v114
    v_sub_u32 v113, v113, v116
    v_lshlrev_b32 v113, 4, v113
    v_mul_u32_u24 v101, 1280, v114
    v_add_u32 v101, v101, v113
    v_lshrrev_b32 v116, 2, v114
    v_mul_u32_u24 v116, 20480, v116
    v_add_u32 v106, v101, v116
    v_add_u32 v113, 128, v0
    v_mul_u32_u24 v114, 1639, v113
    v_lshrrev_b32 v114, 16, v114
    v_mul_u32_u24 v116, 40, v114
    v_sub_u32 v113, v113, v116
    v_lshlrev_b32 v113, 4, v113
    v_mul_u32_u24 v102, 1280, v114
    v_add_u32 v102, v102, v113
    v_lshrrev_b32 v116, 2, v114
    v_mul_u32_u24 v116, 20480, v116
    v_add_u32 v107, v102, v116
    v_add_u32 v113, 192, v0
    v_mul_u32_u24 v114, 1639, v113
    v_lshrrev_b32 v114, 16, v114
    v_mul_u32_u24 v116, 40, v114
    v_sub_u32 v113, v113, v116
    v_lshlrev_b32 v113, 4, v113
    v_mul_u32_u24 v103, 1280, v114
    v_add_u32 v103, v103, v113
    v_lshrrev_b32 v116, 2, v114
    v_mul_u32_u24 v116, 20480, v116
    v_add_u32 v108, v103, v116
    v_add_u32 v113, 256, v0
    v_mul_u32_u24 v114, 1639, v113
    v_lshrrev_b32 v114, 16, v114
    v_mul_u32_u24 v116, 40, v114
    v_sub_u32 v113, v113, v116
    v_lshlrev_b32 v113, 4, v113
    v_mul_u32_u24 v104, 1280, v114
    v_add_u32 v104, v104, v113
    v_lshrrev_b32 v116, 2, v114
    v_mul_u32_u24 v116, 20480, v116
    v_add_u32 v109, v104, v116
    v_lshrrev_b32 v113, 2, v0
    v_mul_u32_u24 v113, 640, v113
    v_and_b32 v114, 3, v0
    v_lshl_add_u32 v110, v114, 4, v113
    v_lshl_add_u32 v111, v114, 3, v113
    s_mul_i32 s48, s3, 20480
    v_add_u32 v110, s48, v110
    v_add_u32 v111, s48, v111
    s_mov_b32 s56, 0x3acccccd
    s_mov_b32 s57, 0x3727c5ac
    s_mov_b32 s58, 0x3f803f80
    s_lshl_b32 s55, s72, 6
    s_add_u32 s55, s55, 16318464
    s_add_u32 s45, s55, 8192
    v_mov_b32 v8, 0
    v_mov_b32 v9, 0
    v_mov_b32 v10, 0
    v_mov_b32 v11, 0
    s_waitcnt vmcnt(10)
    v_dot2c_f32_bf16 v8, s58, v16
    v_dot2c_f32_bf16 v10, v16, v16
    v_dot2c_f32_bf16 v9, s58, v17
    v_dot2c_f32_bf16 v11, v17, v17
    v_dot2c_f32_bf16 v8, s58, v18
    v_dot2c_f32_bf16 v10, v18, v18
    v_dot2c_f32_bf16 v9, s58, v19
    v_dot2c_f32_bf16 v11, v19, v19
    v_dot2c_f32_bf16 v8, s58, v20
    v_dot2c_f32_bf16 v10, v20, v20
    v_dot2c_f32_bf16 v9, s58, v21
    v_dot2c_f32_bf16 v11, v21, v21
    v_dot2c_f32_bf16 v8, s58, v22
    v_dot2c_f32_bf16 v10, v22, v22
    v_dot2c_f32_bf16 v9, s58, v23
    v_dot2c_f32_bf16 v11, v23, v23
    v_dot2c_f32_bf16 v8, s58, v24
    v_dot2c_f32_bf16 v10, v24, v24
    v_dot2c_f32_bf16 v9, s58, v25
    v_dot2c_f32_bf16 v11, v25, v25
    v_dot2c_f32_bf16 v8, s58, v26
    v_dot2c_f32_bf16 v10, v26, v26
    v_dot2c_f32_bf16 v9, s58, v27
    v_dot2c_f32_bf16 v11, v27, v27
    v_dot2c_f32_bf16 v8, s58, v28
    v_dot2c_f32_bf16 v10, v28, v28
    v_dot2c_f32_bf16 v9, s58, v29
    v_dot2c_f32_bf16 v11, v29, v29
    v_dot2c_f32_bf16 v8, s58, v30
    v_dot2c_f32_bf16 v10, v30, v30
    v_dot2c_f32_bf16 v9, s58, v31
    v_dot2c_f32_bf16 v11, v31, v31
    v_dot2c_f32_bf16 v8, s58, v32
    v_dot2c_f32_bf16 v10, v32, v32
    v_dot2c_f32_bf16 v9, s58, v33
    v_dot2c_f32_bf16 v11, v33, v33
    v_dot2c_f32_bf16 v8, s58, v34
    v_dot2c_f32_bf16 v10, v34, v34
    v_dot2c_f32_bf16 v9, s58, v35
    v_dot2c_f32_bf16 v11, v35, v35
    v_dot2c_f32_bf16 v8, s58, v36
    v_dot2c_f32_bf16 v10, v36, v36
    v_dot2c_f32_bf16 v9, s58, v37
    v_dot2c_f32_bf16 v11, v37, v37
    v_dot2c_f32_bf16 v8, s58, v38
    v_dot2c_f32_bf16 v10, v38, v38
    v_dot2c_f32_bf16 v9, s58, v39
    v_dot2c_f32_bf16 v11, v39, v39
    v_dot2c_f32_bf16 v8, s58, v40
    v_dot2c_f32_bf16 v10, v40, v40
    v_dot2c_f32_bf16 v9, s58, v41
    v_dot2c_f32_bf16 v11, v41, v41
    v_dot2c_f32_bf16 v8, s58, v42
    v_dot2c_f32_bf16 v10, v42, v42
    v_dot2c_f32_bf16 v9, s58, v43
    v_dot2c_f32_bf16 v11, v43, v43
    v_dot2c_f32_bf16 v8, s58, v44
    v_dot2c_f32_bf16 v10, v44, v44
    v_dot2c_f32_bf16 v9, s58, v45
    v_dot2c_f32_bf16 v11, v45, v45
    v_dot2c_f32_bf16 v8, s58, v46
    v_dot2c_f32_bf16 v10, v46, v46
    v_dot2c_f32_bf16 v9, s58, v47
    v_dot2c_f32_bf16 v11, v47, v47
    v_dot2c_f32_bf16 v8, s58, v48
    v_dot2c_f32_bf16 v10, v48, v48
    v_dot2c_f32_bf16 v9, s58, v49
    v_dot2c_f32_bf16 v11, v49, v49
    v_dot2c_f32_bf16 v8, s58, v50
    v_dot2c_f32_bf16 v10, v50, v50
    v_dot2c_f32_bf16 v9, s58, v51
    v_dot2c_f32_bf16 v11, v51, v51
    v_dot2c_f32_bf16 v8, s58, v52
    v_dot2c_f32_bf16 v10, v52, v52
    v_dot2c_f32_bf16 v9, s58, v53
    v_dot2c_f32_bf16 v11, v53, v53
    v_dot2c_f32_bf16 v8, s58, v54
    v_dot2c_f32_bf16 v10, v54, v54
    v_dot2c_f32_bf16 v9, s58, v55
    v_dot2c_f32_bf16 v11, v55, v55
    s_nop 2
    v_add_f32 v8, v8, v9
    v_add_f32 v10, v10, v11
    s_nop 1
    v_add_f32_dpp v8, v8, v8 quad_perm:[1,0,3,2] row_mask:0xf bank_mask:0xf
    v_add_f32_dpp v10, v10, v10 quad_perm:[1,0,3,2] row_mask:0xf bank_mask:0xf
    s_nop 1
    v_add_f32_dpp v8, v8, v8 quad_perm:[2,3,0,1] row_mask:0xf bank_mask:0xf
    v_add_f32_dpp v10, v10, v10 quad_perm:[2,3,0,1] row_mask:0xf bank_mask:0xf
    s_nop 1
    v_add_f32_dpp v8, v8, v8 row_half_mirror row_mask:0xf bank_mask:0xf
    v_add_f32_dpp v10, v10, v10 row_half_mirror row_mask:0xf bank_mask:0xf
    s_nop 1
    v_mul_f32 v8, s56, v8
    v_mul_f32 v10, s56, v10
    v_fma_f32 v10, -v8, v8, v10
    v_max_f32 v10, 0, v10
    v_add_f32 v10, s57, v10
    v_rsq_f32 v12, v10
    v_sub_f32 v13, 0, v8
    s_mov_b64 exec, s[60:61]
    buffer_store_dword v13, v5, s[36:39], s55 offen offset:0 sc1
    buffer_store_dword v12, v5, s[36:39], s45 offen offset:0 sc1
    s_mov_b64 exec, -1
    v_mov_b32 v8, 0
    v_mov_b32 v9, 0
    v_mov_b32 v10, 0
    v_mov_b32 v11, 0
    s_waitcnt vmcnt(2)
    v_dot2c_f32_bf16 v8, s58, v56
    v_dot2c_f32_bf16 v10, v56, v56
    v_dot2c_f32_bf16 v9, s58, v57
    v_dot2c_f32_bf16 v11, v57, v57
    v_dot2c_f32_bf16 v8, s58, v58
    v_dot2c_f32_bf16 v10, v58, v58
    v_dot2c_f32_bf16 v9, s58, v59
    v_dot2c_f32_bf16 v11, v59, v59
    v_dot2c_f32_bf16 v8, s58, v60
    v_dot2c_f32_bf16 v10, v60, v60
    v_dot2c_f32_bf16 v9, s58, v61
    v_dot2c_f32_bf16 v11, v61, v61
    v_dot2c_f32_bf16 v8, s58, v62
    v_dot2c_f32_bf16 v10, v62, v62
    v_dot2c_f32_bf16 v9, s58, v63
    v_dot2c_f32_bf16 v11, v63, v63
    v_dot2c_f32_bf16 v8, s58, v64
    v_dot2c_f32_bf16 v10, v64, v64
    v_dot2c_f32_bf16 v9, s58, v65
    v_dot2c_f32_bf16 v11, v65, v65
    v_dot2c_f32_bf16 v8, s58, v66
    v_dot2c_f32_bf16 v10, v66, v66
    v_dot2c_f32_bf16 v9, s58, v67
    v_dot2c_f32_bf16 v11, v67, v67
    v_dot2c_f32_bf16 v8, s58, v68
    v_dot2c_f32_bf16 v10, v68, v68
    v_dot2c_f32_bf16 v9, s58, v69
    v_dot2c_f32_bf16 v11, v69, v69
    v_dot2c_f32_bf16 v8, s58, v70
    v_dot2c_f32_bf16 v10, v70, v70
    v_dot2c_f32_bf16 v9, s58, v71
    v_dot2c_f32_bf16 v11, v71, v71
    v_dot2c_f32_bf16 v8, s58, v72
    v_dot2c_f32_bf16 v10, v72, v72
    v_dot2c_f32_bf16 v9, s58, v73
    v_dot2c_f32_bf16 v11, v73, v73
    v_dot2c_f32_bf16 v8, s58, v74
    v_dot2c_f32_bf16 v10, v74, v74
    v_dot2c_f32_bf16 v9, s58, v75
    v_dot2c_f32_bf16 v11, v75, v75
    v_dot2c_f32_bf16 v8, s58, v76
    v_dot2c_f32_bf16 v10, v76, v76
    v_dot2c_f32_bf16 v9, s58, v77
    v_dot2c_f32_bf16 v11, v77, v77
    v_dot2c_f32_bf16 v8, s58, v78
    v_dot2c_f32_bf16 v10, v78, v78
    v_dot2c_f32_bf16 v9, s58, v79
    v_dot2c_f32_bf16 v11, v79, v79
    v_dot2c_f32_bf16 v8, s58, v80
    v_dot2c_f32_bf16 v10, v80, v80
    v_dot2c_f32_bf16 v9, s58, v81
    v_dot2c_f32_bf16 v11, v81, v81
    v_dot2c_f32_bf16 v8, s58, v82
    v_dot2c_f32_bf16 v10, v82, v82
    v_dot2c_f32_bf16 v9, s58, v83
    v_dot2c_f32_bf16 v11, v83, v83
    v_dot2c_f32_bf16 v8, s58, v84
    v_dot2c_f32_bf16 v10, v84, v84
    v_dot2c_f32_bf16 v9, s58, v85
    v_dot2c_f32_bf16 v11, v85, v85
    v_dot2c_f32_bf16 v8, s58, v86
    v_dot2c_f32_bf16 v10, v86, v86
    v_dot2c_f32_bf16 v9, s58, v87
    v_dot2c_f32_bf16 v11, v87, v87
    v_dot2c_f32_bf16 v8, s58, v88
    v_dot2c_f32_bf16 v10, v88, v88
    v_dot2c_f32_bf16 v9, s58, v89
    v_dot2c_f32_bf16 v11, v89, v89
    v_dot2c_f32_bf16 v8, s58, v90
    v_dot2c_f32_bf16 v10, v90, v90
    v_dot2c_f32_bf16 v9, s58, v91
    v_dot2c_f32_bf16 v11, v91, v91
    v_dot2c_f32_bf16 v8, s58, v92
    v_dot2c_f32_bf16 v10, v92, v92
    v_dot2c_f32_bf16 v9, s58, v93
    v_dot2c_f32_bf16 v11, v93, v93
    v_dot2c_f32_bf16 v8, s58, v94
    v_dot2c_f32_bf16 v10, v94, v94
    v_dot2c_f32_bf16 v9, s58, v95
    v_dot2c_f32_bf16 v11, v95, v95
    s_nop 2
    v_add_f32 v8, v8, v9
    v_add_f32 v10, v10, v11
    s_nop 1
    v_add_f32_dpp v8, v8, v8 quad_perm:[1,0,3,2] row_mask:0xf bank_mask:0xf
    v_add_f32_dpp v10, v10, v10 quad_perm:[1,0,3,2] row_mask:0xf bank_mask:0xf
    s_nop 1
    v_add_f32_dpp v8, v8, v8 quad_perm:[2,3,0,1] row_mask:0xf bank_mask:0xf
    v_add_f32_dpp v10, v10, v10 quad_perm:[2,3,0,1] row_mask:0xf bank_mask:0xf
    s_nop 1
    v_add_f32_dpp v8, v8, v8 row_half_mirror row_mask:0xf bank_mask:0xf
    v_add_f32_dpp v10, v10, v10 row_half_mirror row_mask:0xf bank_mask:0xf
    s_nop 1
    v_mul_f32 v8, s56, v8
    v_mul_f32 v10, s56, v10
    v_fma_f32 v10, -v8, v8, v10
    v_max_f32 v10, 0, v10
    v_add_f32 v10, s57, v10
    v_rsq_f32 v14, v10
    v_sub_f32 v15, 0, v8
    s_mov_b64 exec, s[60:61]
    buffer_store_dword v15, v5, s[36:39], s55 offen offset:32 sc1
    buffer_store_dword v14, v5, s[36:39], s45 offen offset:32 sc1
    s_mov_b64 exec, -1
    s_cmp_eq_u32 s3, 5
    s_cbranch_scc0 L_fl_55
    v_mov_b32 v8, 0
    v_mov_b32 v9, 0
    s_mov_b64 exec, 1
    s_and_b32 s56, s2, 7
    s_lshl_b32 s56, s56, 9
    s_bfe_u32 s57, s2, 0x20003
    s_lshl_b32 s57, s57, 7
    s_add_u32 s56, s56, s57
    s_lshr_b32 s57, s2, 5
    s_lshl_b32 s57, s57, 2
    s_add_u32 s56, s56, s57
    s_add_u32 s56, s56, 16257024
    buffer_store_dword v8, v9, s[36:39], s56 offen sc1
    s_mov_b64 exec, -1
L_fl_55:
    s_lshl_b32 s95, s41, 2
    s_add_u32 s95, s95, 16256000
    s_cmp_eq_u32 s3, 7
    s_cbranch_scc0 L_fl_56
    v_mov_b32 v8, 0
    v_mov_b32 v9, 0
    s_mov_b64 exec, 1
    buffer_store_dword v8, v9, s[36:39], s95 offen sc1
    s_mov_b64 exec, -1
L_fl_56:
    s_waitcnt vmcnt(0)
    s_barrier
    s_cmp_eq_u32 s3, 4
    s_cbranch_scc0 L_k1_R_np
    s_and_b32 s56, s2, 7
    s_lshl_b32 s56, s56, 5
    v_mov_b32 v8, 1
    v_mov_b32 v9, 0
    s_mov_b64 exec, 1
    buffer_atomic_add v8, v9, s[28:31], s56 offen sc1
    s_mov_b64 exec, -1
L_k1_R_np:
    s_lshl_b32 s54, s3, 4
    s_add_u32 s54, s54, s41
L_k1_R_job:
    s_lshr_b32 s44, s54, 1
    s_and_b32 s45, s54, 1
    s_mul_i32 s46, s45, 640
    s_lshr_b32 s56, s44, 2
    s_and_b32 s57, s44, 3
    s_mul_i32 s52, s57, 48
    s_mov_b32 s53, 16
    s_sub_u32 s47, s44, 36
    s_and_b32 s57, s47, 1
    s_mul_i32 s57, s57, 96
    s_add_u32 s57, s57, 32
    s_lshr_b32 s47, s47, 1
    s_cmp_ge_u32 s44, 36
    s_cselect_b32 s56, s47, s56
    s_cselect_b32 s52, s57, s52
    s_cselect_b32 s53, 48, s53
    s_mul_i32 s56, s56, 192
    s_add_u32 s56, s56, s52
    s_sub_u32 s47, s44, 54
    s_mul_i32 s57, s47, 40
    s_cmp_ge_u32 s44, 54
    s_cselect_b32 s56, s57, s56
    s_cselect_b32 s53, 20, s53
    s_cselect_b32 s76, s8, s10
    s_cselect_b32 s77, s9, s11
    s_mov_b32 s78, 2211840
    s_cselect_b32 s78, 819200, s78
    s_mov_b32 s79, 0x20000
    s_cmp_ge_u32 s44, 70
    s_cbranch_scc1 L_k1_R_lam
    s_mul_i32 s56, s56, 1280
    s_add_u32 s56, s56, s46
    s_mul_i32 s53, s53, 1280
    s_add_u32 m0, s48, 0
    s_nop 0
    buffer_load_dwordx4 v100, s[76:79], s56 offen lds
    s_add_u32 m0, s48, 1024
    s_nop 0
    buffer_load_dwordx4 v101, s[76:79], s56 offen lds
    s_add_u32 m0, s48, 2048
    s_nop 0
    buffer_load_dwordx4 v102, s[76:79], s56 offen lds
    s_add_u32 m0, s48, 3072
    s_nop 0
    buffer_load_dwordx4 v103, s[76:79], s56 offen lds
    s_add_u32 m0, s48, 4096
    s_nop 0
    buffer_load_dwordx4 v104, s[76:79], s56 offen lds
    s_add_u32 s57, s56, 10240
    s_add_u32 m0, s48, 5120
    s_nop 0
    buffer_load_dwordx4 v100, s[76:79], s57 offen lds
    s_add_u32 m0, s48, 6144
    s_nop 0
    buffer_load_dwordx4 v101, s[76:79], s57 offen lds
    s_add_u32 m0, s48, 7168
    s_nop 0
    buffer_load_dwordx4 v102, s[76:79], s57 offen lds
    s_add_u32 m0, s48, 8192
    s_nop 0
    buffer_load_dwordx4 v103, s[76:79], s57 offen lds
    s_add_u32 m0, s48, 9216
    s_nop 0
    buffer_load_dwordx4 v104, s[76:79], s57 offen lds
    s_add_u32 s56, s56, s53
    s_add_u32 m0, s48, 10240
    s_nop 0
    buffer_load_dwordx4 v100, s[76:79], s56 offen lds
    s_add_u32 m0, s48, 11264
    s_nop 0
    buffer_load_dwordx4 v101, s[76:79], s56 offen lds
    s_add_u32 m0, s48, 12288
    s_nop 0
    buffer_load_dwordx4 v102, s[76:79], s56 offen lds
    s_add_u32 m0, s48, 13312
    s_nop 0
    buffer_load_dwordx4 v103, s[76:79], s56 offen lds
    s_add_u32 m0, s48, 14336
    s_nop 0
    buffer_load_dwordx4 v104, s[76:79], s56 offen lds
    s_add_u32 s57, s56, 10240
    s_add_u32 m0, s48, 15360
    s_nop 0
    buffer_load_dwordx4 v100, s[76:79], s57 offen lds
    s_add_u32 m0, s48, 16384
    s_nop 0
    buffer_load_dwordx4 v101, s[76:79], s57 offen lds
    s_add_u32 m0, s48, 17408
    s_nop 0
    buffer_load_dwordx4 v102, s[76:79], s57 offen lds
    s_add_u32 m0, s48, 18432
    s_nop 0
    buffer_load_dwordx4 v103, s[76:79], s57 offen lds
    s_add_u32 m0, s48, 19456
    s_nop 0
    buffer_load_dwordx4 v104, s[76:79], s57 offen lds
    s_branch L_k1_R_proc
L_k1_R_lam:
    s_sub_u32 s56, s44, 70
    s_mul_i32 s56, s56, 204800
    s_add_u32 s56, s56, s46
    s_add_u32 s57, s56, 71680
    s_add_u32 m0, s48, 0
    s_nop 0
    buffer_load_dwordx4 v105, s[76:79], s57 offen lds
    s_add_u32 m0, s48, 1024
    s_nop 0
    buffer_load_dwordx4 v106, s[76:79], s57 offen lds
    s_add_u32 m0, s48, 2048
    s_nop 0
    buffer_load_dwordx4 v107, s[76:79], s57 offen lds
    s_add_u32 m0, s48, 3072
    s_nop 0
    buffer_load_dwordx4 v108, s[76:79], s57 offen lds
    s_add_u32 m0, s48, 4096
    s_nop 0
    buffer_load_dwordx4 v109, s[76:79], s57 offen lds
    s_add_u32 s57, s56, 20480
    s_add_u32 m0, s48, 5120
    s_nop 0
    buffer_load_dwordx4 v105, s[76:79], s57 offen lds
    s_add_u32 m0, s48, 6144
    s_nop 0
    buffer_load_dwordx4 v106, s[76:79], s57 offen lds
    s_add_u32 m0, s48, 7168
    s_nop 0
    buffer_load_dwordx4 v107, s[76:79], s57 offen lds
    s_add_u32 m0, s48, 8192
    s_nop 0
    buffer_load_dwordx4 v108, s[76:79], s57 offen lds
    s_add_u32 m0, s48, 9216
    s_nop 0
    buffer_load_dwordx4 v109, s[76:79], s57 offen lds
    s_add_u32 s57, s56, 174080
    s_add_u32 m0, s48, 10240
    s_nop 0
    buffer_load_dwordx4 v105, s[76:79], s57 offen lds
    s_add_u32 m0, s48, 11264
    s_nop 0
    buffer_load_dwordx4 v106, s[76:79], s57 offen lds
    s_add_u32 m0, s48, 12288
    s_nop 0
    buffer_load_dwordx4 v107, s[76:79], s57 offen lds
    s_add_u32 m0, s48, 13312
    s_nop 0
    buffer_load_dwordx4 v108, s[76:79], s57 offen lds
    s_add_u32 m0, s48, 14336
    s_nop 0
    buffer_load_dwordx4 v109, s[76:79], s57 offen lds
    s_add_u32 s57, s56, 122880
    s_add_u32 m0, s48, 15360
    s_nop 0
    buffer_load_dwordx4 v105, s[76:79], s57 offen lds
    s_add_u32 m0, s48, 16384
    s_nop 0
    buffer_load_dwordx4 v106, s[76:79], s57 offen lds
    s_add_u32 m0, s48, 17408
    s_nop 0
    buffer_load_dwordx4 v107, s[76:79], s57 offen lds
    s_add_u32 m0, s48, 18432
    s_nop 0
    buffer_load_dwordx4 v108, s[76:79], s57 offen lds
    s_add_u32 m0, s48, 19456
    s_nop 0
    buffer_load_dwordx4 v109, s[76:79], s57 offen lds
L_k1_R_proc:
    s_mul_i32 s56, s45, 296
    s_add_u32 s56, s56, s44
    s_mul_i32 s56, s56, 5120
    s_add_u32 s56, s56, 10485760
    s_waitcnt vmcnt(0)
    ds_read_b64_tr_b16 v[16:17], v110 offset:0
    ds_read_b64_tr_b16 v[18:19], v110 offset:10240
    ds_read_b64_tr_b16 v[20:21], v110 offset:8
    ds_read_b64_tr_b16 v[22:23], v110 offset:10248
    ds_read_b64_tr_b16 v[24:25], v110 offset:64
    ds_read_b64_tr_b16 v[26:27], v110 offset:10304
    ds_read_b64_tr_b16 v[28:29], v110 offset:72
    ds_read_b64_tr_b16 v[30:31], v110 offset:10312
    ds_read_b64_tr_b16 v[32:33], v111 offset:128
    ds_read_b64_tr_b16 v[34:35], v111 offset:10368
    ds_read_b64_tr_b16 v[36:37], v110 offset:160
    ds_read_b64_tr_b16 v[38:39], v110 offset:10400
    ds_read_b64_tr_b16 v[40:41], v110 offset:168
    ds_read_b64_tr_b16 v[42:43], v110 offset:10408
    ds_read_b64_tr_b16 v[44:45], v110 offset:224
    ds_read_b64_tr_b16 v[46:47], v110 offset:10464
    ds_read_b64_tr_b16 v[48:49], v110 offset:232
    ds_read_b64_tr_b16 v[50:51], v110 offset:10472
    ds_read_b64_tr_b16 v[52:53], v111 offset:288
    ds_read_b64_tr_b16 v[54:55], v111 offset:10528
    ds_read_b64_tr_b16 v[56:57], v110 offset:320
    ds_read_b64_tr_b16 v[58:59], v110 offset:10560
    ds_read_b64_tr_b16 v[60:61], v110 offset:328
    ds_read_b64_tr_b16 v[62:63], v110 offset:10568
    ds_read_b64_tr_b16 v[64:65], v110 offset:384
    ds_read_b64_tr_b16 v[66:67], v110 offset:10624
    ds_read_b64_tr_b16 v[68:69], v110 offset:392
    ds_read_b64_tr_b16 v[70:71], v110 offset:10632
    ds_read_b64_tr_b16 v[72:73], v111 offset:448
    ds_read_b64_tr_b16 v[74:75], v111 offset:10688
    ds_read_b64_tr_b16 v[76:77], v110 offset:480
    ds_read_b64_tr_b16 v[78:79], v110 offset:10720
    ds_read_b64_tr_b16 v[80:81], v110 offset:488
    ds_read_b64_tr_b16 v[82:83], v110 offset:10728
    ds_read_b64_tr_b16 v[84:85], v110 offset:544
    ds_read_b64_tr_b16 v[86:87], v110 offset:10784
    ds_read_b64_tr_b16 v[88:89], v110 offset:552
    ds_read_b64_tr_b16 v[90:91], v110 offset:10792
    ds_read_b64_tr_b16 v[92:93], v111 offset:608
    ds_read_b64_tr_b16 v[94:95], v111 offset:10848
    s_add_u32 s57, s56, 4096
    s_waitcnt lgkmcnt(15)
    buffer_store_dwordx4 v[16:19], v112, s[36:39], s56 offen offset:0 sc1
    buffer_store_dwordx4 v[20:23], v112, s[36:39], s56 offen offset:1024 sc1
    buffer_store_dwordx4 v[24:27], v112, s[36:39], s56 offen offset:2048 sc1
    buffer_store_dwordx4 v[28:31], v112, s[36:39], s56 offen offset:3072 sc1
    buffer_store_dwordx4 v[32:35], v112, s[36:39], s57 offen sc1
    s_add_u32 s56, s56, 378880
    s_add_u32 s57, s56, 4096
    s_waitcnt lgkmcnt(15)
    buffer_store_dwordx4 v[36:39], v112, s[36:39], s56 offen offset:0 sc1
    buffer_store_dwordx4 v[40:43], v112, s[36:39], s56 offen offset:1024 sc1
    buffer_store_dwordx4 v[44:47], v112, s[36:39], s56 offen offset:2048 sc1
    buffer_store_dwordx4 v[48:51], v112, s[36:39], s56 offen offset:3072 sc1
    buffer_store_dwordx4 v[52:55], v112, s[36:39], s57 offen sc1
    s_add_u32 s56, s56, 378880
    s_add_u32 s57, s56, 4096
    s_waitcnt lgkmcnt(10)
    buffer_store_dwordx4 v[56:59], v112, s[36:39], s56 offen offset:0 sc1
    buffer_store_dwordx4 v[60:63], v112, s[36:39], s56 offen offset:1024 sc1
    buffer_store_dwordx4 v[64:67], v112, s[36:39], s56 offen offset:2048 sc1
    buffer_store_dwordx4 v[68:71], v112, s[36:39], s56 offen offset:3072 sc1
    buffer_store_dwordx4 v[72:75], v112, s[36:39], s57 offen sc1
    s_add_u32 s56, s56, 378880
    s_add_u32 s57, s56, 4096
    s_waitcnt lgkmcnt(0)
    buffer_store_dwordx4 v[76:79], v112, s[36:39], s56 offen offset:0 sc1
    buffer_store_dwordx4 v[80:83], v112, s[36:39], s56 offen offset:1024 sc1
    buffer_store_dwordx4 v[84:87], v112, s[36:39], s56 offen offset:2048 sc1
    buffer_store_dwordx4 v[88:91], v112, s[36:39], s56 offen offset:3072 sc1
    buffer_store_dwordx4 v[92:95], v112, s[36:39], s57 offen sc1
    s_add_u32 s54, s54, 128
    s_cmp_lt_u32 s54, 148
    s_cbranch_scc1 L_k1_R_job
L_k1_R_end:
    s_waitcnt vmcnt(0)
    s_barrier
    s_cmp_eq_u32 s3, 0
    s_cbranch_scc0 L_fl_57
    v_mov_b32 v8, 1
    v_mov_b32 v9, 0
    s_mov_b64 exec, 1
    buffer_store_dword v8, v9, s[36:39], s95 offen sc1
    s_mov_b64 exec, -1
L_fl_57:
    v_and_b32 v2, 7, v0
    v_lshlrev_b32 v2, 5, v2
    s_mov_b32 s56, 0
    s_mov_b32 s75, 0
L_k1_R_hs:
    buffer_load_dword v3, v2, s[28:31], 0 offen sc1
    s_add_u32 s56, s56, 1
    s_waitcnt vmcnt(0)
    v_cmp_ne_u32 vcc, 32, v3
    s_nop 3
    s_cmp_eq_u64 vcc, 0
    s_cbranch_scc1 L_k1_done2
    s_cmp_gt_u32 s56, 0x8000
    s_cbranch_scc1 L_k1_done2
    s_sleep 2
    s_branch L_k1_R_hs
L_k1_done:
    s_waitcnt vmcnt(0)
L_k1_done1:
    s_barrier
    s_cmp_eq_u32 s3, 0
    s_cbranch_scc0 L_fl_58
    v_mov_b32 v2, 1
    v_mov_b32 v3, 0
    s_mov_b64 exec, 1
    buffer_store_dword v2, v3, s[36:39], s95 offen sc1
    s_mov_b64 exec, -1
L_fl_58:
L_k1_done2:
    s_branch L_k2f
L_k1_end:
    s_endpgm
L_k2f:
    s_load_dwordx2 s[8:9], s[0:1], 72
    s_load_dwordx2 s[4:5], s[0:1], 0
    s_load_dwordx2 s[6:7], s[0:1], 56
    s_and_b32 s26, s2, 7
    s_lshr_b32 s27, s2, 3
    s_lshl_b32 s10, s26, 2
    s_and_b32 s26, s27, 3
    s_add_u32 s10, s10, s26
    s_lshr_b32 s11, s27, 2
    v_lshlrev_b32 v1, 4, v0
    s_and_b32 s28, s3, 3
    s_mul_i32 s29, s28, 36864
    s_lshl_b32 s30, s10, 2
    s_add_u32 s30, s30, s28
    s_mul_i32 s50, s30, 20480
    s_add_u32 s50, s50, 13631488
    s_mul_i32 s58, s10, 216
    s_add_u32 s58, s58, s28
    s_lshl_b32 s58, s58, 10
    s_lshr_b32 s31, s10, 1
    s_lshl_b32 s31, s31, 7
    s_add_u32 s31, s31, 16252928
    s_xor_b32 s26, s28, 0
    s_mul_i32 s26, s26, 55296
    v_add_u32 v4, s26, v1
    s_xor_b32 s26, s28, 1
    s_mul_i32 s26, s26, 55296
    v_add_u32 v5, s26, v1
    s_xor_b32 s26, s28, 2
    s_mul_i32 s26, s26, 55296
    v_add_u32 v6, s26, v1
    s_xor_b32 s26, s28, 3
    s_mul_i32 s26, s26, 55296
    v_add_u32 v7, s26, v1
    s_waitcnt lgkmcnt(0)
    s_mov_b32 s20, s8
    s_mov_b32 s21, s9
    s_mov_b32 s22, 33554432
    s_mov_b32 s23, 0x20000
    s_cmp_ge_u32 s3, 4
    s_cbranch_scc0 L_k2_comp
    v_add_u32 v2, 4096, v1
    v_lshlrev_b32 v3, 3, v0
    s_mul_i32 s59, s11, 74
    s_add_u32 s59, s59, s28
    s_mul_i32 s59, s59, 5120
    s_add_u32 s59, s59, 10485760
    v_and_b32 v10, 15, v0
    v_lshlrev_b32 v10, 2, v10
    s_mov_b32 s27, 16256000
    s_mov_b32 s26, 0
L_sr_59:
    buffer_load_dword v11, v10, s[20:23], s27 offen sc1
    s_add_u32 s26, s26, 1
    s_waitcnt vmcnt(0)
    v_cmp_ne_u32 vcc, 1, v11
    s_nop 3
    s_cmp_eq_u64 vcc, 0
    s_cbranch_scc1 L_sr_60
    s_sleep 0
    s_cmp_gt_u32 s26, 0x8000
    s_cbranch_scc0 L_sr_59
L_sr_60:
    s_add_u32 m0, s29, 4096
    s_add_u32 s25, s59, 0
    buffer_load_dwordx4 v1, s[20:23], s25 offen offset:0 sc1 lds
    buffer_load_dwordx4 v1, s[20:23], s25 offen offset:1024 sc1 lds
    buffer_load_dwordx4 v1, s[20:23], s25 offen offset:2048 sc1 lds
    buffer_load_dwordx4 v1, s[20:23], s25 offen offset:3072 sc1 lds
    s_add_u32 m0, s29, 8192
    s_nop 0
    buffer_load_dwordx4 v2, s[20:23], s25 offen sc1 lds
    s_add_u32 m0, s29, 13312
    s_add_u32 s25, s59, 20480
    buffer_load_dwordx4 v1, s[20:23], s25 offen offset:0 sc1 lds
    buffer_load_dwordx4 v1, s[20:23], s25 offen offset:1024 sc1 lds
    buffer_load_dwordx4 v1, s[20:23], s25 offen offset:2048 sc1 lds
    buffer_load_dwordx4 v1, s[20:23], s25 offen offset:3072 sc1 lds
    s_add_u32 m0, s29, 17408
    s_nop 0
    buffer_load_dwordx4 v2, s[20:23], s25 offen sc1 lds
    s_add_u32 m0, s29, 22528
    s_add_u32 s25, s59, 40960
    buffer_load_dwordx4 v1, s[20:23], s25 offen offset:0 sc1 lds
    buffer_load_dwordx4 v1, s[20:23], s25 offen offset:1024 sc1 lds
    buffer_load_dwordx4 v1, s[20:23], s25 offen offset:2048 sc1 lds
    buffer_load_dwordx4 v1, s[20:23], s25 offen offset:3072 sc1 lds
    s_add_u32 m0, s29, 26624
    s_nop 0
    buffer_load_dwordx4 v2, s[20:23], s25 offen sc1 lds
    s_add_u32 m0, s29, 31744
    s_add_u32 s25, s59, 61440
    buffer_load_dwordx4 v1, s[20:23], s25 offen offset:0 sc1 lds
    buffer_load_dwordx4 v1, s[20:23], s25 offen offset:1024 sc1 lds
    buffer_load_dwordx4 v1, s[20:23], s25 offen offset:2048 sc1 lds
    buffer_load_dwordx4 v1, s[20:23], s25 offen offset:3072 sc1 lds
    s_add_u32 m0, s29, 35840
    s_nop 0
    buffer_load_dwordx4 v2, s[20:23], s25 offen sc1 lds
    s_lshl_b32 s52, s11, 16
    s_lshl_b32 s27, s28, 11
    s_add_u32 s52, s52, s27
    s_add_u32 s52, s52, 9961472
    s_lshl_b32 s26, s30, 3
    s_add_u32 s26, s26, s11
    s_mul_i32 s26, s26, 2560
    s_add_u32 s53, s26, 7340032
    s_lshr_b32 s26, s11, 1
    s_lshl_b32 s26, s26, 10
    s_and_b32 s27, s11, 1
    s_lshl_b32 s27, s27, 3
    s_add_u32 s26, s26, s27
    s_add_u32 s54, s50, s26
    s_add_u32 s54, s54, 16384
    s_lshl_b32 s26, s11, 11
    s_add_u32 s51, s50, s26
    v_lshrrev_b32 v10, 4, v0
    v_bfe_u32 v11, v0, 2, 2
    v_cmp_eq_u32 s[32:33], 0, v10
    v_cmp_eq_u32 s[40:41], 0, v11
    v_cmp_eq_u32 s[34:35], 1, v10
    v_cmp_eq_u32 s[42:43], 1, v11
    v_cmp_eq_u32 s[36:37], 2, v10
    v_cmp_eq_u32 s[44:45], 2, v11
    v_cmp_eq_u32 s[38:39], 3, v10
    v_cmp_eq_u32 s[46:47], 3, v11
    v_xor_b32 v12, 2, v10
    v_cmp_eq_u32 s[48:49], v12, v11
    v_lshlrev_b32 v13, 7, v10
    v_add_u32 v13, 147456, v13
    v_lshrrev_b32 v14, 1, v10
    v_lshl_add_u32 v14, v14, 6, v13
    v_add_u32 v15, 147456, v3
    s_lshl_b32 s26, s28, 10
    v_add_u32 v16, s26, v15
    v_add_u32 v17, s29, v1
    s_lshl_b32 s26, s11, 7
    s_add_u32 s26, s26, 16254976
    v_lshlrev_b32 v8, 2, v0
    v_add_u32 v8, s26, v8
    s_and_b32 s27, s11, 4
    s_add_u32 s26, s31, s27
    s_add_u32 s26, s26, 36
    v_mov_b32 v9, s26
    v_cmp_gt_u32 vcc, 8, v0
    s_nop 1
    v_cndmask_b32 v8, v9, v8, vcc
    s_barrier
    s_lshl_b32 s31, s10, 7
    s_add_u32 s31, s31, 16257024
    v_and_b32 v20, 7, v0
    v_lshlrev_b32 v20, 2, v20
    s_waitcnt vmcnt(15)
    s_waitcnt lgkmcnt(0)
    s_barrier
    buffer_load_dword v9, v8, s[20:23], 0 offen sc1
    s_waitcnt vmcnt(11)
    s_waitcnt lgkmcnt(0)
    s_barrier
    s_add_u32 s24, s58, 16384
    s_add_u32 m0, s29, 0
    s_nop 0
    buffer_load_dwordx4 v4, s[20:23], s24 offen sc1 lds
    s_add_u32 m0, s29, 1024
    s_nop 0
    buffer_load_dwordx4 v5, s[20:23], s24 offen sc1 lds
    s_add_u32 m0, s29, 2048
    s_nop 0
    buffer_load_dwordx4 v6, s[20:23], s24 offen sc1 lds
    s_add_u32 m0, s29, 3072
    s_nop 0
    buffer_load_dwordx4 v7, s[20:23], s24 offen sc1 lds
    s_add_u32 m0, s29, 4096
    s_add_u32 s25, s59, 81920
    buffer_load_dwordx4 v1, s[20:23], s25 offen offset:0 sc1 lds
    buffer_load_dwordx4 v1, s[20:23], s25 offen offset:1024 sc1 lds
    buffer_load_dwordx4 v1, s[20:23], s25 offen offset:2048 sc1 lds
    buffer_load_dwordx4 v1, s[20:23], s25 offen offset:3072 sc1 lds
    s_add_u32 m0, s29, 8192
    s_nop 0
    buffer_load_dwordx4 v2, s[20:23], s25 offen sc1 lds
    s_waitcnt vmcnt(9)
    v_cmp_ne_u32 vcc, 1, v9
    s_nop 3
    s_cmp_eq_u64 vcc, 0
    s_cbranch_scc1 L_kok_61
    s_mov_b32 s26, 0
L_sk_62:
    buffer_load_dword v9, v8, s[20:23], 0 offen sc1
    s_add_u32 s26, s26, 1
    s_waitcnt vmcnt(0)
    v_cmp_ne_u32 vcc, 1, v9
    s_nop 3
    s_cmp_eq_u64 vcc, 0
    s_cbranch_scc1 L_sk_63
    s_sleep 0
    s_cmp_gt_u32 s26, 0x8000
    s_cbranch_scc0 L_sk_62
L_sk_63:
L_kok_61:
    buffer_load_dwordx4 v[24:27], v1, s[20:23], s52 offen offset:0 sc1
    buffer_load_dwordx4 v[28:31], v1, s[20:23], s52 offen offset:1024 sc1
    s_add_u32 s52, s52, 8192
    buffer_load_dwordx4 v[32:35], v1, s[20:23], s52 offen offset:0 sc1
    buffer_load_dwordx4 v[36:39], v1, s[20:23], s52 offen offset:1024 sc1
    s_add_u32 s52, s52, 8192
    buffer_load_dwordx4 v[40:43], v1, s[20:23], s52 offen offset:0 sc1
    buffer_load_dwordx4 v[44:47], v1, s[20:23], s52 offen offset:1024 sc1
    s_add_u32 s52, s52, 8192
    buffer_load_dwordx4 v[48:51], v1, s[20:23], s52 offen offset:0 sc1
    buffer_load_dwordx4 v[52:55], v1, s[20:23], s52 offen offset:1024 sc1
    s_add_u32 s52, s52, 8192
    buffer_load_dwordx4 v[56:59], v1, s[20:23], s52 offen offset:0 sc1
    buffer_load_dwordx4 v[60:63], v1, s[20:23], s52 offen offset:1024 sc1
    s_add_u32 s52, s52, 8192
    buffer_load_dwordx4 v[64:67], v1, s[20:23], s52 offen offset:0 sc1
    buffer_load_dwordx4 v[68:71], v1, s[20:23], s52 offen offset:1024 sc1
    s_add_u32 s52, s52, 8192
    buffer_load_dwordx4 v[72:75], v1, s[20:23], s52 offen offset:0 sc1
    buffer_load_dwordx4 v[76:79], v1, s[20:23], s52 offen offset:1024 sc1
    s_add_u32 s52, s52, 8192
    buffer_load_dwordx4 v[80:83], v1, s[20:23], s52 offen offset:0 sc1
    buffer_load_dwordx4 v[84:87], v1, s[20:23], s52 offen offset:1024 sc1
    buffer_load_dwordx4 v[88:91], v1, s[20:23], s53 offen sc1
    buffer_load_dwordx4 v[92:95], v1, s[20:23], s53 offen offset:1024 sc1
    buffer_load_dwordx2 v[96:97], v3, s[20:23], s53 offen offset:2048 sc1
    s_waitcnt lgkmcnt(0)
    s_barrier
    s_add_u32 s24, s58, 20480
    s_add_u32 m0, s29, 9216
    s_nop 0
    buffer_load_dwordx4 v4, s[20:23], s24 offen sc1 lds
    s_add_u32 m0, s29, 10240
    s_nop 0
    buffer_load_dwordx4 v5, s[20:23], s24 offen sc1 lds
    s_add_u32 m0, s29, 11264
    s_nop 0
    buffer_load_dwordx4 v6, s[20:23], s24 offen sc1 lds
    s_add_u32 m0, s29, 12288
    s_nop 0
    buffer_load_dwordx4 v7, s[20:23], s24 offen sc1 lds
    s_add_u32 m0, s29, 13312
    s_add_u32 s25, s59, 102400
    buffer_load_dwordx4 v1, s[20:23], s25 offen offset:0 sc1 lds
    buffer_load_dwordx4 v1, s[20:23], s25 offen offset:1024 sc1 lds
    buffer_load_dwordx4 v1, s[20:23], s25 offen offset:2048 sc1 lds
    buffer_load_dwordx4 v1, s[20:23], s25 offen offset:3072 sc1 lds
    s_add_u32 m0, s29, 17408
    s_nop 0
    buffer_load_dwordx4 v2, s[20:23], s25 offen sc1 lds
    s_waitcnt lgkmcnt(0)
    s_barrier
    s_add_u32 s24, s58, 24576
    s_add_u32 m0, s29, 18432
    s_nop 0
    buffer_load_dwordx4 v4, s[20:23], s24 offen sc1 lds
    s_add_u32 m0, s29, 19456
    s_nop 0
    buffer_load_dwordx4 v5, s[20:23], s24 offen sc1 lds
    s_add_u32 m0, s29, 20480
    s_nop 0
    buffer_load_dwordx4 v6, s[20:23], s24 offen sc1 lds
    s_add_u32 m0, s29, 21504
    s_nop 0
    buffer_load_dwordx4 v7, s[20:23], s24 offen sc1 lds
    s_add_u32 m0, s29, 22528
    s_add_u32 s25, s59, 122880
    buffer_load_dwordx4 v1, s[20:23], s25 offen offset:0 sc1 lds
    buffer_load_dwordx4 v1, s[20:23], s25 offen offset:1024 sc1 lds
    buffer_load_dwordx4 v1, s[20:23], s25 offen offset:2048 sc1 lds
    buffer_load_dwordx4 v1, s[20:23], s25 offen offset:3072 sc1 lds
    s_add_u32 m0, s29, 26624
    s_nop 0
    buffer_load_dwordx4 v2, s[20:23], s25 offen sc1 lds
    s_waitcnt vmcnt(21)
    v_pk_add_f32 v[24:25], v[24:25], v[32:33]
    v_pk_add_f32 v[40:41], v[40:41], v[48:49]
    v_pk_add_f32 v[56:57], v[56:57], v[64:65]
    v_pk_add_f32 v[72:73], v[72:73], v[80:81]
    v_pk_add_f32 v[24:25], v[24:25], v[40:41]
    v_pk_add_f32 v[56:57], v[56:57], v[72:73]
    v_pk_add_f32 v[24:25], v[24:25], v[56:57]
    v_pk_add_f32 v[26:27], v[26:27], v[34:35]
    v_pk_add_f32 v[42:43], v[42:43], v[50:51]
    v_pk_add_f32 v[58:59], v[58:59], v[66:67]
    v_pk_add_f32 v[74:75], v[74:75], v[82:83]
    v_pk_add_f32 v[26:27], v[26:27], v[42:43]
    v_pk_add_f32 v[58:59], v[58:59], v[74:75]
    v_pk_add_f32 v[26:27], v[26:27], v[58:59]
    v_cvt_pk_bf16_f32 v32, v24, v25
    v_cvt_pk_bf16_f32 v33, v26, v27
    ds_write_b64 v16, v[32:33] offset:0
    v_pk_add_f32 v[28:29], v[28:29], v[36:37]
    v_pk_add_f32 v[44:45], v[44:45], v[52:53]
    v_pk_add_f32 v[60:61], v[60:61], v[68:69]
    v_pk_add_f32 v[76:77], v[76:77], v[84:85]
    v_pk_add_f32 v[28:29], v[28:29], v[44:45]
    v_pk_add_f32 v[60:61], v[60:61], v[76:77]
    v_pk_add_f32 v[28:29], v[28:29], v[60:61]
    v_pk_add_f32 v[30:31], v[30:31], v[38:39]
    v_pk_add_f32 v[46:47], v[46:47], v[54:55]
    v_pk_add_f32 v[62:63], v[62:63], v[70:71]
    v_pk_add_f32 v[78:79], v[78:79], v[86:87]
    v_pk_add_f32 v[30:31], v[30:31], v[46:47]
    v_pk_add_f32 v[62:63], v[62:63], v[78:79]
    v_pk_add_f32 v[30:31], v[30:31], v[62:63]
    v_cvt_pk_bf16_f32 v34, v28, v29
    v_cvt_pk_bf16_f32 v35, v30, v31
    ds_write_b64 v16, v[34:35] offset:512
    s_waitcnt lgkmcnt(0)
    s_barrier
    s_add_u32 s24, s58, 28672
    s_add_u32 m0, s29, 27648
    s_nop 0
    buffer_load_dwordx4 v4, s[20:23], s24 offen sc1 lds
    s_add_u32 m0, s29, 28672
    s_nop 0
    buffer_load_dwordx4 v5, s[20:23], s24 offen sc1 lds
    s_add_u32 m0, s29, 29696
    s_nop 0
    buffer_load_dwordx4 v6, s[20:23], s24 offen sc1 lds
    s_add_u32 m0, s29, 30720
    s_nop 0
    buffer_load_dwordx4 v7, s[20:23], s24 offen sc1 lds
    s_add_u32 m0, s29, 31744
    s_add_u32 s25, s59, 143360
    buffer_load_dwordx4 v1, s[20:23], s25 offen offset:0 sc1 lds
    buffer_load_dwordx4 v1, s[20:23], s25 offen offset:1024 sc1 lds
    buffer_load_dwordx4 v1, s[20:23], s25 offen offset:2048 sc1 lds
    buffer_load_dwordx4 v1, s[20:23], s25 offen offset:3072 sc1 lds
    s_add_u32 m0, s29, 35840
    s_nop 0
    buffer_load_dwordx4 v2, s[20:23], s25 offen sc1 lds
    ds_read_b64 v[40:41], v15 offset:0
    ds_read_b64 v[42:43], v15 offset:512
    ds_read_b64 v[44:45], v15 offset:1024
    ds_read_b64 v[46:47], v15 offset:1536
    ds_read_b64 v[48:49], v15 offset:2048
    ds_read_b64 v[50:51], v15 offset:2560
    ds_read_b64 v[52:53], v15 offset:3072
    ds_read_b64 v[54:55], v15 offset:3584
    ds_read_b64 v[56:57], v13 offset:1024
    ds_read_b64 v[58:59], v13 offset:1056
    ds_read_b64 v[60:61], v13 offset:2624
    ds_read_b64 v[62:63], v13 offset:2656
    ds_read_b64 v[64:65], v14 offset:3584
    s_waitcnt vmcnt(27)
    v_cndmask_b32 v66, 0, v96, s[32:33]
    v_cndmask_b32 v67, 0, v97, s[32:33]
    v_cndmask_b32 v68, 0, v96, s[34:35]
    v_cndmask_b32 v69, 0, v97, s[34:35]
    v_cndmask_b32 v70, 0, v96, s[36:37]
    v_cndmask_b32 v71, 0, v97, s[36:37]
    v_cndmask_b32 v72, 0, v96, s[38:39]
    v_cndmask_b32 v73, 0, v97, s[38:39]
    s_waitcnt lgkmcnt(0)
    v_cndmask_b32 v54, 0, v54, s[48:49]
    v_cndmask_b32 v55, 0, v55, s[48:49]
    v_mfma_f32_16x16x16_bf16 v[120:123], v[56:57], v[88:89], 0
    v_mfma_f32_16x16x16_bf16 v[124:127], v[58:59], v[90:91], 0
    v_mfma_f32_16x16x16_bf16 v[128:131], v[60:61], v[92:93], 0
    v_mfma_f32_16x16x16_bf16 v[132:135], v[62:63], v[94:95], 0
    v_mfma_f32_16x16x16_bf16 v[120:123], v[64:65], v[66:67], v[120:123]
    v_cndmask_b32 v74, 0, v44, s[44:45]
    v_cndmask_b32 v75, 0, v45, s[44:45]
    v_mfma_f32_16x16x16_bf16 v[124:127], v[64:65], v[68:69], v[124:127]
    v_cndmask_b32 v76, 0, v44, s[46:47]
    v_cndmask_b32 v77, 0, v45, s[46:47]
    v_mfma_f32_16x16x16_bf16 v[128:131], v[64:65], v[70:71], v[128:131]
    v_cndmask_b32 v78, 0, v50, s[40:41]
    v_cndmask_b32 v79, 0, v51, s[40:41]
    v_mfma_f32_16x16x16_bf16 v[132:135], v[64:65], v[72:73], v[132:135]
    v_cndmask_b32 v80, 0, v50, s[42:43]
    v_cndmask_b32 v81, 0, v51, s[42:43]
    v_mfma_f32_16x16x16_bf16 v[100:103], v[40:41], v[88:89], 0
    v_mfma_f32_16x16x16_bf16 v[104:107], v[42:43], v[90:91], 0
    v_mfma_f32_16x16x16_bf16 v[108:111], v[46:47], v[92:93], 0
    v_mfma_f32_16x16x16_bf16 v[112:115], v[48:49], v[94:95], 0
    v_mfma_f32_16x16x16_bf16 v[116:119], v[54:55], v[96:97], 0
    s_mov_b32 s27, 0x358637bd
    v_mfma_f32_16x16x16_bf16 v[100:103], v[52:53], v[66:67], v[100:103]
    v_mfma_f32_16x16x16_bf16 v[116:119], v[74:75], v[88:89], v[116:119]
    v_add_f32 v120, s27, v120
    v_mfma_f32_16x16x16_bf16 v[104:107], v[52:53], v[68:69], v[104:107]
    v_mfma_f32_16x16x16_bf16 v[116:119], v[76:77], v[90:91], v[116:119]
    v_add_f32 v124, s27, v124
    v_mfma_f32_16x16x16_bf16 v[108:111], v[52:53], v[70:71], v[108:111]
    v_mfma_f32_16x16x16_bf16 v[116:119], v[78:79], v[92:93], v[116:119]
    v_add_f32 v128, s27, v128
    v_mfma_f32_16x16x16_bf16 v[112:115], v[52:53], v[72:73], v[112:115]
    v_mfma_f32_16x16x16_bf16 v[116:119], v[80:81], v[94:95], v[116:119]
    v_add_f32 v132, s27, v132
    v_rcp_f32 v120, v120
    v_rcp_f32 v124, v124
    v_rcp_f32 v128, v128
    v_rcp_f32 v132, v132
    s_nop 1
    v_cndmask_b32 v121, v128, v132, s[34:35]
    v_cndmask_b32 v121, v121, v120, s[36:37]
    v_cndmask_b32 v121, v121, v124, s[38:39]
    v_pk_mul_f32 v[100:101], v[100:101], v[120:121] op_sel_hi:[1,0]
    v_pk_mul_f32 v[102:103], v[102:103], v[120:121] op_sel_hi:[1,0]
    v_pk_mul_f32 v[104:105], v[104:105], v[124:125] op_sel_hi:[1,0]
    v_pk_mul_f32 v[106:107], v[106:107], v[124:125] op_sel_hi:[1,0]
    v_pk_mul_f32 v[108:109], v[108:109], v[128:129] op_sel_hi:[1,0]
    v_pk_mul_f32 v[110:111], v[110:111], v[128:129] op_sel_hi:[1,0]
    v_pk_mul_f32 v[112:113], v[112:113], v[132:133] op_sel_hi:[1,0]
    v_pk_mul_f32 v[114:115], v[114:115], v[132:133] op_sel_hi:[1,0]
    v_mul_f32 v116, v116, v121
    v_mul_f32 v117, v117, v121
    v_mul_f32 v118, v118, v121
    v_mul_f32 v119, v119, v121
    v_cvt_pk_bf16_f32 v140, v100, v101
    v_cvt_pk_bf16_f32 v141, v102, v103
    v_cvt_pk_bf16_f32 v142, v104, v105
    v_cvt_pk_bf16_f32 v143, v106, v107
    v_cvt_pk_bf16_f32 v144, v108, v109
    v_cvt_pk_bf16_f32 v145, v110, v111
    v_cvt_pk_bf16_f32 v146, v112, v113
    v_cvt_pk_bf16_f32 v147, v114, v115
    v_cvt_pk_bf16_f32 v148, v116, v117
    v_cvt_pk_bf16_f32 v149, v118, v119
    buffer_store_dwordx4 v[140:143], v1, s[20:23], s51 offen sc1
    buffer_store_dwordx4 v[144:147], v1, s[20:23], s51 offen offset:1024 sc1
    buffer_store_dwordx2 v[148:149], v1, s[20:23], s54 offen sc1
    s_waitcnt vmcnt(21)
    s_waitcnt lgkmcnt(0)
    s_barrier
    s_add_u32 s24, s58, 32768
    s_add_u32 m0, s29, 0
    s_nop 0
    buffer_load_dwordx4 v4, s[20:23], s24 offen sc1 lds
    s_add_u32 m0, s29, 1024
    s_nop 0
    buffer_load_dwordx4 v5, s[20:23], s24 offen sc1 lds
    s_add_u32 m0, s29, 2048
    s_nop 0
    buffer_load_dwordx4 v6, s[20:23], s24 offen sc1 lds
    s_add_u32 m0, s29, 3072
    s_nop 0
    buffer_load_dwordx4 v7, s[20:23], s24 offen sc1 lds
    s_add_u32 m0, s29, 4096
    s_add_u32 s25, s59, 163840
    buffer_load_dwordx4 v1, s[20:23], s25 offen offset:0 sc1 lds
    buffer_load_dwordx4 v1, s[20:23], s25 offen offset:1024 sc1 lds
    buffer_load_dwordx4 v1, s[20:23], s25 offen offset:2048 sc1 lds
    buffer_load_dwordx4 v1, s[20:23], s25 offen offset:3072 sc1 lds
    s_add_u32 m0, s29, 8192
    s_nop 0
    buffer_load_dwordx4 v2, s[20:23], s25 offen sc1 lds
    s_waitcnt vmcnt(9)
    s_waitcnt lgkmcnt(0)
    s_barrier
    v_mov_b32 v21, 1
    v_mov_b32 v22, 2146435072
    s_lshl_b32 s26, s11, 2
    s_add_u32 s26, s26, s31
    s_cmp_eq_u32 s3, 4
    s_cbranch_scc0 L_of_64
    v_mov_b32 v22, 0
L_of_64:
    s_mov_b64 exec, 1
    buffer_store_dword v21, v22, s[20:23], s26 offen sc1
    s_mov_b64 exec, -1
    s_add_u32 s24, s58, 36864
    s_add_u32 m0, s29, 9216
    s_nop 0
    buffer_load_dwordx4 v4, s[20:23], s24 offen sc1 lds
    s_add_u32 m0, s29, 10240
    s_nop 0
    buffer_load_dwordx4 v5, s[20:23], s24 offen sc1 lds
    s_add_u32 m0, s29, 11264
    s_nop 0
    buffer_load_dwordx4 v6, s[20:23], s24 offen sc1 lds
    s_add_u32 m0, s29, 12288
    s_nop 0
    buffer_load_dwordx4 v7, s[20:23], s24 offen sc1 lds
    s_add_u32 m0, s29, 13312
    s_add_u32 s25, s59, 184320
    buffer_load_dwordx4 v1, s[20:23], s25 offen offset:0 sc1 lds
    buffer_load_dwordx4 v1, s[20:23], s25 offen offset:1024 sc1 lds
    buffer_load_dwordx4 v1, s[20:23], s25 offen offset:2048 sc1 lds
    buffer_load_dwordx4 v1, s[20:23], s25 offen offset:3072 sc1 lds
    s_add_u32 m0, s29, 17408
    s_nop 0
    buffer_load_dwordx4 v2, s[20:23], s25 offen sc1 lds
    s_waitcnt lgkmcnt(0)
    s_barrier
    s_add_u32 s24, s58, 40960
    s_add_u32 m0, s29, 18432
    s_nop 0
    buffer_load_dwordx4 v4, s[20:23], s24 offen sc1 lds
    s_add_u32 m0, s29, 19456
    s_nop 0
    buffer_load_dwordx4 v5, s[20:23], s24 offen sc1 lds
    s_add_u32 m0, s29, 20480
    s_nop 0
    buffer_load_dwordx4 v6, s[20:23], s24 offen sc1 lds
    s_add_u32 m0, s29, 21504
    s_nop 0
    buffer_load_dwordx4 v7, s[20:23], s24 offen sc1 lds
    s_add_u32 m0, s29, 22528
    s_add_u32 s25, s59, 204800
    buffer_load_dwordx4 v1, s[20:23], s25 offen offset:0 sc1 lds
    buffer_load_dwordx4 v1, s[20:23], s25 offen offset:1024 sc1 lds
    buffer_load_dwordx4 v1, s[20:23], s25 offen offset:2048 sc1 lds
    buffer_load_dwordx4 v1, s[20:23], s25 offen offset:3072 sc1 lds
    s_add_u32 m0, s29, 26624
    s_nop 0
    buffer_load_dwordx4 v2, s[20:23], s25 offen sc1 lds
    s_waitcnt vmcnt(19)
    s_waitcnt lgkmcnt(0)
    s_barrier
    s_add_u32 s24, s58, 45056
    s_add_u32 m0, s29, 27648
    s_nop 0
    buffer_load_dwordx4 v4, s[20:23], s24 offen sc1 lds
    s_add_u32 m0, s29, 28672
    s_nop 0
    buffer_load_dwordx4 v5, s[20:23], s24 offen sc1 lds
    s_add_u32 m0, s29, 29696
    s_nop 0
    buffer_load_dwordx4 v6, s[20:23], s24 offen sc1 lds
    s_add_u32 m0, s29, 30720
    s_nop 0
    buffer_load_dwordx4 v7, s[20:23], s24 offen sc1 lds
    s_add_u32 m0, s29, 31744
    s_add_u32 s25, s59, 225280
    buffer_load_dwordx4 v1, s[20:23], s25 offen offset:0 sc1 lds
    buffer_load_dwordx4 v1, s[20:23], s25 offen offset:1024 sc1 lds
    buffer_load_dwordx4 v1, s[20:23], s25 offen offset:2048 sc1 lds
    buffer_load_dwordx4 v1, s[20:23], s25 offen offset:3072 sc1 lds
    s_add_u32 m0, s29, 35840
    s_nop 0
    buffer_load_dwordx4 v2, s[20:23], s25 offen sc1 lds
    s_waitcnt vmcnt(18)
    s_waitcnt lgkmcnt(0)
    s_barrier
    s_add_u32 s24, s58, 49152
    s_add_u32 m0, s29, 0
    s_nop 0
    buffer_load_dwordx4 v4, s[20:23], s24 offen sc1 lds
    s_add_u32 m0, s29, 1024
    s_nop 0
    buffer_load_dwordx4 v5, s[20:23], s24 offen sc1 lds
    s_add_u32 m0, s29, 2048
    s_nop 0
    buffer_load_dwordx4 v6, s[20:23], s24 offen sc1 lds
    s_add_u32 m0, s29, 3072
    s_nop 0
    buffer_load_dwordx4 v7, s[20:23], s24 offen sc1 lds
    s_add_u32 m0, s29, 4096
    s_add_u32 s25, s59, 245760
    buffer_load_dwordx4 v1, s[20:23], s25 offen offset:0 sc1 lds
    buffer_load_dwordx4 v1, s[20:23], s25 offen offset:1024 sc1 lds
    buffer_load_dwordx4 v1, s[20:23], s25 offen offset:2048 sc1 lds
    buffer_load_dwordx4 v1, s[20:23], s25 offen offset:3072 sc1 lds
    s_add_u32 m0, s29, 8192
    s_nop 0
    buffer_load_dwordx4 v2, s[20:23], s25 offen sc1 lds
    buffer_load_dword v23, v20, s[20:23], s31 offen sc1
    s_waitcnt vmcnt(19)
    s_waitcnt lgkmcnt(0)
    s_barrier
    s_add_u32 s24, s58, 53248
    s_cmp_ge_u32 s28, 2
    s_cselect_b32 s24, 2146435072, s24
    s_add_u32 m0, s29, 9216
    s_nop 0
    buffer_load_dwordx4 v4, s[20:23], s24 offen sc1 lds
    s_add_u32 m0, s29, 10240
    s_nop 0
    buffer_load_dwordx4 v5, s[20:23], s24 offen sc1 lds
    s_add_u32 m0, s29, 11264
    s_nop 0
    buffer_load_dwordx4 v6, s[20:23], s24 offen sc1 lds
    s_add_u32 m0, s29, 12288
    s_nop 0
    buffer_load_dwordx4 v7, s[20:23], s24 offen sc1 lds
    s_add_u32 m0, s29, 13312
    s_add_u32 s25, s59, 266240
    buffer_load_dwordx4 v1, s[20:23], s25 offen offset:0 sc1 lds
    buffer_load_dwordx4 v1, s[20:23], s25 offen offset:1024 sc1 lds
    buffer_load_dwordx4 v1, s[20:23], s25 offen offset:2048 sc1 lds
    buffer_load_dwordx4 v1, s[20:23], s25 offen offset:3072 sc1 lds
    s_add_u32 m0, s29, 17408
    s_nop 0
    buffer_load_dwordx4 v2, s[20:23], s25 offen sc1 lds
    s_waitcnt vmcnt(19)
    s_waitcnt lgkmcnt(0)
    s_barrier
    s_waitcnt vmcnt(9)
    v_cmp_ne_u32 vcc, 1, v23
    s_nop 3
    s_cmp_eq_u64 vcc, 0
    s_cbranch_scc1 L_ook_65
    s_mov_b32 s26, 0
L_so_66:
    buffer_load_dword v23, v20, s[20:23], s31 offen sc1
    s_add_u32 s26, s26, 1
    s_waitcnt vmcnt(0)
    v_cmp_ne_u32 vcc, 1, v23
    s_nop 3
    s_cmp_eq_u64 vcc, 0
    s_cbranch_scc1 L_so_67
    s_sleep 0
    s_cmp_gt_u32 s26, 0x8000
    s_cbranch_scc0 L_so_66
L_so_67:
L_ook_65:
    s_add_u32 m0, s29, 18432
    s_add_u32 s24, s50, 0
    buffer_load_dwordx4 v1, s[20:23], s24 offen offset:0 sc1 lds
    buffer_load_dwordx4 v1, s[20:23], s24 offen offset:1024 sc1 lds
    buffer_load_dwordx4 v1, s[20:23], s24 offen offset:2048 sc1 lds
    buffer_load_dwordx4 v1, s[20:23], s24 offen offset:3072 sc1 lds
    s_add_u32 m0, s29, 22528
    s_add_u32 s25, s59, 276480
    buffer_load_dwordx4 v1, s[20:23], s25 offen offset:0 sc1 lds
    buffer_load_dwordx4 v1, s[20:23], s25 offen offset:1024 sc1 lds
    buffer_load_dwordx4 v1, s[20:23], s25 offen offset:2048 sc1 lds
    buffer_load_dwordx4 v1, s[20:23], s25 offen offset:3072 sc1 lds
    s_add_u32 m0, s29, 26624
    s_nop 0
    buffer_load_dwordx4 v2, s[20:23], s25 offen sc1 lds
    s_waitcnt lgkmcnt(0)
    s_barrier
    s_add_u32 m0, s29, 27648
    s_add_u32 s24, s50, 4096
    buffer_load_dwordx4 v1, s[20:23], s24 offen offset:0 sc1 lds
    buffer_load_dwordx4 v1, s[20:23], s24 offen offset:1024 sc1 lds
    buffer_load_dwordx4 v1, s[20:23], s24 offen offset:2048 sc1 lds
    buffer_load_dwordx4 v1, s[20:23], s24 offen offset:3072 sc1 lds
    s_add_u32 m0, s29, 31744
    s_add_u32 s25, s59, 296960
    buffer_load_dwordx4 v1, s[20:23], s25 offen offset:0 sc1 lds
    buffer_load_dwordx4 v1, s[20:23], s25 offen offset:1024 sc1 lds
    buffer_load_dwordx4 v1, s[20:23], s25 offen offset:2048 sc1 lds
    buffer_load_dwordx4 v1, s[20:23], s25 offen offset:3072 sc1 lds
    s_add_u32 m0, s29, 35840
    s_nop 0
    buffer_load_dwordx4 v2, s[20:23], s25 offen sc1 lds
    s_waitcnt vmcnt(18)
    s_waitcnt lgkmcnt(0)
    s_barrier
    s_add_u32 m0, s29, 0
    s_add_u32 s24, s50, 8192
    buffer_load_dwordx4 v1, s[20:23], s24 offen offset:0 sc1 lds
    buffer_load_dwordx4 v1, s[20:23], s24 offen offset:1024 sc1 lds
    buffer_load_dwordx4 v1, s[20:23], s24 offen offset:2048 sc1 lds
    buffer_load_dwordx4 v1, s[20:23], s24 offen offset:3072 sc1 lds
    s_add_u32 m0, s29, 4096
    s_add_u32 s25, s59, 317440
    buffer_load_dwordx4 v1, s[20:23], s25 offen offset:0 sc1 lds
    buffer_load_dwordx4 v1, s[20:23], s25 offen offset:1024 sc1 lds
    buffer_load_dwordx4 v1, s[20:23], s25 offen offset:2048 sc1 lds
    buffer_load_dwordx4 v1, s[20:23], s25 offen offset:3072 sc1 lds
    s_add_u32 m0, s29, 8192
    s_nop 0
    buffer_load_dwordx4 v2, s[20:23], s25 offen sc1 lds
    s_waitcnt vmcnt(18)
    s_waitcnt lgkmcnt(0)
    s_barrier
    s_add_u32 m0, s29, 9216
    s_add_u32 s24, s50, 12288
    buffer_load_dwordx4 v1, s[20:23], s24 offen offset:0 sc1 lds
    buffer_load_dwordx4 v1, s[20:23], s24 offen offset:1024 sc1 lds
    buffer_load_dwordx4 v1, s[20:23], s24 offen offset:2048 sc1 lds
    buffer_load_dwordx4 v1, s[20:23], s24 offen offset:3072 sc1 lds
    s_add_u32 m0, s29, 13312
    s_add_u32 s25, s59, 337920
    buffer_load_dwordx4 v1, s[20:23], s25 offen offset:0 sc1 lds
    buffer_load_dwordx4 v1, s[20:23], s25 offen offset:1024 sc1 lds
    buffer_load_dwordx4 v1, s[20:23], s25 offen offset:2048 sc1 lds
    buffer_load_dwordx4 v1, s[20:23], s25 offen offset:3072 sc1 lds
    s_add_u32 m0, s29, 17408
    s_nop 0
    buffer_load_dwordx4 v2, s[20:23], s25 offen sc1 lds
    s_waitcnt vmcnt(18)
    s_waitcnt lgkmcnt(0)
    s_barrier
    s_add_u32 m0, s29, 18432
    s_add_u32 s24, s50, 16384
    buffer_load_dwordx4 v1, s[20:23], s24 offen offset:0 sc1 lds
    buffer_load_dwordx4 v1, s[20:23], s24 offen offset:1024 sc1 lds
    buffer_load_dwordx4 v1, s[20:23], s24 offen offset:2048 sc1 lds
    buffer_load_dwordx4 v1, s[20:23], s24 offen offset:3072 sc1 lds
    s_add_u32 m0, s29, 22528
    s_add_u32 s25, s59, 358400
    buffer_load_dwordx4 v1, s[20:23], s25 offen offset:0 sc1 lds
    buffer_load_dwordx4 v1, s[20:23], s25 offen offset:1024 sc1 lds
    buffer_load_dwordx4 v1, s[20:23], s25 offen offset:2048 sc1 lds
    buffer_load_dwordx4 v1, s[20:23], s25 offen offset:3072 sc1 lds
    s_add_u32 m0, s29, 26624
    s_nop 0
    buffer_load_dwordx4 v2, s[20:23], s25 offen sc1 lds
    s_waitcnt vmcnt(18)
    s_waitcnt lgkmcnt(0)
    s_barrier
    s_waitcnt vmcnt(9)
    s_waitcnt lgkmcnt(0)
    s_barrier
    s_waitcnt vmcnt(0)
    s_waitcnt lgkmcnt(0)
    s_barrier
    s_endpgm
L_k2_comp:
    v_min_u32 v10, 8, v0
    v_lshlrev_b32 v10, 2, v10
    s_mov_b32 s12, s4
    s_mov_b32 s13, s5
    s_mov_b32 s14, 2621440
    s_mov_b32 s15, 0x20000
    s_mov_b32 s16, s6
    s_mov_b32 s17, s7
    s_mov_b32 s18, 2621440
    s_mov_b32 s19, 0x20000
    v_lshrrev_b32 v12, 4, v0
    v_and_b32 v14, 15, v0
    s_lshl_b32 s26, s30, 4
    v_add_u32 v14, s26, v14
    v_mul_u32_u24 v14, 1280, v14
    s_mul_i32 s26, s11, 160
    v_add_u32 v14, s26, v14
    v_lshl_add_u32 v15, v12, 3, v14
    v_lshl_add_u32 v14, v12, 4, v14
    buffer_load_dwordx4 v[246:249], v14, s[12:15], 0 offen
    buffer_load_dwordx4 v[250:253], v14, s[12:15], 0 offen offset:64
    buffer_load_dwordx2 v[254:255], v15, s[12:15], 0 offen offset:128
    s_xor_b32 s26, s28, 1
    s_mul_i32 s27, s26, 36864
    v_add_u32 v9, s27, v1
    s_lshl_b32 s26, s26, 12
    s_add_u32 s26, s26, 147456
    v_add_u32 v17, s26, v1
    s_xor_b32 s26, s28, 2
    s_mul_i32 s27, s26, 36864
    v_add_u32 v244, s27, v1
    s_lshl_b32 s26, s26, 12
    s_add_u32 s26, s26, 147456
    v_add_u32 v18, s26, v1
    s_xor_b32 s26, s28, 3
    s_mul_i32 s27, s26, 36864
    v_add_u32 v245, s27, v1
    s_lshl_b32 s26, s26, 12
    s_add_u32 s26, s26, 147456
    v_add_u32 v19, s26, v1
    v_add_u32 v8, s29, v1
    s_lshl_b32 s26, s28, 12
    s_add_u32 s26, s26, 147456
    v_add_u32 v16, s26, v1
    v_add_u32 v20, 0, v1
    v_add_u32 v21, 36864, v1
    v_add_u32 v22, 73728, v1
    v_add_u32 v23, 110592, v1
    v_mov_b32 v144, 0
    v_mov_b32 v145, 0
    v_mov_b32 v146, 0
    v_mov_b32 v147, 0
    v_mov_b32 v148, 0
    v_mov_b32 v149, 0
    v_mov_b32 v150, 0
    v_mov_b32 v151, 0
    v_mov_b32 v152, 0
    v_mov_b32 v153, 0
    v_mov_b32 v154, 0
    v_mov_b32 v155, 0
    v_mov_b32 v156, 0
    v_mov_b32 v157, 0
    v_mov_b32 v158, 0
    v_mov_b32 v159, 0
    v_mov_b32 v160, 0
    v_mov_b32 v161, 0
    v_mov_b32 v162, 0
    v_mov_b32 v163, 0
    v_mov_b32 v164, 0
    v_mov_b32 v165, 0
    v_mov_b32 v166, 0
    v_mov_b32 v167, 0
    v_mov_b32 v168, 0
    v_mov_b32 v169, 0
    v_mov_b32 v170, 0
    v_mov_b32 v171, 0
    v_mov_b32 v172, 0
    v_mov_b32 v173, 0
    v_mov_b32 v174, 0
    v_mov_b32 v175, 0
    v_mov_b32 v176, 0
    v_mov_b32 v177, 0
    v_mov_b32 v178, 0
    v_mov_b32 v179, 0
    v_mov_b32 v180, 0
    v_mov_b32 v181, 0
    v_mov_b32 v182, 0
    v_mov_b32 v183, 0
    v_mov_b32 v184, 0
    v_mov_b32 v185, 0
    v_mov_b32 v186, 0
    v_mov_b32 v187, 0
    v_mov_b32 v188, 0
    v_mov_b32 v189, 0
    v_mov_b32 v190, 0
    v_mov_b32 v191, 0
    v_mov_b32 v192, 0
    v_mov_b32 v193, 0
    v_mov_b32 v194, 0
    v_mov_b32 v195, 0
    v_mov_b32 v196, 0
    v_mov_b32 v197, 0
    v_mov_b32 v198, 0
    v_mov_b32 v199, 0
    v_mov_b32 v200, 0
    v_mov_b32 v201, 0
    v_mov_b32 v202, 0
    v_mov_b32 v203, 0
    v_mov_b32 v204, 0
    v_mov_b32 v205, 0
    v_mov_b32 v206, 0
    v_mov_b32 v207, 0
    v_mov_b32 v208, 0
    v_mov_b32 v209, 0
    v_mov_b32 v210, 0
    v_mov_b32 v211, 0
    v_mov_b32 v212, 0
    v_mov_b32 v213, 0
    v_mov_b32 v214, 0
    v_mov_b32 v215, 0
    v_mov_b32 v216, 0
    v_mov_b32 v217, 0
    v_mov_b32 v218, 0
    v_mov_b32 v219, 0
    v_mov_b32 v220, 0
    v_mov_b32 v221, 0
    v_mov_b32 v222, 0
    v_mov_b32 v223, 0
    v_mov_b32 v224, 0
    v_mov_b32 v225, 0
    v_mov_b32 v226, 0
    v_mov_b32 v227, 0
    v_mov_b32 v228, 0
    v_mov_b32 v229, 0
    v_mov_b32 v230, 0
    v_mov_b32 v231, 0
    v_mov_b32 v232, 0
    v_mov_b32 v233, 0
    v_mov_b32 v234, 0
    v_mov_b32 v235, 0
    v_mov_b32 v236, 0
    v_mov_b32 v237, 0
    v_mov_b32 v238, 0
    v_mov_b32 v239, 0
    v_mov_b32 v240, 0
    v_mov_b32 v241, 0
    v_mov_b32 v242, 0
    v_mov_b32 v243, 0
    s_cmp_eq_u32 s3, 0
    s_cbranch_scc0 L_np_68
    s_mov_b32 s26, 0
L_sf_69:
    buffer_load_dword v11, v10, s[20:23], s31 offen sc1
    s_add_u32 s26, s26, 1
    s_waitcnt vmcnt(0)
    v_cmp_ne_u32 vcc, 1, v11
    s_nop 3
    s_cmp_eq_u64 vcc, 0
    s_cbranch_scc1 L_sf_70
    s_sleep 0
    s_cmp_gt_u32 s26, 0x8000
    s_cbranch_scc0 L_sf_69
L_sf_70:
L_np_68:
    s_waitcnt vmcnt(0)
    s_barrier
    s_add_u32 m0, s29, 0
    s_nop 0
    buffer_load_dwordx4 v4, s[20:23], s58 offen sc1 lds
    s_add_u32 m0, s29, 1024
    s_nop 0
    buffer_load_dwordx4 v5, s[20:23], s58 offen sc1 lds
    s_add_u32 m0, s29, 2048
    s_nop 0
    buffer_load_dwordx4 v6, s[20:23], s58 offen sc1 lds
    s_add_u32 m0, s29, 3072
    s_nop 0
    buffer_load_dwordx4 v7, s[20:23], s58 offen sc1 lds
    s_add_u32 s58, s58, 4096
    s_add_u32 m0, s29, 9216
    s_nop 0
    buffer_load_dwordx4 v4, s[20:23], s58 offen sc1 lds
    s_add_u32 m0, s29, 10240
    s_nop 0
    buffer_load_dwordx4 v5, s[20:23], s58 offen sc1 lds
    s_add_u32 m0, s29, 11264
    s_nop 0
    buffer_load_dwordx4 v6, s[20:23], s58 offen sc1 lds
    s_add_u32 m0, s29, 12288
    s_nop 0
    buffer_load_dwordx4 v7, s[20:23], s58 offen sc1 lds
    s_add_u32 s58, s58, 4096
    s_add_u32 m0, s29, 18432
    s_nop 0
    buffer_load_dwordx4 v4, s[20:23], s58 offen sc1 lds
    s_add_u32 m0, s29, 19456
    s_nop 0
    buffer_load_dwordx4 v5, s[20:23], s58 offen sc1 lds
    s_add_u32 m0, s29, 20480
    s_nop 0
    buffer_load_dwordx4 v6, s[20:23], s58 offen sc1 lds
    s_add_u32 m0, s29, 21504
    s_nop 0
    buffer_load_dwordx4 v7, s[20:23], s58 offen sc1 lds
    s_add_u32 s58, s58, 4096
    s_add_u32 m0, s29, 27648
    s_nop 0
    buffer_load_dwordx4 v4, s[20:23], s58 offen sc1 lds
    s_add_u32 m0, s29, 28672
    s_nop 0
    buffer_load_dwordx4 v5, s[20:23], s58 offen sc1 lds
    s_add_u32 m0, s29, 29696
    s_nop 0
    buffer_load_dwordx4 v6, s[20:23], s58 offen sc1 lds
    s_add_u32 m0, s29, 30720
    s_nop 0
    buffer_load_dwordx4 v7, s[20:23], s58 offen sc1 lds
    s_mov_b32 s31, 0xbfb8aa3b
    s_mov_b32 s52, 0xffff0000
    s_waitcnt vmcnt(12)
    s_barrier
    ds_read_b128 v[24:27], v8 offset:0
    ds_read_b128 v[28:31], v8 offset:1024
    ds_read_b128 v[32:35], v8 offset:2048
    ds_read_b128 v[36:39], v8 offset:3072
    ds_read_b128 v[40:43], v8 offset:4096
    ds_read_b128 v[44:47], v8 offset:5120
    ds_read_b128 v[48:51], v8 offset:6144
    ds_read_b128 v[52:55], v8 offset:7168
    ds_read_b128 v[56:59], v8 offset:8192
    s_waitcnt lgkmcnt(0)
    s_waitcnt vmcnt(8)
    s_barrier
    ds_read_b128 v[60:63], v8 offset:9216
    v_mfma_f32_16x16x32_bf16 v[144:147], v[40:43], v[24:27], v[144:147]
    ds_read_b128 v[64:67], v8 offset:10240
    v_mfma_f32_16x16x32_bf16 v[160:163], v[44:47], v[24:27], v[160:163]
    ds_read_b128 v[68:71], v8 offset:11264
    v_mfma_f32_16x16x32_bf16 v[176:179], v[48:51], v[24:27], v[176:179]
    ds_read_b128 v[72:75], v8 offset:12288
    v_mfma_f32_16x16x32_bf16 v[192:195], v[52:55], v[24:27], v[192:195]
    ds_read_b128 v[76:79], v8 offset:13312
    v_mfma_f32_16x16x32_bf16 v[208:211], v[56:59], v[24:27], v[208:211]
    ds_read_b128 v[80:83], v8 offset:14336
    v_mfma_f32_16x16x32_bf16 v[148:151], v[40:43], v[28:31], v[148:151]
    ds_read_b128 v[84:87], v8 offset:15360
    v_mfma_f32_16x16x32_bf16 v[164:167], v[44:47], v[28:31], v[164:167]
    ds_read_b128 v[88:91], v8 offset:16384
    v_mfma_f32_16x16x32_bf16 v[180:183], v[48:51], v[28:31], v[180:183]
    ds_read_b128 v[92:95], v8 offset:17408
    v_mfma_f32_16x16x32_bf16 v[196:199], v[52:55], v[28:31], v[196:199]
    v_mfma_f32_16x16x32_bf16 v[212:215], v[56:59], v[28:31], v[212:215]
    v_mfma_f32_16x16x32_bf16 v[152:155], v[40:43], v[32:35], v[152:155]
    v_mfma_f32_16x16x32_bf16 v[168:171], v[44:47], v[32:35], v[168:171]
    v_mfma_f32_16x16x32_bf16 v[184:187], v[48:51], v[32:35], v[184:187]
    v_mfma_f32_16x16x32_bf16 v[200:203], v[52:55], v[32:35], v[200:203]
    v_mfma_f32_16x16x32_bf16 v[216:219], v[56:59], v[32:35], v[216:219]
    v_mfma_f32_16x16x32_bf16 v[156:159], v[40:43], v[36:39], v[156:159]
    v_mfma_f32_16x16x32_bf16 v[172:175], v[44:47], v[36:39], v[172:175]
    v_mfma_f32_16x16x32_bf16 v[188:191], v[48:51], v[36:39], v[188:191]
    v_mfma_f32_16x16x32_bf16 v[204:207], v[52:55], v[36:39], v[204:207]
    v_mfma_f32_16x16x32_bf16 v[220:223], v[56:59], v[36:39], v[220:223]
    s_waitcnt lgkmcnt(0)
    s_waitcnt vmcnt(4)
    s_barrier
    ds_read_b128 v[24:27], v8 offset:18432
    v_mfma_f32_16x16x32_bf16 v[144:147], v[76:79], v[60:63], v[144:147]
    ds_read_b128 v[28:31], v8 offset:19456
    v_mfma_f32_16x16x32_bf16 v[160:163], v[80:83], v[60:63], v[160:163]
    ds_read_b128 v[32:35], v8 offset:20480
    v_mfma_f32_16x16x32_bf16 v[176:179], v[84:87], v[60:63], v[176:179]
    ds_read_b128 v[36:39], v8 offset:21504
    v_mfma_f32_16x16x32_bf16 v[192:195], v[88:91], v[60:63], v[192:195]
    ds_read_b128 v[40:43], v8 offset:22528
    v_mfma_f32_16x16x32_bf16 v[208:211], v[92:95], v[60:63], v[208:211]
    ds_read_b128 v[44:47], v8 offset:23552
    v_mfma_f32_16x16x32_bf16 v[148:151], v[76:79], v[64:67], v[148:151]
    ds_read_b128 v[48:51], v8 offset:24576
    v_mfma_f32_16x16x32_bf16 v[164:167], v[80:83], v[64:67], v[164:167]
    ds_read_b128 v[52:55], v8 offset:25600
    v_mfma_f32_16x16x32_bf16 v[180:183], v[84:87], v[64:67], v[180:183]
    ds_read_b128 v[56:59], v8 offset:26624
    v_mfma_f32_16x16x32_bf16 v[196:199], v[88:91], v[64:67], v[196:199]
    v_mfma_f32_16x16x32_bf16 v[212:215], v[92:95], v[64:67], v[212:215]
    v_mfma_f32_16x16x32_bf16 v[152:155], v[76:79], v[68:71], v[152:155]
    v_mfma_f32_16x16x32_bf16 v[168:171], v[80:83], v[68:71], v[168:171]
    v_mfma_f32_16x16x32_bf16 v[184:187], v[84:87], v[68:71], v[184:187]
    v_mfma_f32_16x16x32_bf16 v[200:203], v[88:91], v[68:71], v[200:203]
    v_mfma_f32_16x16x32_bf16 v[216:219], v[92:95], v[68:71], v[216:219]
    v_mfma_f32_16x16x32_bf16 v[156:159], v[76:79], v[72:75], v[156:159]
    v_mfma_f32_16x16x32_bf16 v[172:175], v[80:83], v[72:75], v[172:175]
    v_mfma_f32_16x16x32_bf16 v[188:191], v[84:87], v[72:75], v[188:191]
    v_mfma_f32_16x16x32_bf16 v[204:207], v[88:91], v[72:75], v[204:207]
    v_mfma_f32_16x16x32_bf16 v[220:223], v[92:95], v[72:75], v[220:223]
    s_waitcnt lgkmcnt(0)
    s_waitcnt vmcnt(0)
    s_barrier
    ds_read_b128 v[60:63], v8 offset:27648
    v_mfma_f32_16x16x32_bf16 v[144:147], v[40:43], v[24:27], v[144:147]
    ds_read_b128 v[64:67], v8 offset:28672
    v_mfma_f32_16x16x32_bf16 v[160:163], v[44:47], v[24:27], v[160:163]
    ds_read_b128 v[68:71], v8 offset:29696
    v_mfma_f32_16x16x32_bf16 v[176:179], v[48:51], v[24:27], v[176:179]
    ds_read_b128 v[72:75], v8 offset:30720
    v_mfma_f32_16x16x32_bf16 v[192:195], v[52:55], v[24:27], v[192:195]
    ds_read_b128 v[76:79], v8 offset:31744
    v_mfma_f32_16x16x32_bf16 v[208:211], v[56:59], v[24:27], v[208:211]
    ds_read_b128 v[80:83], v8 offset:32768
    v_mfma_f32_16x16x32_bf16 v[148:151], v[40:43], v[28:31], v[148:151]
    ds_read_b128 v[84:87], v8 offset:33792
    v_mfma_f32_16x16x32_bf16 v[164:167], v[44:47], v[28:31], v[164:167]
    ds_read_b128 v[88:91], v8 offset:34816
    v_mfma_f32_16x16x32_bf16 v[180:183], v[48:51], v[28:31], v[180:183]
    ds_read_b128 v[92:95], v8 offset:35840
    v_mfma_f32_16x16x32_bf16 v[196:199], v[52:55], v[28:31], v[196:199]
    v_mfma_f32_16x16x32_bf16 v[212:215], v[56:59], v[28:31], v[212:215]
    v_mfma_f32_16x16x32_bf16 v[152:155], v[40:43], v[32:35], v[152:155]
    v_mfma_f32_16x16x32_bf16 v[168:171], v[44:47], v[32:35], v[168:171]
    v_mfma_f32_16x16x32_bf16 v[184:187], v[48:51], v[32:35], v[184:187]
    v_mfma_f32_16x16x32_bf16 v[200:203], v[52:55], v[32:35], v[200:203]
    v_mfma_f32_16x16x32_bf16 v[216:219], v[56:59], v[32:35], v[216:219]
    v_mfma_f32_16x16x32_bf16 v[156:159], v[40:43], v[36:39], v[156:159]
    v_mfma_f32_16x16x32_bf16 v[172:175], v[44:47], v[36:39], v[172:175]
    v_mfma_f32_16x16x32_bf16 v[188:191], v[48:51], v[36:39], v[188:191]
    v_mfma_f32_16x16x32_bf16 v[204:207], v[52:55], v[36:39], v[204:207]
    v_mfma_f32_16x16x32_bf16 v[220:223], v[56:59], v[36:39], v[220:223]
    s_waitcnt lgkmcnt(0)
    s_barrier
    ds_read_b128 v[24:27], v8 offset:0
    v_mfma_f32_16x16x32_bf16 v[144:147], v[76:79], v[60:63], v[144:147]
    ds_read_b128 v[28:31], v8 offset:1024
    v_mfma_f32_16x16x32_bf16 v[160:163], v[80:83], v[60:63], v[160:163]
    ds_read_b128 v[32:35], v8 offset:2048
    v_mfma_f32_16x16x32_bf16 v[176:179], v[84:87], v[60:63], v[176:179]
    ds_read_b128 v[36:39], v8 offset:3072
    v_mfma_f32_16x16x32_bf16 v[192:195], v[88:91], v[60:63], v[192:195]
    ds_read_b128 v[40:43], v8 offset:4096
    v_mfma_f32_16x16x32_bf16 v[208:211], v[92:95], v[60:63], v[208:211]
    ds_read_b128 v[44:47], v8 offset:5120
    v_mfma_f32_16x16x32_bf16 v[148:151], v[76:79], v[64:67], v[148:151]
    ds_read_b128 v[48:51], v8 offset:6144
    v_mfma_f32_16x16x32_bf16 v[164:167], v[80:83], v[64:67], v[164:167]
    ds_read_b128 v[52:55], v8 offset:7168
    v_mfma_f32_16x16x32_bf16 v[180:183], v[84:87], v[64:67], v[180:183]
    ds_read_b128 v[56:59], v8 offset:8192
    v_mfma_f32_16x16x32_bf16 v[196:199], v[88:91], v[64:67], v[196:199]
    v_mfma_f32_16x16x32_bf16 v[212:215], v[92:95], v[64:67], v[212:215]
    v_mfma_f32_16x16x32_bf16 v[152:155], v[76:79], v[68:71], v[152:155]
    v_mfma_f32_16x16x32_bf16 v[168:171], v[80:83], v[68:71], v[168:171]
    v_mfma_f32_16x16x32_bf16 v[184:187], v[84:87], v[68:71], v[184:187]
    v_mfma_f32_16x16x32_bf16 v[200:203], v[88:91], v[68:71], v[200:203]
    v_mfma_f32_16x16x32_bf16 v[216:219], v[92:95], v[68:71], v[216:219]
    v_mfma_f32_16x16x32_bf16 v[156:159], v[76:79], v[72:75], v[156:159]
    v_mfma_f32_16x16x32_bf16 v[172:175], v[80:83], v[72:75], v[172:175]
    v_mfma_f32_16x16x32_bf16 v[188:191], v[84:87], v[72:75], v[188:191]
    v_mfma_f32_16x16x32_bf16 v[204:207], v[88:91], v[72:75], v[204:207]
    v_mfma_f32_16x16x32_bf16 v[220:223], v[92:95], v[72:75], v[220:223]
    s_waitcnt lgkmcnt(0)
    s_barrier
    ds_read_b128 v[60:63], v8 offset:9216
    v_mfma_f32_16x16x32_bf16 v[144:147], v[40:43], v[24:27], v[144:147]
    ds_read_b128 v[64:67], v8 offset:10240
    v_mfma_f32_16x16x32_bf16 v[160:163], v[44:47], v[24:27], v[160:163]
    ds_read_b128 v[68:71], v8 offset:11264
    v_mfma_f32_16x16x32_bf16 v[176:179], v[48:51], v[24:27], v[176:179]
    ds_read_b128 v[72:75], v8 offset:12288
    v_mfma_f32_16x16x32_bf16 v[192:195], v[52:55], v[24:27], v[192:195]
    ds_read_b128 v[76:79], v8 offset:13312
    v_mfma_f32_16x16x32_bf16 v[208:211], v[56:59], v[24:27], v[208:211]
    ds_read_b128 v[80:83], v8 offset:14336
    v_mfma_f32_16x16x32_bf16 v[148:151], v[40:43], v[28:31], v[148:151]
    ds_read_b128 v[84:87], v8 offset:15360
    v_mfma_f32_16x16x32_bf16 v[164:167], v[44:47], v[28:31], v[164:167]
    ds_read_b128 v[88:91], v8 offset:16384
    v_mfma_f32_16x16x32_bf16 v[180:183], v[48:51], v[28:31], v[180:183]
    ds_read_b128 v[92:95], v8 offset:17408
    v_mfma_f32_16x16x32_bf16 v[196:199], v[52:55], v[28:31], v[196:199]
    v_mfma_f32_16x16x32_bf16 v[212:215], v[56:59], v[28:31], v[212:215]
    v_mfma_f32_16x16x32_bf16 v[152:155], v[40:43], v[32:35], v[152:155]
    v_mfma_f32_16x16x32_bf16 v[168:171], v[44:47], v[32:35], v[168:171]
    v_mfma_f32_16x16x32_bf16 v[184:187], v[48:51], v[32:35], v[184:187]
    v_mfma_f32_16x16x32_bf16 v[200:203], v[52:55], v[32:35], v[200:203]
    v_mfma_f32_16x16x32_bf16 v[216:219], v[56:59], v[32:35], v[216:219]
    v_mfma_f32_16x16x32_bf16 v[156:159], v[40:43], v[36:39], v[156:159]
    v_mfma_f32_16x16x32_bf16 v[172:175], v[44:47], v[36:39], v[172:175]
    v_mfma_f32_16x16x32_bf16 v[188:191], v[48:51], v[36:39], v[188:191]
    v_mfma_f32_16x16x32_bf16 v[204:207], v[52:55], v[36:39], v[204:207]
    v_mfma_f32_16x16x32_bf16 v[220:223], v[56:59], v[36:39], v[220:223]
    s_waitcnt lgkmcnt(0)
    s_barrier
    ds_read_b128 v[24:27], v8 offset:18432
    v_mfma_f32_16x16x32_bf16 v[144:147], v[76:79], v[60:63], v[144:147]
    ds_read_b128 v[28:31], v8 offset:19456
    v_mfma_f32_16x16x32_bf16 v[160:163], v[80:83], v[60:63], v[160:163]
    ds_read_b128 v[32:35], v8 offset:20480
    v_mfma_f32_16x16x32_bf16 v[176:179], v[84:87], v[60:63], v[176:179]
    ds_read_b128 v[36:39], v8 offset:21504
    v_mfma_f32_16x16x32_bf16 v[192:195], v[88:91], v[60:63], v[192:195]
    ds_read_b128 v[40:43], v8 offset:22528
    v_mfma_f32_16x16x32_bf16 v[208:211], v[92:95], v[60:63], v[208:211]
    ds_read_b128 v[44:47], v8 offset:23552
    v_mfma_f32_16x16x32_bf16 v[148:151], v[76:79], v[64:67], v[148:151]
    ds_read_b128 v[48:51], v8 offset:24576
    v_mfma_f32_16x16x32_bf16 v[164:167], v[80:83], v[64:67], v[164:167]
    ds_read_b128 v[52:55], v8 offset:25600
    v_mfma_f32_16x16x32_bf16 v[180:183], v[84:87], v[64:67], v[180:183]
    ds_read_b128 v[56:59], v8 offset:26624
    v_mfma_f32_16x16x32_bf16 v[196:199], v[88:91], v[64:67], v[196:199]
    v_mfma_f32_16x16x32_bf16 v[212:215], v[92:95], v[64:67], v[212:215]
    v_mfma_f32_16x16x32_bf16 v[152:155], v[76:79], v[68:71], v[152:155]
    v_mfma_f32_16x16x32_bf16 v[168:171], v[80:83], v[68:71], v[168:171]
    v_mfma_f32_16x16x32_bf16 v[184:187], v[84:87], v[68:71], v[184:187]
    v_mfma_f32_16x16x32_bf16 v[200:203], v[88:91], v[68:71], v[200:203]
    v_mfma_f32_16x16x32_bf16 v[216:219], v[92:95], v[68:71], v[216:219]
    v_mfma_f32_16x16x32_bf16 v[156:159], v[76:79], v[72:75], v[156:159]
    v_mfma_f32_16x16x32_bf16 v[172:175], v[80:83], v[72:75], v[172:175]
    v_mfma_f32_16x16x32_bf16 v[188:191], v[84:87], v[72:75], v[188:191]
    v_mfma_f32_16x16x32_bf16 v[204:207], v[88:91], v[72:75], v[204:207]
    v_mfma_f32_16x16x32_bf16 v[220:223], v[92:95], v[72:75], v[220:223]
    s_waitcnt lgkmcnt(0)
    s_barrier
    ds_read_b128 v[60:63], v8 offset:27648
    v_mfma_f32_16x16x32_bf16 v[144:147], v[40:43], v[24:27], v[144:147]
    ds_read_b128 v[64:67], v8 offset:28672
    v_mfma_f32_16x16x32_bf16 v[160:163], v[44:47], v[24:27], v[160:163]
    ds_read_b128 v[68:71], v8 offset:29696
    v_mfma_f32_16x16x32_bf16 v[176:179], v[48:51], v[24:27], v[176:179]
    ds_read_b128 v[72:75], v8 offset:30720
    v_mfma_f32_16x16x32_bf16 v[192:195], v[52:55], v[24:27], v[192:195]
    ds_read_b128 v[76:79], v8 offset:31744
    v_mfma_f32_16x16x32_bf16 v[208:211], v[56:59], v[24:27], v[208:211]
    ds_read_b128 v[80:83], v8 offset:32768
    v_mfma_f32_16x16x32_bf16 v[148:151], v[40:43], v[28:31], v[148:151]
    ds_read_b128 v[84:87], v8 offset:33792
    v_mfma_f32_16x16x32_bf16 v[164:167], v[44:47], v[28:31], v[164:167]
    ds_read_b128 v[88:91], v8 offset:34816
    v_mfma_f32_16x16x32_bf16 v[180:183], v[48:51], v[28:31], v[180:183]
    ds_read_b128 v[92:95], v8 offset:35840
    v_mfma_f32_16x16x32_bf16 v[196:199], v[52:55], v[28:31], v[196:199]
    v_mfma_f32_16x16x32_bf16 v[212:215], v[56:59], v[28:31], v[212:215]
    v_mfma_f32_16x16x32_bf16 v[152:155], v[40:43], v[32:35], v[152:155]
    v_mfma_f32_16x16x32_bf16 v[168:171], v[44:47], v[32:35], v[168:171]
    v_mfma_f32_16x16x32_bf16 v[184:187], v[48:51], v[32:35], v[184:187]
    v_mfma_f32_16x16x32_bf16 v[200:203], v[52:55], v[32:35], v[200:203]
    v_mfma_f32_16x16x32_bf16 v[216:219], v[56:59], v[32:35], v[216:219]
    v_mfma_f32_16x16x32_bf16 v[156:159], v[40:43], v[36:39], v[156:159]
    v_mfma_f32_16x16x32_bf16 v[172:175], v[44:47], v[36:39], v[172:175]
    v_mfma_f32_16x16x32_bf16 v[188:191], v[48:51], v[36:39], v[188:191]
    v_mfma_f32_16x16x32_bf16 v[204:207], v[52:55], v[36:39], v[204:207]
    v_mfma_f32_16x16x32_bf16 v[220:223], v[56:59], v[36:39], v[220:223]
    s_waitcnt lgkmcnt(0)
    s_barrier
    ds_read_b128 v[24:27], v8 offset:0
    v_mfma_f32_16x16x32_bf16 v[144:147], v[76:79], v[60:63], v[144:147]
    ds_read_b128 v[28:31], v8 offset:1024
    v_mfma_f32_16x16x32_bf16 v[160:163], v[80:83], v[60:63], v[160:163]
    ds_read_b128 v[32:35], v8 offset:2048
    v_mfma_f32_16x16x32_bf16 v[176:179], v[84:87], v[60:63], v[176:179]
    ds_read_b128 v[36:39], v8 offset:3072
    v_mfma_f32_16x16x32_bf16 v[192:195], v[88:91], v[60:63], v[192:195]
    ds_read_b128 v[40:43], v8 offset:4096
    v_mfma_f32_16x16x32_bf16 v[208:211], v[92:95], v[60:63], v[208:211]
    ds_read_b128 v[44:47], v8 offset:5120
    v_mfma_f32_16x16x32_bf16 v[148:151], v[76:79], v[64:67], v[148:151]
    ds_read_b128 v[48:51], v8 offset:6144
    v_mfma_f32_16x16x32_bf16 v[164:167], v[80:83], v[64:67], v[164:167]
    ds_read_b128 v[52:55], v8 offset:7168
    v_mfma_f32_16x16x32_bf16 v[180:183], v[84:87], v[64:67], v[180:183]
    ds_read_b128 v[56:59], v8 offset:8192
    v_mfma_f32_16x16x32_bf16 v[196:199], v[88:91], v[64:67], v[196:199]
    v_mfma_f32_16x16x32_bf16 v[212:215], v[92:95], v[64:67], v[212:215]
    v_mfma_f32_16x16x32_bf16 v[152:155], v[76:79], v[68:71], v[152:155]
    v_mfma_f32_16x16x32_bf16 v[168:171], v[80:83], v[68:71], v[168:171]
    v_mfma_f32_16x16x32_bf16 v[184:187], v[84:87], v[68:71], v[184:187]
    v_mfma_f32_16x16x32_bf16 v[200:203], v[88:91], v[68:71], v[200:203]
    v_mfma_f32_16x16x32_bf16 v[216:219], v[92:95], v[68:71], v[216:219]
    v_mfma_f32_16x16x32_bf16 v[156:159], v[76:79], v[72:75], v[156:159]
    v_mfma_f32_16x16x32_bf16 v[172:175], v[80:83], v[72:75], v[172:175]
    v_mfma_f32_16x16x32_bf16 v[188:191], v[84:87], v[72:75], v[188:191]
    v_mfma_f32_16x16x32_bf16 v[204:207], v[88:91], v[72:75], v[204:207]
    v_mfma_f32_16x16x32_bf16 v[220:223], v[92:95], v[72:75], v[220:223]
    s_waitcnt lgkmcnt(0)
    s_barrier
    ds_read_b128 v[60:63], v8 offset:9216
    v_mfma_f32_16x16x32_bf16 v[144:147], v[40:43], v[24:27], v[144:147]
    ds_read_b128 v[64:67], v8 offset:10240
    v_mfma_f32_16x16x32_bf16 v[160:163], v[44:47], v[24:27], v[160:163]
    ds_read_b128 v[68:71], v8 offset:11264
    v_mfma_f32_16x16x32_bf16 v[176:179], v[48:51], v[24:27], v[176:179]
    ds_read_b128 v[72:75], v8 offset:12288
    v_mfma_f32_16x16x32_bf16 v[192:195], v[52:55], v[24:27], v[192:195]
    ds_read_b128 v[76:79], v8 offset:13312
    v_mfma_f32_16x16x32_bf16 v[208:211], v[56:59], v[24:27], v[208:211]
    ds_read_b128 v[80:83], v8 offset:14336
    v_mfma_f32_16x16x32_bf16 v[148:151], v[40:43], v[28:31], v[148:151]
    ds_read_b128 v[84:87], v8 offset:15360
    v_mfma_f32_16x16x32_bf16 v[164:167], v[44:47], v[28:31], v[164:167]
    ds_read_b128 v[88:91], v8 offset:16384
    v_mfma_f32_16x16x32_bf16 v[180:183], v[48:51], v[28:31], v[180:183]
    ds_read_b128 v[92:95], v8 offset:17408
    v_mfma_f32_16x16x32_bf16 v[196:199], v[52:55], v[28:31], v[196:199]
    v_mfma_f32_16x16x32_bf16 v[212:215], v[56:59], v[28:31], v[212:215]
    v_mfma_f32_16x16x32_bf16 v[152:155], v[40:43], v[32:35], v[152:155]
    v_mfma_f32_16x16x32_bf16 v[168:171], v[44:47], v[32:35], v[168:171]
    v_mfma_f32_16x16x32_bf16 v[184:187], v[48:51], v[32:35], v[184:187]
    v_mfma_f32_16x16x32_bf16 v[200:203], v[52:55], v[32:35], v[200:203]
    v_mfma_f32_16x16x32_bf16 v[216:219], v[56:59], v[32:35], v[216:219]
    v_mfma_f32_16x16x32_bf16 v[156:159], v[40:43], v[36:39], v[156:159]
    v_mfma_f32_16x16x32_bf16 v[172:175], v[44:47], v[36:39], v[172:175]
    v_mfma_f32_16x16x32_bf16 v[188:191], v[48:51], v[36:39], v[188:191]
    v_mfma_f32_16x16x32_bf16 v[204:207], v[52:55], v[36:39], v[204:207]
    v_mfma_f32_16x16x32_bf16 v[220:223], v[56:59], v[36:39], v[220:223]
    s_waitcnt lgkmcnt(0)
    s_bitcmp1_b32 s28, 0
    s_cbranch_scc1 L_sw_71
    v_swap_b32 v62, v64
    v_swap_b32 v63, v65
    v_swap_b32 v70, v72
    v_swap_b32 v71, v73
    s_branch L_sw_72
L_sw_71:
    v_swap_b32 v60, v66
    v_swap_b32 v61, v67
    v_swap_b32 v68, v74
    v_swap_b32 v69, v75
L_sw_72:
    s_barrier
    ds_read_b128 v[24:27], v8 offset:18432
    v_mfma_f32_16x16x32_bf16 v[144:147], v[76:79], v[60:63], v[144:147]
    ds_read_b128 v[28:31], v8 offset:19456
    v_mfma_f32_16x16x32_bf16 v[160:163], v[80:83], v[60:63], v[160:163]
    ds_read_b128 v[32:35], v8 offset:20480
    v_mfma_f32_16x16x32_bf16 v[176:179], v[84:87], v[60:63], v[176:179]
    ds_read_b128 v[36:39], v8 offset:21504
    v_mfma_f32_16x16x32_bf16 v[192:195], v[88:91], v[60:63], v[192:195]
    ds_read_b128 v[40:43], v8 offset:22528
    v_mfma_f32_16x16x32_bf16 v[208:211], v[92:95], v[60:63], v[208:211]
    ds_read_b128 v[44:47], v8 offset:23552
    v_mfma_f32_16x16x32_bf16 v[148:151], v[76:79], v[64:67], v[148:151]
    ds_read_b128 v[48:51], v8 offset:24576
    v_mfma_f32_16x16x32_bf16 v[164:167], v[80:83], v[64:67], v[164:167]
    ds_read_b128 v[52:55], v8 offset:25600
    v_mfma_f32_16x16x32_bf16 v[180:183], v[84:87], v[64:67], v[180:183]
    ds_read_b128 v[56:59], v8 offset:26624
    v_mfma_f32_16x16x32_bf16 v[196:199], v[88:91], v[64:67], v[196:199]
    v_mfma_f32_16x16x32_bf16 v[212:215], v[92:95], v[64:67], v[212:215]
    v_mfma_f32_16x16x32_bf16 v[152:155], v[76:79], v[68:71], v[152:155]
    v_mfma_f32_16x16x32_bf16 v[168:171], v[80:83], v[68:71], v[168:171]
    v_mfma_f32_16x16x32_bf16 v[184:187], v[84:87], v[68:71], v[184:187]
    v_mfma_f32_16x16x32_bf16 v[200:203], v[88:91], v[68:71], v[200:203]
    v_mfma_f32_16x16x32_bf16 v[216:219], v[92:95], v[68:71], v[216:219]
    v_mfma_f32_16x16x32_bf16 v[156:159], v[76:79], v[72:75], v[156:159]
    v_mfma_f32_16x16x32_bf16 v[172:175], v[80:83], v[72:75], v[172:175]
    v_mfma_f32_16x16x32_bf16 v[188:191], v[84:87], v[72:75], v[188:191]
    v_mfma_f32_16x16x32_bf16 v[204:207], v[88:91], v[72:75], v[204:207]
    v_mfma_f32_16x16x32_bf16 v[220:223], v[92:95], v[72:75], v[220:223]
    s_waitcnt lgkmcnt(0)
    s_bitcmp1_b32 s28, 0
    s_cbranch_scc1 L_sw_73
    v_swap_b32 v26, v28
    v_swap_b32 v27, v29
    v_swap_b32 v34, v36
    v_swap_b32 v35, v37
    s_branch L_sw_74
L_sw_73:
    v_swap_b32 v24, v30
    v_swap_b32 v25, v31
    v_swap_b32 v32, v38
    v_swap_b32 v33, v39
L_sw_74:
    s_barrier
    ds_read_b128 v[60:63], v8 offset:27648
    v_mfma_f32_16x16x32_bf16 v[144:147], v[40:43], v[24:27], v[144:147]
    ds_read_b128 v[64:67], v8 offset:28672
    v_mfma_f32_16x16x32_bf16 v[160:163], v[44:47], v[24:27], v[160:163]
    ds_read_b128 v[68:71], v8 offset:29696
    v_mfma_f32_16x16x32_bf16 v[176:179], v[48:51], v[24:27], v[176:179]
    ds_read_b128 v[72:75], v8 offset:30720
    v_mfma_f32_16x16x32_bf16 v[192:195], v[52:55], v[24:27], v[192:195]
    ds_read_b128 v[76:79], v8 offset:31744
    v_mfma_f32_16x16x32_bf16 v[208:211], v[56:59], v[24:27], v[208:211]
    ds_read_b128 v[80:83], v8 offset:32768
    v_mfma_f32_16x16x32_bf16 v[148:151], v[40:43], v[28:31], v[148:151]
    ds_read_b128 v[84:87], v8 offset:33792
    v_mfma_f32_16x16x32_bf16 v[164:167], v[44:47], v[28:31], v[164:167]
    ds_read_b128 v[88:91], v8 offset:34816
    v_mfma_f32_16x16x32_bf16 v[180:183], v[48:51], v[28:31], v[180:183]
    ds_read_b128 v[92:95], v8 offset:35840
    v_mfma_f32_16x16x32_bf16 v[196:199], v[52:55], v[28:31], v[196:199]
    v_mfma_f32_16x16x32_bf16 v[212:215], v[56:59], v[28:31], v[212:215]
    v_mfma_f32_16x16x32_bf16 v[152:155], v[40:43], v[32:35], v[152:155]
    v_mfma_f32_16x16x32_bf16 v[168:171], v[44:47], v[32:35], v[168:171]
    v_mfma_f32_16x16x32_bf16 v[184:187], v[48:51], v[32:35], v[184:187]
    v_mfma_f32_16x16x32_bf16 v[200:203], v[52:55], v[32:35], v[200:203]
    v_mfma_f32_16x16x32_bf16 v[216:219], v[56:59], v[32:35], v[216:219]
    v_mfma_f32_16x16x32_bf16 v[156:159], v[40:43], v[36:39], v[156:159]
    v_mfma_f32_16x16x32_bf16 v[172:175], v[44:47], v[36:39], v[172:175]
    v_mfma_f32_16x16x32_bf16 v[188:191], v[48:51], v[36:39], v[188:191]
    v_mfma_f32_16x16x32_bf16 v[204:207], v[52:55], v[36:39], v[204:207]
    v_mfma_f32_16x16x32_bf16 v[220:223], v[56:59], v[36:39], v[220:223]
    s_waitcnt lgkmcnt(0)
    s_bitcmp1_b32 s28, 0
    s_cbranch_scc1 L_sw_75
    v_swap_b32 v62, v64
    v_swap_b32 v63, v65
    v_swap_b32 v70, v72
    v_swap_b32 v71, v73
    s_branch L_sw_76
L_sw_75:
    v_swap_b32 v60, v66
    v_swap_b32 v61, v67
    v_swap_b32 v68, v74
    v_swap_b32 v69, v75
L_sw_76:
    s_barrier
    ds_read_b128 v[24:27], v8 offset:0
    v_mfma_f32_16x16x32_bf16 v[144:147], v[76:79], v[60:63], v[144:147]
    ds_read_b128 v[28:31], v8 offset:1024
    v_mfma_f32_16x16x32_bf16 v[160:163], v[80:83], v[60:63], v[160:163]
    ds_read_b128 v[32:35], v8 offset:2048
    v_mfma_f32_16x16x32_bf16 v[176:179], v[84:87], v[60:63], v[176:179]
    ds_read_b128 v[36:39], v8 offset:3072
    v_mfma_f32_16x16x32_bf16 v[192:195], v[88:91], v[60:63], v[192:195]
    ds_read_b128 v[40:43], v8 offset:4096
    v_mfma_f32_16x16x32_bf16 v[208:211], v[92:95], v[60:63], v[208:211]
    ds_read_b128 v[44:47], v8 offset:5120
    v_mfma_f32_16x16x32_bf16 v[148:151], v[76:79], v[64:67], v[148:151]
    ds_read_b128 v[48:51], v8 offset:6144
    v_mfma_f32_16x16x32_bf16 v[164:167], v[80:83], v[64:67], v[164:167]
    ds_read_b128 v[52:55], v8 offset:7168
    v_mfma_f32_16x16x32_bf16 v[180:183], v[84:87], v[64:67], v[180:183]
    ds_read_b128 v[56:59], v8 offset:8192
    v_mfma_f32_16x16x32_bf16 v[196:199], v[88:91], v[64:67], v[196:199]
    v_mfma_f32_16x16x32_bf16 v[212:215], v[92:95], v[64:67], v[212:215]
    v_mfma_f32_16x16x32_bf16 v[152:155], v[76:79], v[68:71], v[152:155]
    v_mfma_f32_16x16x32_bf16 v[168:171], v[80:83], v[68:71], v[168:171]
    v_mfma_f32_16x16x32_bf16 v[184:187], v[84:87], v[68:71], v[184:187]
    v_mfma_f32_16x16x32_bf16 v[200:203], v[88:91], v[68:71], v[200:203]
    v_mfma_f32_16x16x32_bf16 v[216:219], v[92:95], v[68:71], v[216:219]
    v_mfma_f32_16x16x32_bf16 v[156:159], v[76:79], v[72:75], v[156:159]
    v_mfma_f32_16x16x32_bf16 v[172:175], v[80:83], v[72:75], v[172:175]
    v_mfma_f32_16x16x32_bf16 v[188:191], v[84:87], v[72:75], v[188:191]
    v_mfma_f32_16x16x32_bf16 v[204:207], v[88:91], v[72:75], v[204:207]
    v_mfma_f32_16x16x32_bf16 v[220:223], v[92:95], v[72:75], v[220:223]
    s_waitcnt lgkmcnt(0)
    s_bitcmp1_b32 s28, 0
    s_cbranch_scc1 L_sw_77
    v_swap_b32 v26, v28
    v_swap_b32 v27, v29
    v_swap_b32 v34, v36
    v_swap_b32 v35, v37
    s_branch L_sw_78
L_sw_77:
    v_swap_b32 v24, v30
    v_swap_b32 v25, v31
    v_swap_b32 v32, v38
    v_swap_b32 v33, v39
L_sw_78:
    s_barrier
    ds_read_b128 v[60:63], v8 offset:9216
    v_mfma_f32_16x16x32_bf16 v[144:147], v[40:43], v[24:27], v[144:147]
    ds_read_b128 v[64:67], v8 offset:10240
    v_mfma_f32_16x16x32_bf16 v[160:163], v[44:47], v[24:27], v[160:163]
    ds_read_b128 v[68:71], v8 offset:11264
    v_mfma_f32_16x16x32_bf16 v[176:179], v[48:51], v[24:27], v[176:179]
    ds_read_b128 v[72:75], v8 offset:12288
    v_mfma_f32_16x16x32_bf16 v[192:195], v[52:55], v[24:27], v[192:195]
    ds_read_b128 v[76:79], v8 offset:13312
    v_mfma_f32_16x16x32_bf16 v[208:211], v[56:59], v[24:27], v[208:211]
    ds_read_b128 v[80:83], v8 offset:14336
    v_mfma_f32_16x16x32_bf16 v[148:151], v[40:43], v[28:31], v[148:151]
    ds_read_b128 v[84:87], v8 offset:15360
    v_mfma_f32_16x16x32_bf16 v[164:167], v[44:47], v[28:31], v[164:167]
    ds_read_b128 v[88:91], v8 offset:16384
    v_mfma_f32_16x16x32_bf16 v[180:183], v[48:51], v[28:31], v[180:183]
    ds_read_b128 v[92:95], v8 offset:17408
    v_mfma_f32_16x16x32_bf16 v[196:199], v[52:55], v[28:31], v[196:199]
    v_mfma_f32_16x16x32_bf16 v[212:215], v[56:59], v[28:31], v[212:215]
    v_mfma_f32_16x16x32_bf16 v[152:155], v[40:43], v[32:35], v[152:155]
    v_mfma_f32_16x16x32_bf16 v[168:171], v[44:47], v[32:35], v[168:171]
    v_mfma_f32_16x16x32_bf16 v[184:187], v[48:51], v[32:35], v[184:187]
    v_mfma_f32_16x16x32_bf16 v[200:203], v[52:55], v[32:35], v[200:203]
    v_mfma_f32_16x16x32_bf16 v[216:219], v[56:59], v[32:35], v[216:219]
    v_mfma_f32_16x16x32_bf16 v[156:159], v[40:43], v[36:39], v[156:159]
    v_mfma_f32_16x16x32_bf16 v[172:175], v[44:47], v[36:39], v[172:175]
    v_mfma_f32_16x16x32_bf16 v[188:191], v[48:51], v[36:39], v[188:191]
    v_mfma_f32_16x16x32_bf16 v[204:207], v[52:55], v[36:39], v[204:207]
    v_mfma_f32_16x16x32_bf16 v[220:223], v[56:59], v[36:39], v[220:223]
    s_waitcnt lgkmcnt(0)
    s_bitcmp1_b32 s28, 0
    s_cbranch_scc1 L_sw_79
    v_swap_b32 v62, v64
    v_swap_b32 v63, v65
    v_swap_b32 v70, v72
    v_swap_b32 v71, v73
    s_branch L_sw_80
L_sw_79:
    v_swap_b32 v60, v66
    v_swap_b32 v61, v67
    v_swap_b32 v68, v74
    v_swap_b32 v69, v75
L_sw_80:
    s_barrier
    ds_read_b128 v[24:27], v8 offset:18432
    ds_read_b128 v[32:35], v20 offset:22528
    ds_read_b128 v[36:39], v20 offset:23552
    ds_read_b128 v[40:43], v20 offset:24576
    ds_read_b128 v[44:47], v20 offset:25600
    ds_read_b128 v[48:51], v20 offset:26624
    ds_read_b128 v[28:31], v8 offset:19456
    ds_read_b128 v[52:55], v21 offset:22528
    ds_read_b128 v[56:59], v21 offset:23552
    v_mfma_f32_16x16x32_bf16 v[144:147], v[76:79], v[60:63], v[144:147]
    v_mfma_f32_16x16x32_bf16 v[160:163], v[80:83], v[60:63], v[160:163]
    v_mfma_f32_16x16x32_bf16 v[176:179], v[84:87], v[60:63], v[176:179]
    v_mfma_f32_16x16x32_bf16 v[192:195], v[88:91], v[60:63], v[192:195]
    v_mfma_f32_16x16x32_bf16 v[208:211], v[92:95], v[60:63], v[208:211]
    v_mfma_f32_16x16x32_bf16 v[148:151], v[76:79], v[64:67], v[148:151]
    v_mfma_f32_16x16x32_bf16 v[164:167], v[80:83], v[64:67], v[164:167]
    v_mfma_f32_16x16x32_bf16 v[180:183], v[84:87], v[64:67], v[180:183]
    v_mfma_f32_16x16x32_bf16 v[196:199], v[88:91], v[64:67], v[196:199]
    v_mfma_f32_16x16x32_bf16 v[212:215], v[92:95], v[64:67], v[212:215]
    v_mfma_f32_16x16x32_bf16 v[152:155], v[76:79], v[68:71], v[152:155]
    v_mfma_f32_16x16x32_bf16 v[168:171], v[80:83], v[68:71], v[168:171]
    v_mfma_f32_16x16x32_bf16 v[184:187], v[84:87], v[68:71], v[184:187]
    v_mfma_f32_16x16x32_bf16 v[200:203], v[88:91], v[68:71], v[200:203]
    v_mfma_f32_16x16x32_bf16 v[216:219], v[92:95], v[68:71], v[216:219]
    v_mfma_f32_16x16x32_bf16 v[156:159], v[76:79], v[72:75], v[156:159]
    ds_read_b128 v[60:63], v21 offset:24576
    v_mfma_f32_16x16x32_bf16 v[172:175], v[80:83], v[72:75], v[172:175]
    ds_read_b128 v[64:67], v21 offset:25600
    v_mfma_f32_16x16x32_bf16 v[188:191], v[84:87], v[72:75], v[188:191]
    ds_read_b128 v[68:71], v21 offset:26624
    v_mfma_f32_16x16x32_bf16 v[204:207], v[88:91], v[72:75], v[204:207]
    v_mfma_f32_16x16x32_bf16 v[220:223], v[92:95], v[72:75], v[220:223]
    s_waitcnt lgkmcnt(6)
    v_mfma_f32_16x16x32_bf16 v[224:227], v[32:35], v[24:27], v[224:227]
    ds_read_b128 v[72:75], v8 offset:20480
    ds_read_b128 v[80:83], v22 offset:22528
    v_mfma_f32_16x16x32_bf16 v[228:231], v[36:39], v[24:27], v[228:231]
    ds_read_b128 v[84:87], v22 offset:23552
    v_mfma_f32_16x16x32_bf16 v[232:235], v[40:43], v[24:27], v[232:235]
    ds_read_b128 v[88:91], v22 offset:24576
    v_mfma_f32_16x16x32_bf16 v[236:239], v[44:47], v[24:27], v[236:239]
    ds_read_b128 v[92:95], v22 offset:25600
    v_mfma_f32_16x16x32_bf16 v[240:243], v[48:51], v[24:27], v[240:243]
    ds_read_b128 v[96:99], v22 offset:26624
    s_waitcnt lgkmcnt(6)
    v_mfma_f32_16x16x32_bf16 v[224:227], v[52:55], v[28:31], v[224:227]
    ds_read_b128 v[76:79], v8 offset:21504
    ds_read_b128 v[100:103], v23 offset:22528
    v_mfma_f32_16x16x32_bf16 v[228:231], v[56:59], v[28:31], v[228:231]
    ds_read_b128 v[104:107], v23 offset:23552
    v_mfma_f32_16x16x32_bf16 v[232:235], v[60:63], v[28:31], v[232:235]
    ds_read_b128 v[108:111], v23 offset:24576
    v_mfma_f32_16x16x32_bf16 v[236:239], v[64:67], v[28:31], v[236:239]
    ds_read_b128 v[112:115], v23 offset:25600
    v_mfma_f32_16x16x32_bf16 v[240:243], v[68:71], v[28:31], v[240:243]
    ds_read_b128 v[116:119], v23 offset:26624
    ds_write_b128 v17, v[148:151] offset:0
    ds_write_b128 v17, v[164:167] offset:1024
    ds_write_b128 v17, v[180:183] offset:2048
    ds_write_b128 v17, v[196:199] offset:3072
    s_waitcnt lgkmcnt(0)
    s_barrier
    v_mfma_f32_16x16x32_bf16 v[224:227], v[80:83], v[72:75], v[224:227]
    ds_read_b128 v[24:27], v8 offset:27648
    ds_read_b128 v[32:35], v20 offset:31744
    v_mfma_f32_16x16x32_bf16 v[228:231], v[84:87], v[72:75], v[228:231]
    ds_read_b128 v[36:39], v20 offset:32768
    ds_read_b128 v[40:43], v20 offset:33792
    v_mfma_f32_16x16x32_bf16 v[232:235], v[88:91], v[72:75], v[232:235]
    ds_read_b128 v[44:47], v20 offset:34816
    v_mfma_f32_16x16x32_bf16 v[236:239], v[92:95], v[72:75], v[236:239]
    ds_read_b128 v[48:51], v20 offset:35840
    v_mfma_f32_16x16x32_bf16 v[240:243], v[96:99], v[72:75], v[240:243]
    ds_read_b128 v[28:31], v8 offset:28672
    v_mfma_f32_16x16x32_bf16 v[224:227], v[100:103], v[76:79], v[224:227]
    ds_read_b128 v[52:55], v21 offset:31744
    v_mfma_f32_16x16x32_bf16 v[228:231], v[104:107], v[76:79], v[228:231]
    ds_read_b128 v[56:59], v21 offset:32768
    v_mfma_f32_16x16x32_bf16 v[232:235], v[108:111], v[76:79], v[232:235]
    ds_read_b128 v[60:63], v21 offset:33792
    v_mfma_f32_16x16x32_bf16 v[236:239], v[112:115], v[76:79], v[236:239]
    ds_read_b128 v[64:67], v21 offset:34816
    v_mfma_f32_16x16x32_bf16 v[240:243], v[116:119], v[76:79], v[240:243]
    ds_read_b128 v[68:71], v21 offset:35840
    s_waitcnt lgkmcnt(6)
    v_mfma_f32_16x16x32_bf16 v[224:227], v[32:35], v[24:27], v[224:227]
    ds_read_b128 v[72:75], v8 offset:29696
    ds_read_b128 v[80:83], v22 offset:31744
    v_mfma_f32_16x16x32_bf16 v[228:231], v[36:39], v[24:27], v[228:231]
    ds_read_b128 v[84:87], v22 offset:32768
    v_mfma_f32_16x16x32_bf16 v[232:235], v[40:43], v[24:27], v[232:235]
    ds_read_b128 v[88:91], v22 offset:33792
    v_mfma_f32_16x16x32_bf16 v[236:239], v[44:47], v[24:27], v[236:239]
    ds_read_b128 v[92:95], v22 offset:34816
    v_mfma_f32_16x16x32_bf16 v[240:243], v[48:51], v[24:27], v[240:243]
    ds_read_b128 v[96:99], v22 offset:35840
    s_waitcnt lgkmcnt(6)
    v_mfma_f32_16x16x32_bf16 v[224:227], v[52:55], v[28:31], v[224:227]
    ds_read_b128 v[76:79], v8 offset:30720
    ds_read_b128 v[100:103], v23 offset:31744
    v_mfma_f32_16x16x32_bf16 v[228:231], v[56:59], v[28:31], v[228:231]
    ds_read_b128 v[104:107], v23 offset:32768
    ds_read_b128 v[108:111], v23 offset:33792
    v_mfma_f32_16x16x32_bf16 v[232:235], v[60:63], v[28:31], v[232:235]
    ds_read_b128 v[112:115], v23 offset:34816
    ds_read_b128 v[116:119], v23 offset:35840
    v_mfma_f32_16x16x32_bf16 v[236:239], v[64:67], v[28:31], v[236:239]
    ds_read_b128 v[148:151], v16 offset:0
    ds_read_b128 v[164:167], v16 offset:1024
    v_mfma_f32_16x16x32_bf16 v[240:243], v[68:71], v[28:31], v[240:243]
    ds_read_b128 v[180:183], v16 offset:2048
    ds_read_b128 v[196:199], v16 offset:3072
    s_waitcnt lgkmcnt(0)
    s_barrier
    v_mfma_f32_16x16x32_bf16 v[224:227], v[80:83], v[72:75], v[224:227]
    ds_read_b128 v[24:27], v8 offset:0
    ds_read_b128 v[32:35], v20 offset:4096
    v_lshlrev_b32 v120, 16, v246
    v_and_b32 v121, s52, v246
    v_lshlrev_b32 v122, 16, v247
    v_mfma_f32_16x16x32_bf16 v[228:231], v[84:87], v[72:75], v[228:231]
    ds_read_b128 v[36:39], v20 offset:5120
    ds_read_b128 v[40:43], v20 offset:6144
    v_and_b32 v123, s52, v247
    v_lshlrev_b32 v124, 16, v248
    v_and_b32 v125, s52, v248
    v_mfma_f32_16x16x32_bf16 v[232:235], v[88:91], v[72:75], v[232:235]
    ds_read_b128 v[44:47], v20 offset:7168
    v_lshlrev_b32 v126, 16, v249
    v_and_b32 v127, s52, v249
    v_lshlrev_b32 v128, 16, v250
    v_mfma_f32_16x16x32_bf16 v[236:239], v[92:95], v[72:75], v[236:239]
    ds_read_b128 v[48:51], v20 offset:8192
    v_and_b32 v129, s52, v250
    v_lshlrev_b32 v130, 16, v251
    v_and_b32 v131, s52, v251
    v_mfma_f32_16x16x32_bf16 v[240:243], v[96:99], v[72:75], v[240:243]
    ds_read_b128 v[28:31], v8 offset:1024
    v_lshlrev_b32 v132, 16, v252
    v_and_b32 v133, s52, v252
    v_lshlrev_b32 v134, 16, v253
    v_mfma_f32_16x16x32_bf16 v[224:227], v[100:103], v[76:79], v[224:227]
    ds_read_b128 v[52:55], v21 offset:4096
    v_and_b32 v135, s52, v253
    v_lshlrev_b32 v136, 16, v254
    v_and_b32 v137, s52, v254
    v_mfma_f32_16x16x32_bf16 v[228:231], v[104:107], v[76:79], v[228:231]
    ds_read_b128 v[56:59], v21 offset:5120
    v_lshlrev_b32 v138, 16, v255
    v_and_b32 v139, s52, v255
    v_mfma_f32_16x16x32_bf16 v[232:235], v[108:111], v[76:79], v[232:235]
    ds_read_b128 v[60:63], v21 offset:6144
    v_mfma_f32_16x16x32_bf16 v[236:239], v[112:115], v[76:79], v[236:239]
    ds_read_b128 v[64:67], v21 offset:7168
    v_mfma_f32_16x16x32_bf16 v[240:243], v[116:119], v[76:79], v[240:243]
    ds_read_b128 v[68:71], v21 offset:8192
    s_waitcnt lgkmcnt(6)
    v_mfma_f32_16x16x32_bf16 v[224:227], v[32:35], v[24:27], v[224:227]
    ds_read_b128 v[72:75], v8 offset:2048
    ds_read_b128 v[80:83], v22 offset:4096
    v_mfma_f32_16x16x32_bf16 v[228:231], v[36:39], v[24:27], v[228:231]
    ds_read_b128 v[84:87], v22 offset:5120
    v_mfma_f32_16x16x32_bf16 v[232:235], v[40:43], v[24:27], v[232:235]
    ds_read_b128 v[88:91], v22 offset:6144
    v_mfma_f32_16x16x32_bf16 v[236:239], v[44:47], v[24:27], v[236:239]
    ds_read_b128 v[92:95], v22 offset:7168
    v_mfma_f32_16x16x32_bf16 v[240:243], v[48:51], v[24:27], v[240:243]
    ds_read_b128 v[96:99], v22 offset:8192
    s_waitcnt lgkmcnt(6)
    v_mfma_f32_16x16x32_bf16 v[224:227], v[52:55], v[28:31], v[224:227]
    ds_read_b128 v[76:79], v8 offset:3072
    ds_read_b128 v[100:103], v23 offset:4096
    v_mfma_f32_16x16x32_bf16 v[228:231], v[56:59], v[28:31], v[228:231]
    ds_read_b128 v[104:107], v23 offset:5120
    v_mfma_f32_16x16x32_bf16 v[232:235], v[60:63], v[28:31], v[232:235]
    ds_read_b128 v[108:111], v23 offset:6144
    v_mfma_f32_16x16x32_bf16 v[236:239], v[64:67], v[28:31], v[236:239]
    ds_read_b128 v[112:115], v23 offset:7168
    v_mfma_f32_16x16x32_bf16 v[240:243], v[68:71], v[28:31], v[240:243]
    ds_read_b128 v[116:119], v23 offset:8192
    ds_write_b128 v9, v[212:215] offset:27648
    ds_write_b128 v244, v[152:155] offset:28672
    ds_write_b128 v244, v[168:171] offset:29696
    ds_write_b128 v244, v[184:187] offset:30720
    ds_write_b128 v244, v[200:203] offset:31744
    ds_write_b128 v244, v[216:219] offset:32768
    ds_write_b128 v245, v[156:159] offset:33792
    ds_write_b128 v245, v[172:175] offset:34816
    ds_write_b128 v245, v[188:191] offset:35840
    ds_write_b128 v19, v[204:207] offset:0
    ds_write_b128 v19, v[220:223] offset:1024
    s_waitcnt lgkmcnt(0)
    s_barrier
    v_mfma_f32_16x16x32_bf16 v[224:227], v[80:83], v[72:75], v[224:227]
    ds_read_b128 v[24:27], v8 offset:9216
    ds_read_b128 v[32:35], v20 offset:13312
    v_mfma_f32_16x16x32_bf16 v[228:231], v[84:87], v[72:75], v[228:231]
    ds_read_b128 v[36:39], v20 offset:14336
    ds_read_b128 v[40:43], v20 offset:15360
    v_mfma_f32_16x16x32_bf16 v[232:235], v[88:91], v[72:75], v[232:235]
    ds_read_b128 v[44:47], v20 offset:16384
    v_mfma_f32_16x16x32_bf16 v[236:239], v[92:95], v[72:75], v[236:239]
    ds_read_b128 v[48:51], v20 offset:17408
    v_mfma_f32_16x16x32_bf16 v[240:243], v[96:99], v[72:75], v[240:243]
    ds_read_b128 v[28:31], v8 offset:10240
    v_mfma_f32_16x16x32_bf16 v[224:227], v[100:103], v[76:79], v[224:227]
    ds_read_b128 v[52:55], v21 offset:13312
    v_mfma_f32_16x16x32_bf16 v[228:231], v[104:107], v[76:79], v[228:231]
    ds_read_b128 v[56:59], v21 offset:14336
    v_mfma_f32_16x16x32_bf16 v[232:235], v[108:111], v[76:79], v[232:235]
    ds_read_b128 v[60:63], v21 offset:15360
    v_mfma_f32_16x16x32_bf16 v[236:239], v[112:115], v[76:79], v[236:239]
    ds_read_b128 v[64:67], v21 offset:16384
    v_mfma_f32_16x16x32_bf16 v[240:243], v[116:119], v[76:79], v[240:243]
    ds_read_b128 v[68:71], v21 offset:17408
    s_waitcnt lgkmcnt(6)
    v_mfma_f32_16x16x32_bf16 v[224:227], v[32:35], v[24:27], v[224:227]
    ds_read_b128 v[72:75], v8 offset:11264
    ds_read_b128 v[80:83], v22 offset:13312
    v_mfma_f32_16x16x32_bf16 v[228:231], v[36:39], v[24:27], v[228:231]
    ds_read_b128 v[84:87], v22 offset:14336
    v_mfma_f32_16x16x32_bf16 v[232:235], v[40:43], v[24:27], v[232:235]
    ds_read_b128 v[88:91], v22 offset:15360
    v_mfma_f32_16x16x32_bf16 v[236:239], v[44:47], v[24:27], v[236:239]
    ds_read_b128 v[92:95], v22 offset:16384
    v_mfma_f32_16x16x32_bf16 v[240:243], v[48:51], v[24:27], v[240:243]
    ds_read_b128 v[96:99], v22 offset:17408
    s_waitcnt lgkmcnt(6)
    v_mfma_f32_16x16x32_bf16 v[224:227], v[52:55], v[28:31], v[224:227]
    ds_read_b128 v[76:79], v8 offset:12288
    ds_read_b128 v[100:103], v23 offset:13312
    v_mfma_f32_16x16x32_bf16 v[228:231], v[56:59], v[28:31], v[228:231]
    ds_read_b128 v[104:107], v23 offset:14336
    ds_read_b128 v[108:111], v23 offset:15360
    v_mfma_f32_16x16x32_bf16 v[232:235], v[60:63], v[28:31], v[232:235]
    ds_read_b128 v[112:115], v23 offset:16384
    ds_read_b128 v[116:119], v23 offset:17408
    v_mfma_f32_16x16x32_bf16 v[236:239], v[64:67], v[28:31], v[236:239]
    ds_read_b128 v[212:215], v8 offset:27648
    ds_read_b128 v[152:155], v8 offset:28672
    v_mfma_f32_16x16x32_bf16 v[240:243], v[68:71], v[28:31], v[240:243]
    ds_read_b128 v[168:171], v8 offset:29696
    ds_read_b128 v[184:187], v8 offset:30720
    ds_read_b128 v[200:203], v8 offset:31744
    ds_read_b128 v[216:219], v8 offset:32768
    ds_read_b128 v[156:159], v8 offset:33792
    ds_read_b128 v[172:175], v8 offset:34816
    ds_read_b128 v[188:191], v8 offset:35840
    ds_read_b128 v[204:207], v16 offset:0
    ds_read_b128 v[220:223], v16 offset:1024
    s_waitcnt lgkmcnt(0)
    v_pk_add_f32 v[148:149], v[148:149], v[152:153]
    v_pk_add_f32 v[144:145], v[144:145], v[156:157]
    v_pk_add_f32 v[150:151], v[150:151], v[154:155]
    v_pk_add_f32 v[146:147], v[146:147], v[158:159]
    v_pk_add_f32 v[144:145], v[144:145], v[148:149]
    v_pk_add_f32 v[146:147], v[146:147], v[150:151]
    v_mul_f32 v148, s31, v144
    v_mul_f32 v149, s31, v145
    v_mul_f32 v150, s31, v146
    v_mul_f32 v151, s31, v147
    v_exp_f32 v148, v148
    v_exp_f32 v149, v149
    v_exp_f32 v150, v150
    v_exp_f32 v151, v151
    v_pk_add_f32 v[164:165], v[164:165], v[168:169]
    v_pk_add_f32 v[160:161], v[160:161], v[172:173]
    v_pk_add_f32 v[166:167], v[166:167], v[170:171]
    v_pk_add_f32 v[162:163], v[162:163], v[174:175]
    v_pk_add_f32 v[160:161], v[160:161], v[164:165]
    v_pk_add_f32 v[162:163], v[162:163], v[166:167]
    v_mul_f32 v164, s31, v160
    v_mul_f32 v165, s31, v161
    v_mul_f32 v166, s31, v162
    v_mul_f32 v167, s31, v163
    v_exp_f32 v164, v164
    v_exp_f32 v165, v165
    v_exp_f32 v166, v166
    v_exp_f32 v167, v167
    v_pk_add_f32 v[180:181], v[180:181], v[184:185]
    v_pk_add_f32 v[176:177], v[176:177], v[188:189]
    s_barrier
    v_mfma_f32_16x16x32_bf16 v[224:227], v[80:83], v[72:75], v[224:227]
    ds_read_b128 v[24:27], v8 offset:18432
    ds_read_b128 v[32:35], v20 offset:22528
    v_pk_add_f32 v[182:183], v[182:183], v[186:187]
    v_pk_add_f32 v[178:179], v[178:179], v[190:191]
    v_pk_add_f32 v[176:177], v[176:177], v[180:181]
    v_mfma_f32_16x16x32_bf16 v[228:231], v[84:87], v[72:75], v[228:231]
    ds_read_b128 v[36:39], v20 offset:23552
    ds_read_b128 v[40:43], v20 offset:24576
    v_pk_add_f32 v[178:179], v[178:179], v[182:183]
    v_mul_f32 v180, s31, v176
    v_mul_f32 v181, s31, v177
    v_mfma_f32_16x16x32_bf16 v[232:235], v[88:91], v[72:75], v[232:235]
    ds_read_b128 v[44:47], v20 offset:25600
    v_mul_f32 v182, s31, v178
    v_mul_f32 v183, s31, v179
    v_exp_f32 v180, v180
    v_mfma_f32_16x16x32_bf16 v[236:239], v[92:95], v[72:75], v[236:239]
    ds_read_b128 v[48:51], v20 offset:26624
    v_exp_f32 v181, v181
    v_exp_f32 v182, v182
    v_exp_f32 v183, v183
    v_mfma_f32_16x16x32_bf16 v[240:243], v[96:99], v[72:75], v[240:243]
    ds_read_b128 v[28:31], v8 offset:19456
    v_pk_add_f32 v[196:197], v[196:197], v[200:201]
    v_pk_add_f32 v[192:193], v[192:193], v[204:205]
    v_pk_add_f32 v[198:199], v[198:199], v[202:203]
    v_mfma_f32_16x16x32_bf16 v[224:227], v[100:103], v[76:79], v[224:227]
    ds_read_b128 v[52:55], v21 offset:22528
    v_pk_add_f32 v[194:195], v[194:195], v[206:207]
    v_pk_add_f32 v[192:193], v[192:193], v[196:197]
    v_pk_add_f32 v[194:195], v[194:195], v[198:199]
    v_mfma_f32_16x16x32_bf16 v[228:231], v[104:107], v[76:79], v[228:231]
    ds_read_b128 v[56:59], v21 offset:23552
    v_mul_f32 v196, s31, v192
    v_mul_f32 v197, s31, v193
    v_mul_f32 v198, s31, v194
    v_mfma_f32_16x16x32_bf16 v[232:235], v[108:111], v[76:79], v[232:235]
    ds_read_b128 v[60:63], v21 offset:24576
    v_mul_f32 v199, s31, v195
    v_exp_f32 v196, v196
    v_exp_f32 v197, v197
    v_mfma_f32_16x16x32_bf16 v[236:239], v[112:115], v[76:79], v[236:239]
    ds_read_b128 v[64:67], v21 offset:25600
    v_exp_f32 v198, v198
    v_exp_f32 v199, v199
    v_pk_add_f32 v[212:213], v[212:213], v[216:217]
    v_mfma_f32_16x16x32_bf16 v[240:243], v[116:119], v[76:79], v[240:243]
    ds_read_b128 v[68:71], v21 offset:26624
    v_pk_add_f32 v[208:209], v[208:209], v[220:221]
    v_pk_add_f32 v[214:215], v[214:215], v[218:219]
    v_pk_add_f32 v[210:211], v[210:211], v[222:223]
    s_waitcnt lgkmcnt(6)
    v_mfma_f32_16x16x32_bf16 v[224:227], v[32:35], v[24:27], v[224:227]
    ds_read_b128 v[72:75], v8 offset:20480
    ds_read_b128 v[80:83], v22 offset:22528
    v_pk_add_f32 v[208:209], v[208:209], v[212:213]
    v_pk_add_f32 v[210:211], v[210:211], v[214:215]
    v_mul_f32 v212, s31, v208
    v_mfma_f32_16x16x32_bf16 v[228:231], v[36:39], v[24:27], v[228:231]
    ds_read_b128 v[84:87], v22 offset:23552
    v_mul_f32 v213, s31, v209
    v_mul_f32 v214, s31, v210
    v_mul_f32 v215, s31, v211
    v_mfma_f32_16x16x32_bf16 v[232:235], v[40:43], v[24:27], v[232:235]
    ds_read_b128 v[88:91], v22 offset:24576
    v_exp_f32 v212, v212
    v_exp_f32 v213, v213
    v_exp_f32 v214, v214
    v_mfma_f32_16x16x32_bf16 v[236:239], v[44:47], v[24:27], v[236:239]
    ds_read_b128 v[92:95], v22 offset:25600
    v_exp_f32 v215, v215
    v_add_f32 v148, 1.0, v148
    v_add_f32 v149, 1.0, v149
    v_mfma_f32_16x16x32_bf16 v[240:243], v[48:51], v[24:27], v[240:243]
    ds_read_b128 v[96:99], v22 offset:26624
    v_add_f32 v150, 1.0, v150
    v_add_f32 v151, 1.0, v151
    v_add_f32 v164, 1.0, v164
    s_waitcnt lgkmcnt(6)
    v_mfma_f32_16x16x32_bf16 v[224:227], v[52:55], v[28:31], v[224:227]
    ds_read_b128 v[76:79], v8 offset:21504
    ds_read_b128 v[100:103], v23 offset:22528
    v_add_f32 v165, 1.0, v165
    v_add_f32 v166, 1.0, v166
    v_add_f32 v167, 1.0, v167
    v_mfma_f32_16x16x32_bf16 v[228:231], v[56:59], v[28:31], v[228:231]
    ds_read_b128 v[104:107], v23 offset:23552
    v_add_f32 v180, 1.0, v180
    v_add_f32 v181, 1.0, v181
    v_add_f32 v182, 1.0, v182
    v_mfma_f32_16x16x32_bf16 v[232:235], v[60:63], v[28:31], v[232:235]
    ds_read_b128 v[108:111], v23 offset:24576
    v_add_f32 v183, 1.0, v183
    v_add_f32 v196, 1.0, v196
    v_add_f32 v197, 1.0, v197
    v_mfma_f32_16x16x32_bf16 v[236:239], v[64:67], v[28:31], v[236:239]
    ds_read_b128 v[112:115], v23 offset:25600
    v_add_f32 v198, 1.0, v198
    v_add_f32 v199, 1.0, v199
    v_add_f32 v212, 1.0, v212
    v_mfma_f32_16x16x32_bf16 v[240:243], v[68:71], v[28:31], v[240:243]
    ds_read_b128 v[116:119], v23 offset:26624
    v_add_f32 v213, 1.0, v213
    v_add_f32 v214, 1.0, v214
    v_add_f32 v215, 1.0, v215
    s_waitcnt lgkmcnt(0)
    v_mfma_f32_16x16x32_bf16 v[224:227], v[80:83], v[72:75], v[224:227]
    v_rcp_f32 v148, v148
    v_rcp_f32 v149, v149
    v_rcp_f32 v150, v150
    v_mfma_f32_16x16x32_bf16 v[228:231], v[84:87], v[72:75], v[228:231]
    v_rcp_f32 v151, v151
    v_rcp_f32 v164, v164
    v_rcp_f32 v165, v165
    v_mfma_f32_16x16x32_bf16 v[232:235], v[88:91], v[72:75], v[232:235]
    v_rcp_f32 v166, v166
    v_rcp_f32 v167, v167
    v_rcp_f32 v180, v180
    v_mfma_f32_16x16x32_bf16 v[236:239], v[92:95], v[72:75], v[236:239]
    v_rcp_f32 v181, v181
    v_rcp_f32 v182, v182
    v_rcp_f32 v183, v183
    v_mfma_f32_16x16x32_bf16 v[240:243], v[96:99], v[72:75], v[240:243]
    v_rcp_f32 v196, v196
    v_rcp_f32 v197, v197
    v_rcp_f32 v198, v198
    v_mfma_f32_16x16x32_bf16 v[224:227], v[100:103], v[76:79], v[224:227]
    v_rcp_f32 v199, v199
    v_rcp_f32 v212, v212
    v_rcp_f32 v213, v213
    v_mfma_f32_16x16x32_bf16 v[228:231], v[104:107], v[76:79], v[228:231]
    v_rcp_f32 v214, v214
    v_rcp_f32 v215, v215
    v_pk_mul_f32 v[144:145], v[144:145], v[148:149]
    v_mfma_f32_16x16x32_bf16 v[232:235], v[108:111], v[76:79], v[232:235]
    v_pk_mul_f32 v[146:147], v[146:147], v[150:151]
    v_pk_mul_f32 v[160:161], v[160:161], v[164:165]
    v_pk_mul_f32 v[162:163], v[162:163], v[166:167]
    v_mfma_f32_16x16x32_bf16 v[236:239], v[112:115], v[76:79], v[236:239]
    v_pk_mul_f32 v[176:177], v[176:177], v[180:181]
    v_pk_mul_f32 v[178:179], v[178:179], v[182:183]
    v_pk_mul_f32 v[192:193], v[192:193], v[196:197]
    v_mfma_f32_16x16x32_bf16 v[240:243], v[116:119], v[76:79], v[240:243]
    v_pk_mul_f32 v[194:195], v[194:195], v[198:199]
    v_pk_mul_f32 v[208:209], v[208:209], v[212:213]
    v_pk_mul_f32 v[210:211], v[210:211], v[214:215]
    s_nop 5
    v_pk_fma_f32 v[120:121], v[144:145], v[224:225], v[120:121]
    v_pk_fma_f32 v[122:123], v[146:147], v[226:227], v[122:123]
    v_cvt_pk_bf16_f32 v246, v120, v121
    v_cvt_pk_bf16_f32 v247, v122, v123
    v_pk_fma_f32 v[124:125], v[160:161], v[228:229], v[124:125]
    v_pk_fma_f32 v[126:127], v[162:163], v[230:231], v[126:127]
    v_cvt_pk_bf16_f32 v248, v124, v125
    v_cvt_pk_bf16_f32 v249, v126, v127
    buffer_store_dwordx4 v[246:249], v14, s[16:19], 0 offen
    v_pk_fma_f32 v[128:129], v[176:177], v[232:233], v[128:129]
    v_pk_fma_f32 v[130:131], v[178:179], v[234:235], v[130:131]
    v_cvt_pk_bf16_f32 v250, v128, v129
    v_cvt_pk_bf16_f32 v251, v130, v131
    v_pk_fma_f32 v[132:133], v[192:193], v[236:237], v[132:133]
    v_pk_fma_f32 v[134:135], v[194:195], v[238:239], v[134:135]
    v_cvt_pk_bf16_f32 v252, v132, v133
    v_cvt_pk_bf16_f32 v253, v134, v135
    buffer_store_dwordx4 v[250:253], v14, s[16:19], 0 offen offset:64
    v_pk_fma_f32 v[136:137], v[208:209], v[240:241], v[136:137]
    v_pk_fma_f32 v[138:139], v[210:211], v[242:243], v[138:139]
    v_cvt_pk_bf16_f32 v254, v136, v137
    v_cvt_pk_bf16_f32 v255, v138, v139
    buffer_store_dwordx2 v[254:255], v15, s[16:19], 0 offen offset:128
    s_endpgm
L_code_end:
.section .rodata,"a"
.p2align 6
.amdhsa_kernel recurrent_scan__linear_attn_block__glu_gated_reglu__prompt_kernel
  .amdhsa_next_free_vgpr 256
  .amdhsa_next_free_sgpr 100
  .amdhsa_accum_offset 256
  .amdhsa_group_segment_fixed_size 0
  .amdhsa_kernarg_size 80
  .amdhsa_user_sgpr_count 2
  .amdhsa_user_sgpr_kernarg_segment_ptr 1
  .amdhsa_system_sgpr_workgroup_id_x 1
.end_amdhsa_kernel
```
